```python
import torch

def _softmax(x, axis=-1):
    return torch.softmax(x, dim=axis)
def _gelu(x):
    return torch.nn.functional.gelu(x, approximate="tanh")
def _silu(x):
    return torch.nn.functional.silu(x)
def _sigmoid(x):
    return torch.sigmoid(x)
def _layernorm(x, axis=-1, eps=1e-5):
    m = x.mean(dim=axis, keepdim=True)
    v = x.var(dim=axis, keepdim=True, unbiased=False)
    return (x - m) / torch.sqrt(v + eps)
def _scatter_add(tgt, idx, src, axis=0):
    return tgt.clone().index_add_(axis, idx, src)
def _segment_sum(src, seg, n):
    out = torch.zeros((n,) + src.shape[1:], dtype=src.dtype)
    return out.index_add_(0, seg, src)
def _pad(x, pw):
    flat = tuple(v for pair in reversed(pw) for v in pair)
    return torch.nn.functional.pad(x, flat)

kernel_name = 'concat_heads__mha_block_cached__mha_block_cached__near_ridge'

def setup_inputs():

    _w = (lambda a: (lambda t: t.to(torch.bfloat16) if t.is_floating_point() else t)(torch.as_tensor(a)))
    def _A_setup():
        B, Sq, D = 16, 192, 576
        H, Sk, Dh = 32, 512, 128
        return {
            "x": _w((lambda *s: torch.randn(*s, dtype=torch.bfloat16) * 0.8)(B, Sq, D)),
            "k_cache": _w((lambda *s: torch.randn(*s, dtype=torch.bfloat16) * 0.8)(B, H, Sk, Dh)),
            "v_cache": _w((lambda *s: torch.randn(*s, dtype=torch.bfloat16) * 0.05)(B, H, Sk, Dh)),
            "wq": _w((lambda *s: torch.randn(*s, dtype=torch.bfloat16) * 0.8)(D, H * Dh) * (D ** -0.5)),
            "wo": _w((lambda *s: torch.randn(*s, dtype=torch.bfloat16) * 0.05)(H * Dh, D) * ((H * Dh) ** -0.5)),
        }
    _A_in = _A_setup()

    def _B_setup():
        B, Sq, D = 16, 192, 576
        H, Sk, Dh = 32, 512, 128
        return {
            "x": _w((lambda *s: torch.randn(*s, dtype=torch.bfloat16) * 0.8)(B, Sq, D)),
            "k_cache": _w((lambda *s: torch.randn(*s, dtype=torch.bfloat16) * 0.8)(B, H, Sk, Dh)),
            "v_cache": _w((lambda *s: torch.randn(*s, dtype=torch.bfloat16) * 0.05)(B, H, Sk, Dh)),
            "wq": _w((lambda *s: torch.randn(*s, dtype=torch.bfloat16) * 0.8)(D, H * Dh) * (D ** -0.5)),
            "wo": _w((lambda *s: torch.randn(*s, dtype=torch.bfloat16) * 0.05)(H * Dh, D) * ((H * Dh) ** -0.5)),
        }
    _B_in = _B_setup()

    return {
        "A_x": _A_in["x"],
        "A_k_cache": _A_in["k_cache"],
        "A_v_cache": _A_in["v_cache"],
        "A_wq": _A_in["wq"],
        "A_wo": _A_in["wo"],
        "B_x": _B_in["x"],
        "B_k_cache": _B_in["k_cache"],
        "B_v_cache": _B_in["v_cache"],
        "B_wq": _B_in["wq"],
        "B_wo": _B_in["wo"],
    }

def reference(A_x, A_k_cache, A_v_cache, A_wq, A_wo, B_x, B_k_cache, B_v_cache, B_wq, B_wo):
    def _A_ref(x, k_cache, v_cache, wq, wo):
        B, Sq, D = x.shape
        H, Dh = 32, 128
        q = (lambda x, *d: x.permute(*d))((x @ wq).reshape(B, Sq, H, Dh), 0, 2, 1, 3)
        scores = torch.einsum("bhqd,bhkd->bhqk", q, k_cache) * (Dh ** -0.5)
        p = _softmax(scores, axis=-1)
        o = torch.einsum("bhqk,bhkd->bhqd", p, v_cache)
        return (lambda x, *d: x.permute(*d))(o, 0, 2, 1, 3).reshape(B, Sq, H * Dh) @ wo

    def _B_ref(x, k_cache, v_cache, wq, wo):
        B, Sq, D = x.shape
        H, Dh = 32, 128
        q = (lambda x, *d: x.permute(*d))((x @ wq).reshape(B, Sq, H, Dh), 0, 2, 1, 3)
        scores = torch.einsum("bhqd,bhkd->bhqk", q, k_cache) * (Dh ** -0.5)
        p = _softmax(scores, axis=-1)
        o = torch.einsum("bhqk,bhkd->bhqd", p, v_cache)
        return (lambda x, *d: x.permute(*d))(o, 0, 2, 1, 3).reshape(B, Sq, H * Dh) @ wo

    a = _A_ref(A_x, A_k_cache, A_v_cache, A_wq, A_wo)
    b = _B_ref(B_x, B_k_cache, B_v_cache, B_wq, B_wo)
    return torch.concatenate([a, b], axis=-1)
```

```asm
; @launch grid=(256,1,1) block=(512,1,1) lds=163840
.amdgcn_target "amdgcn-amd-amdhsa--gfx950"
.macro MA d,a,b
v_mfma_f32_16x16x32_bf16 v[\d:\d+3], v[\a:\a+3], v[\b:\b+3], v[\d:\d+3]
.endm
.macro MZ d,a,b
v_mfma_f32_16x16x32_bf16 v[\d:\d+3], v[\a:\a+3], v[\b:\b+3], 0
.endm
.macro MC d,a,b,c
v_mfma_f32_16x16x32_bf16 v[\d:\d+3], v[\a:\a+3], v[\b:\b+3], v[\c:\c+3]
.endm
.macro TR d,a,o
ds_read_b64_tr_b16 v[\d:\d+1], v\a offset:\o
.endm
.text
.globl concat_heads__mha_block_cached__mha_block_cached__near_ridge_kernel
.p2align 8
.type concat_heads__mha_block_cached__mha_block_cached__near_ridge_kernel,@function
concat_heads__mha_block_cached__mha_block_cached__near_ridge_kernel:
s_cmp_lt_u32 s2, 256
s_cbranch_scc1 L_go
s_endpgm
L_go:
s_load_dwordx16 s[16:31], s[0:1], 0
s_load_dwordx8 s[32:39], s[0:1], 64
s_load_dwordx2 s[90:91], s[0:1], 96
v_lshrrev_b32 v16, 6, v0
v_and_b32 v24, 63, v0
v_readfirstlane_b32 s62, v16
s_and_b32 s3, s2, 7
s_lshr_b32 s4, s2, 3
s_and_b32 s71, s4, 3
s_and_b32 s5, s3, 1
s_lshl_b32 s5, s5, 2
s_add_u32 s71, s71, s5
s_lshr_b32 s5, s4, 2
s_lshr_b32 s86, s3, 1
s_lshl_b32 s86, s86, 3
s_add_u32 s86, s86, s5
s_and_b32 s60, s62, 3
s_lshr_b32 s6, s62, 2
s_lshl_b32 s7, s71, 1
s_add_u32 s7, s7, s6
s_mul_i32 s63, s6, 81920
s_lshl_b32 s61, s60, 10
s_add_u32 s61, s61, s63
s_mov_b32 s64, 131072
s_mov_b32 s65, 262144
v_mbcnt_lo_u32_b32 v21, -1, 0
v_mbcnt_hi_u32_b32 v21, -1, v21
v_lshrrev_b32 v19, 4, v21
v_lshl_add_u32 v16, s60, 2, v19
v_and_b32 v17, 15, v21
v_and_b32 v18, 3, v16
v_lshrrev_b32 v20, 3, v16
v_lshl_add_u32 v18, v20, 2, v18
v_lshlrev_b32 v18, 1, v18
v_xor_b32 v18, v18, v17
v_lshlrev_b32 v18, 4, v18
v_lshl_add_u32 v0, v16, 13, v18
s_lshr_b32 s73, s62, 2
s_mul_i32 s73, s73, 96
s_lshl_b32 s74, s60, 3
s_add_u32 s73, s73, s74
s_and_b32 s74, s60, 1
s_lshl_b32 s74, s74, 2
v_lshrrev_b32 v18, 3, v21
v_add_u32 v18, s73, v18
v_mul_u32_u24 v18, 1152, v18
v_and_b32 v20, 7, v21
v_xor_b32 v20, v20, v19
v_xor_b32 v20, s74, v20
v_lshl_add_u32 v1, v20, 4, v18
s_waitcnt lgkmcnt(0)
s_cmp_lt_u32 s86, 16
s_cselect_b64 s[8:9], s[16:17], s[26:27]
s_cselect_b64 s[10:11], s[18:19], s[28:29]
s_cselect_b64 s[12:13], s[20:21], s[30:31]
s_cselect_b64 s[14:15], s[22:23], s[32:33]
s_cselect_b64 s[24:25], s[24:25], s[34:35]
s_mov_b64 s[84:85], s[38:39]
s_and_b32 s5, s86, 15
s_mul_i32 s72, s5, 221184
s_add_u32 s40, s8, s72
s_addc_u32 s41, s9, 0
s_mov_b32 s42, 221184
s_mov_b32 s43, 0x20000
s_lshl_b32 s72, s7, 8
s_add_u32 s44, s14, s72
s_addc_u32 s45, s15, 0
s_sub_u32 s46, 4718592, s72
s_mov_b32 s47, 0x20000
s_lshl_b32 s72, s86, 13
s_add_u32 s72, s72, 104857600
s_add_u32 s96, s90, s72
s_addc_u32 s97, s91, 0
s_getpc_b64 s[72:73]
s_cmp_lg_u32 s62, 1
s_cbranch_scc1 L_tc
v_min_u32 v43, 19, v24
s_mul_i32 s74, s4, 20
v_add_u32 v43, s74, v43
v_lshlrev_b32 v43, 7, v43
global_load_dword v44, v43, s[72:73]
L_tc:
s_cmp_lg_u32 s62, 0
s_cbranch_scc1 L_z
s_lshl_b32 s73, s71, 9
s_add_u32 s73, s73, 3968
s_lshl_b32 s74, s71, 2
v_lshl_add_u32 v41, v24, 7, s73
v_writelane_b32 v41, s74, 0
v_mov_b32 v42, 0
s_mov_b64 exec, 31
global_store_dword v41, v42, s[96:97] sc0 sc1
s_mov_b64 exec, -1
L_z:
s_add_u32 m0, s61, 0
s_mov_b32 s66, 0
buffer_load_dwordx4 v1, s[40:43], s66 offen lds
s_add_u32 m0, s61, 4096
s_mov_b32 s66, 36864
buffer_load_dwordx4 v1, s[40:43], s66 offen lds
s_add_u32 m0, s61, 8192
s_mov_b32 s66, 73728
buffer_load_dwordx4 v1, s[40:43], s66 offen lds
s_add_u32 m0, s61, 40960
s_mov_b32 s66, 0
buffer_load_dwordx4 v0, s[44:47], s66 offen nt lds
s_add_u32 m0, s61, 45056
s_mov_b32 s66, 131072
buffer_load_dwordx4 v0, s[44:47], s66 offen nt lds
s_add_u32 m0, s61, 49152
s_mov_b32 s66, 262144
buffer_load_dwordx4 v0, s[44:47], s66 offen nt lds
s_add_u32 m0, s61, 53248
s_mov_b32 s66, 393216
buffer_load_dwordx4 v0, s[44:47], s66 offen nt lds
s_add_u32 m0, s61, 12288
s_mov_b32 s66, 128
buffer_load_dwordx4 v1, s[40:43], s66 offen lds
s_add_u32 m0, s61, 16384
s_mov_b32 s66, 36992
buffer_load_dwordx4 v1, s[40:43], s66 offen lds
s_add_u32 m0, s61, 20480
s_mov_b32 s66, 73856
buffer_load_dwordx4 v1, s[40:43], s66 offen lds
s_add_u32 m0, s61, 57344
s_mov_b32 s66, 524288
buffer_load_dwordx4 v0, s[44:47], s66 offen nt lds
s_add_u32 m0, s61, 61440
s_mov_b32 s66, 655360
buffer_load_dwordx4 v0, s[44:47], s66 offen nt lds
s_add_u32 m0, s61, 24576
s_mov_b32 s66, 256
buffer_load_dwordx4 v1, s[40:43], s66 offen lds
s_add_u32 m0, s61, 28672
s_mov_b32 s66, 37120
buffer_load_dwordx4 v1, s[40:43], s66 offen lds
s_add_u32 m0, s61, 32768
s_mov_b32 s66, 73984
buffer_load_dwordx4 v1, s[40:43], s66 offen lds
s_add_u32 m0, s61, 65536
s_mov_b32 s66, 786432
buffer_load_dwordx4 v0, s[44:47], s66 offen nt lds
s_add_u32 m0, s61, 69632
s_mov_b32 s66, 917504
buffer_load_dwordx4 v0, s[44:47], s66 offen nt lds
s_add_u32 m0, s61, 73728
s_mov_b32 s66, 1048576
buffer_load_dwordx4 v0, s[44:47], s66 offen nt lds
s_add_u32 m0, s61, 77824
s_mov_b32 s66, 1179648
buffer_load_dwordx4 v0, s[44:47], s66 offen nt lds
s_lshl_b32 s72, s5, 5
s_add_u32 s72, s72, s7
s_lshl_b32 s72, s72, 17
s_add_u32 s48, s10, s72
s_addc_u32 s49, s11, 0
s_mov_b32 s50, 2228224
s_mov_b32 s51, 0x20000
s_add_u32 s52, s12, s72
s_addc_u32 s53, s13, 0
s_mov_b32 s54, 2228224
s_mov_b32 s55, 0x20000
s_mul_i32 s72, s86, 1572864
s_add_u32 s56, s90, s72
s_addc_u32 s57, s91, 0
s_mov_b32 s58, 1572864
s_mov_b32 s59, 0x20000
s_mul_i32 s72, s2, 98304
s_add_u32 s72, s72, 52428800
s_add_u32 s80, s90, s72
s_addc_u32 s81, s91, 0
s_mov_b32 s82, 98304
s_mov_b32 s83, 0x20000
s_mul_i32 s89, s60, 393216
s_lshl_b32 s72, s7, 12
s_add_u32 s89, s89, s72
s_mov_b32 s67, 0x5d800000
s_mov_b32 s68, 0x3e0293ee
s_mov_b32 s69, 0x3e0293ee
s_mov_b32 s26, 4718592
s_mov_b32 s27, 0x20000
s_lshr_b32 s74, s71, 2
s_lshl_b32 s74, s74, 3
s_add_u32 s74, s74, s6
s_and_b32 s72, s71, 3
s_mul_i32 s72, s72, 288
s_mul_i32 s73, s74, 147456
s_add_u32 s73, s73, s72
s_add_u32 s16, s24, s73
s_addc_u32 s17, s25, 0
s_sub_u32 s18, 4718592, s73
s_mov_b32 s19, 0x20000
s_mul_i32 s73, s5, 192
s_mul_i32 s75, s60, 48
s_add_u32 s73, s73, s75
s_mul_i32 s73, s73, 2304
s_lshr_b32 s75, s86, 4
s_mul_i32 s75, s75, 1152
s_add_u32 s73, s73, s75
s_add_u32 s73, s73, s72
s_add_u32 s20, s36, s73
s_addc_u32 s21, s37, 0
s_mov_b32 s22, 108576
s_mov_b32 s23, 0x20000
s_mul_i32 s88, s60, 2304
s_add_u32 s88, s88, s63
s_mul_i32 s94, s60, 393216
s_lshl_b32 s73, s74, 12
s_add_u32 s94, s94, s73
s_add_u32 s73, s71, 0
s_and_b32 s73, s73, 3
s_mul_i32 s8, s73, 294912
s_lshl_b32 s12, s73, 13
s_add_u32 s12, s12, 65536
s_add_u32 s73, s71, 1
s_and_b32 s73, s73, 3
s_mul_i32 s9, s73, 294912
s_lshl_b32 s13, s73, 13
s_add_u32 s13, s13, 65536
s_add_u32 s73, s71, 2
s_and_b32 s73, s73, 3
s_mul_i32 s10, s73, 294912
s_lshl_b32 s14, s73, 13
s_add_u32 s14, s14, 65536
s_add_u32 s73, s71, 3
s_and_b32 s73, s73, 3
s_mul_i32 s11, s73, 294912
s_lshl_b32 s15, s73, 13
s_add_u32 s15, s15, 65536
s_lshl_b32 s72, s86, 2
s_and_b32 s73, s71, 3
s_add_u32 s72, s72, s73
s_lshl_b32 s72, s72, 3
s_add_u32 s72, s72, s62
s_mul_i32 s72, s72, 14336
s_add_u32 s72, s72, 134217728
s_add_u32 s28, s90, s72
s_addc_u32 s29, s91, 0
s_mov_b32 s30, 14336
s_mov_b32 s31, 0x20000
s_mov_b32 s36, 9216
s_cmp_eq_u32 s60, 1
s_cselect_b32 s36, 36864, s36
s_cmp_eq_u32 s60, 2
s_cselect_b32 s36, 51200, s36
s_cmp_eq_u32 s60, 3
s_cselect_b32 s36, 65536, s36
s_sub_u32 s72, 81920, s63
s_add_u32 s37, s36, s72
s_add_u32 s36, s36, s63
s_lshr_b32 s72, s60, 1
s_lshr_b32 s73, s71, 2
s_xor_b32 s38, s72, s73
s_xor_b32 s72, s71, 4
s_cmp_lg_u32 s38, 0
s_cselect_b32 s72, s71, s72
s_lshl_b32 s72, s72, 2
s_and_b32 s73, s60, 1
s_add_u32 s72, s72, s73
s_lshl_b32 s73, s6, 1
s_add_u32 s72, s72, s73
s_lshl_b32 s72, s72, 7
s_add_u32 s39, s72, 4096
v_lshrrev_b32 v19, 5, v16
v_lshlrev_b32 v19, 17, v19
v_and_b32 v20, 31, v16
v_lshl_add_u32 v19, v20, 8, v19
v_xor_b32 v18, v16, v17
v_lshl_add_u32 v3, v18, 4, v19
v_and_b32 v18, 7, v16
v_lshlrev_b32 v18, 1, v18
v_xor_b32 v18, v18, v17
v_lshl_add_u32 v2, v18, 4, v19
s_lshr_b32 s72, s60, 1
s_mul_i32 s72, s72, 81920
s_and_b32 s73, s60, 1
s_mul_i32 s73, s73, 6144
s_add_u32 s32, s72, s73
s_and_b32 s72, s2, 3
s_lshl_b32 s73, s4, 2
s_add_u32 s72, s72, s73
s_lshl_b32 s72, s72, 1
s_add_u32 s79, s72, s6
s_lshl_b32 s72, s4, 1
s_add_u32 s72, s72, s6
s_lshr_b32 s73, s4, 3
s_add_u32 s72, s72, s73
s_add_u32 s72, s72, s3
s_and_b32 s72, s72, 15
s_lshl_b32 s98, s72, 13
v_mbcnt_lo_u32_b32 v28, -1, 0
v_mbcnt_hi_u32_b32 v28, -1, v28
v_and_b32 v25, 15, v28
v_lshrrev_b32 v27, 4, v28
v_lshrrev_b32 v26, 1, v25
v_xor_b32 v26, v26, v27
v_lshlrev_b32 v26, 4, v26
v_lshl_add_u32 v26, v25, 7, v26
v_add_u32 v60, s32, v26
v_xor_b32 v61, 64, v60
v_lshrrev_b32 v24, 2, v28
v_and_b32 v24, 3, v24
v_lshl_add_u32 v25, v27, 3, v24
v_and_b32 v26, 1, v27
v_lshl_add_u32 v26, v26, 2, v24
v_lshlrev_b32 v26, 5, v26
v_lshl_add_u32 v26, v25, 8, v26
v_and_b32 v28, 3, v28
v_lshl_add_u32 v26, v28, 3, v26
v_add_u32 v26, 24576, v26
v_add_u32 v52, s63, v26
v_xor_b32 v53, 32, v52
v_xor_b32 v54, 64, v52
v_xor_b32 v55, 96, v52
v_xor_b32 v56, 128, v52
v_xor_b32 v57, 160, v52
v_xor_b32 v58, 192, v52
v_xor_b32 v59, 224, v52
v_mbcnt_lo_u32_b32 v24, -1, 0
v_mbcnt_hi_u32_b32 v24, -1, v24
v_and_b32 v25, 15, v24
v_lshrrev_b32 v26, 4, v24
v_xor_b32 v27, v25, v26
v_lshlrev_b32 v27, 4, v27
v_lshl_add_u32 v27, v25, 8, v27
v_add_u32 v4, s63, v27
v_xor_b32 v5, 64, v4
v_xor_b32 v6, 128, v4
v_xor_b32 v7, 192, v4
v_lshrrev_b32 v25, 2, v24
v_and_b32 v26, 3, v24
v_lshlrev_b32 v26, 3, v26
v_lshl_add_u32 v26, v25, 8, v26
v_and_b32 v27, 7, v25
v_lshl_add_u32 v26, v27, 5, v26
v_add_u32 v26, 40960, v26
v_add_u32 v8, s63, v26
v_xor_b32 v9, 32, v8
v_xor_b32 v10, 64, v8
v_xor_b32 v11, 96, v8
v_xor_b32 v12, 128, v8
v_xor_b32 v13, 160, v8
v_xor_b32 v14, 192, v8
v_xor_b32 v15, 224, v8
v_and_b32 v25, 3, v24
v_mov_b32 v26, 0x3f803f80
v_cmp_eq_u32 vcc, 0, v25
s_nop 1
v_cndmask_b32 v36, 0, v26, vcc
v_mov_b32 v37, v36
v_mov_b32 v38, v36
v_mov_b32 v39, v36
s_waitcnt vmcnt(14)
s_barrier
ds_read_b128 v[64:67], v60 offset:0
ds_read_b128 v[76:79], v61 offset:0
ds_read_b128 v[68:71], v60 offset:2048
ds_read_b128 v[80:83], v61 offset:2048
ds_read_b128 v[72:75], v60 offset:4096
ds_read_b128 v[84:87], v61 offset:4096
TR 16,52,16384
TR 18,52,17408
s_waitcnt lgkmcnt(0)
MZ 160,16,64
TR 20,53,16384
TR 22,53,17408
MZ 164,16,68
TR 24,54,16384
TR 26,54,17408
MZ 168,16,72
TR 28,55,16384
TR 30,55,17408
s_waitcnt lgkmcnt(4)
MZ 172,20,64
TR 32,56,16384
TR 34,56,17408
MZ 176,20,68
TR 16,57,16384
TR 18,57,17408
MZ 180,20,72
TR 20,58,16384
TR 22,58,17408
s_waitcnt lgkmcnt(8)
MZ 184,24,64
MZ 188,24,68
MZ 192,24,72
TR 24,59,16384
TR 26,59,17408
s_waitcnt lgkmcnt(8)
MZ 196,28,64
MZ 200,28,68
MZ 204,28,72
s_waitcnt lgkmcnt(6)
MZ 208,32,64
MZ 212,32,68
MZ 216,32,72
s_waitcnt lgkmcnt(4)
MZ 220,16,64
MZ 224,16,68
MZ 228,16,72
s_waitcnt lgkmcnt(2)
MZ 232,20,64
MZ 236,20,68
MZ 240,20,72
s_waitcnt lgkmcnt(0)
MZ 244,24,64
MZ 248,24,68
MZ 252,24,72
s_waitcnt vmcnt(7)
s_barrier
TR 28,52,24576
TR 30,52,25600
s_waitcnt lgkmcnt(0)
MA 160,28,76
TR 32,53,24576
TR 34,53,25600
MA 164,28,80
TR 16,54,24576
TR 18,54,25600
MA 168,28,84
TR 20,55,24576
TR 22,55,25600
s_waitcnt lgkmcnt(4)
MA 172,32,76
ds_read_b128 v[88:91], v60 offset:12288
ds_read_b128 v[100:103], v61 offset:12288
MA 176,32,80
TR 24,56,24576
TR 26,56,25600
MA 180,32,84
ds_read_b128 v[92:95], v60 offset:14336
ds_read_b128 v[104:107], v61 offset:14336
s_waitcnt lgkmcnt(8)
MA 184,16,76
TR 28,57,24576
TR 30,57,25600
MA 188,16,80
ds_read_b128 v[96:99], v60 offset:16384
ds_read_b128 v[108:111], v61 offset:16384
MA 192,16,84
TR 32,58,24576
TR 34,58,25600
s_waitcnt lgkmcnt(12)
MA 196,20,76
s_add_u32 m0, s61, 0
s_mov_b32 s66, 384
buffer_load_dwordx4 v1, s[40:43], s66 offen lds
TR 16,59,24576
TR 18,59,25600
MA 200,20,80
MA 204,20,84
TR 20,52,32768
TR 22,52,33792
s_waitcnt lgkmcnt(12)
MA 208,24,76
MA 212,24,80
MA 216,24,84
TR 24,53,32768
TR 26,53,33792
s_waitcnt lgkmcnt(10)
MA 220,28,76
MA 224,28,80
MA 228,28,84
TR 28,54,32768
TR 30,54,33792
s_waitcnt lgkmcnt(8)
MA 232,32,76
MA 236,32,80
s_add_u32 m0, s61, 4096
s_mov_b32 s66, 37248
buffer_load_dwordx4 v1, s[40:43], s66 offen lds
MA 240,32,84
TR 32,55,32768
TR 34,55,33792
s_waitcnt lgkmcnt(8)
MA 244,16,76
MA 248,16,80
MA 252,16,84
TR 16,56,32768
TR 18,56,33792
s_waitcnt vmcnt(2)
s_barrier
s_lshr_b32 s72, s2, 3
s_and_b32 s72, s72, 0
s_cmp_lg_u32 s72, 0
s_cbranch_scc1 L0i2
s_cmp_lg_u32 s62, 0
s_cbranch_scc1 L0i2
s_lshl_b32 s73, s86, 2
v_mov_b32 v41, s73
v_mov_b32 v42, 1
s_mov_b64 exec, 1
global_atomic_add v41, v42, s[84:85] offset:128 sc1
s_mov_b64 exec, -1
L0i2:
s_waitcnt lgkmcnt(8)
MA 160,20,88
s_add_u32 m0, s61, 8192
s_mov_b32 s66, 74112
buffer_load_dwordx4 v1, s[40:43], s66 offen lds
ds_read_b128 v[64:67], v60 offset:24576
ds_read_b128 v[76:79], v61 offset:24576
MA 164,20,92
MA 168,20,96
s_add_u32 m0, s61, 40960
s_mov_b32 s66, 1310720
buffer_load_dwordx4 v0, s[44:47], s66 offen nt lds
TR 20,57,32768
TR 22,57,33792
s_waitcnt lgkmcnt(10)
MA 172,24,88
ds_read_b128 v[68:71], v60 offset:26624
MA 176,24,92
s_add_u32 m0, s61, 45056
s_mov_b32 s66, 1441792
buffer_load_dwordx4 v0, s[44:47], s66 offen nt lds
ds_read_b128 v[80:83], v61 offset:26624
MA 180,24,96
TR 24,58,32768
TR 26,58,33792
s_waitcnt lgkmcnt(12)
MA 184,28,88
s_add_u32 m0, s61, 49152
s_mov_b32 s66, 1572864
buffer_load_dwordx4 v0, s[44:47], s66 offen nt lds
ds_read_b128 v[72:75], v60 offset:28672
ds_read_b128 v[84:87], v61 offset:28672
MA 188,28,92
MA 192,28,96
s_add_u32 m0, s61, 53248
s_mov_b32 s66, 1703936
buffer_load_dwordx4 v0, s[44:47], s66 offen nt lds
TR 28,59,32768
TR 30,59,33792
s_waitcnt lgkmcnt(14)
MA 196,32,88
MA 200,32,92
MA 204,32,96
TR 32,52,40960
TR 34,52,41984
s_waitcnt lgkmcnt(14)
MA 208,16,88
MA 212,16,92
MA 216,16,96
TR 16,53,40960
TR 18,53,41984
s_waitcnt lgkmcnt(12)
MA 220,20,88
MA 224,20,92
MA 228,20,96
TR 20,54,40960
TR 22,54,41984
s_waitcnt lgkmcnt(10)
MA 232,24,88
s_add_u32 m0, s61, 12288
s_mov_b32 s66, 512
buffer_load_dwordx4 v1, s[40:43], s66 offen lds
MA 236,24,92
MA 240,24,96
TR 24,55,40960
TR 26,55,41984
s_waitcnt lgkmcnt(8)
MA 244,28,88
MA 248,28,92
MA 252,28,96
TR 28,56,40960
TR 30,56,41984
s_waitcnt lgkmcnt(8)
MA 160,32,100
MA 164,32,104
MA 168,32,108
TR 32,57,40960
TR 34,57,41984
s_waitcnt lgkmcnt(8)
MA 172,16,100
MA 176,16,104
s_add_u32 m0, s61, 16384
s_mov_b32 s66, 37376
buffer_load_dwordx4 v1, s[40:43], s66 offen lds
MA 180,16,108
TR 16,58,40960
TR 18,58,41984
s_waitcnt lgkmcnt(8)
MA 184,20,100
MA 188,20,104
MA 192,20,108
TR 20,59,40960
TR 22,59,41984
s_waitcnt lgkmcnt(8)
MA 196,24,100
MA 200,24,104
MA 204,24,108
TR 24,52,49152
TR 26,52,50176
s_waitcnt lgkmcnt(8)
MA 208,28,100
MA 212,28,104
MA 216,28,108
s_add_u32 m0, s61, 20480
s_mov_b32 s66, 74240
buffer_load_dwordx4 v1, s[40:43], s66 offen lds
TR 28,53,49152
TR 30,53,50176
s_waitcnt lgkmcnt(8)
MA 220,32,100
MA 224,32,104
MA 228,32,108
TR 32,54,49152
TR 34,54,50176
s_waitcnt lgkmcnt(8)
MA 232,16,100
MA 236,16,104
MA 240,16,108
TR 16,55,49152
TR 18,55,50176
s_waitcnt lgkmcnt(8)
MA 244,20,100
MA 248,20,104
MA 252,20,108
TR 20,56,49152
TR 22,56,50176
s_waitcnt vmcnt(3)
s_barrier
s_waitcnt lgkmcnt(8)
MA 160,24,64
ds_read_b128 v[88:91], v60 offset:0
ds_read_b128 v[100:103], v61 offset:0
MA 164,24,68
s_add_u32 m0, s61, 57344
s_mov_b32 s66, 1835008
buffer_load_dwordx4 v0, s[44:47], s66 offen nt lds
MA 168,24,72
TR 24,57,49152
TR 26,57,50176
s_waitcnt lgkmcnt(10)
MA 172,28,64
s_add_u32 m0, s61, 61440
s_mov_b32 s66, 1966080
buffer_load_dwordx4 v0, s[44:47], s66 offen nt lds
ds_read_b128 v[92:95], v60 offset:2048
ds_read_b128 v[104:107], v61 offset:2048
MA 176,28,68
MA 180,28,72
s_add_u32 m0, s61, 65536
s_mov_b32 s66, 2097152
buffer_load_dwordx4 v0, s[44:47], s66 offen nt lds
TR 28,58,49152
TR 30,58,50176
s_waitcnt lgkmcnt(12)
MA 184,32,64
ds_read_b128 v[96:99], v60 offset:4096
ds_read_b128 v[108:111], v61 offset:4096
MA 188,32,68
s_add_u32 m0, s61, 69632
s_mov_b32 s66, 2228224
buffer_load_dwordx4 v0, s[44:47], s66 offen nt lds
MA 192,32,72
TR 32,59,49152
TR 34,59,50176
s_waitcnt lgkmcnt(14)
MA 196,16,64
MA 200,16,68
MA 204,16,72
TR 16,52,16384
TR 18,52,17408
s_waitcnt lgkmcnt(14)
MA 208,20,64
MA 212,20,68
MA 216,20,72
TR 20,53,16384
TR 22,53,17408
s_waitcnt lgkmcnt(12)
MA 220,24,64
MA 224,24,68
MA 228,24,72
s_add_u32 m0, s61, 24576
s_mov_b32 s66, 640
buffer_load_dwordx4 v1, s[40:43], s66 offen lds
TR 24,54,16384
TR 26,54,17408
s_add_u32 m0, s61, 36864
s_mul_i32 s72, s79, 18432
s_add_u32 s72, s72, 0
buffer_load_dwordx4 v3, s[24:27], s72 offen lds
s_waitcnt lgkmcnt(10)
MA 232,28,64
MA 236,28,68
MA 240,28,72
TR 28,55,16384
TR 30,55,17408
s_waitcnt lgkmcnt(8)
MA 244,32,64
MA 248,32,68
MA 252,32,72
TR 32,56,16384
TR 34,56,17408
s_waitcnt lgkmcnt(8)
MA 160,16,76
MA 164,16,80
MA 168,16,84
TR 16,57,16384
TR 18,57,17408
s_waitcnt lgkmcnt(8)
MA 172,20,76
s_add_u32 m0, s61, 28672
s_mov_b32 s66, 37504
buffer_load_dwordx4 v1, s[40:43], s66 offen lds
MA 176,20,80
MA 180,20,84
TR 20,58,16384
TR 22,58,17408
s_waitcnt lgkmcnt(8)
MA 184,24,76
MA 188,24,80
MA 192,24,84
TR 24,59,16384
TR 26,59,17408
s_waitcnt lgkmcnt(8)
MA 196,28,76
MA 200,28,80
MA 204,28,84
TR 28,52,24576
TR 30,52,25600
s_waitcnt lgkmcnt(8)
MA 208,32,76
MA 212,32,80
s_add_u32 m0, s61, 32768
s_mov_b32 s66, 74368
buffer_load_dwordx4 v1, s[40:43], s66 offen lds
MA 216,32,84
TR 32,53,24576
TR 34,53,25600
s_waitcnt lgkmcnt(8)
MA 220,16,76
MA 224,16,80
MA 228,16,84
TR 16,54,24576
TR 18,54,25600
s_waitcnt lgkmcnt(8)
MA 232,20,76
MA 236,20,80
MA 240,20,84
TR 20,55,24576
TR 22,55,25600
s_waitcnt lgkmcnt(8)
MA 244,24,76
MA 248,24,80
MA 252,24,84
TR 24,56,24576
TR 26,56,25600
s_waitcnt vmcnt(3)
s_barrier
s_waitcnt lgkmcnt(8)
MA 160,28,88
ds_read_b128 v[64:67], v60 offset:12288
ds_read_b128 v[76:79], v61 offset:12288
MA 164,28,92
s_add_u32 m0, s61, 40960
s_mov_b32 s66, 2359296
buffer_load_dwordx4 v0, s[44:47], s66 offen nt lds
MA 168,28,96
TR 28,57,24576
TR 30,57,25600
s_waitcnt lgkmcnt(10)
MA 172,32,88
s_add_u32 m0, s61, 45056
s_mov_b32 s66, 2490368
buffer_load_dwordx4 v0, s[44:47], s66 offen nt lds
ds_read_b128 v[68:71], v60 offset:14336
ds_read_b128 v[80:83], v61 offset:14336
MA 176,32,92
MA 180,32,96
s_add_u32 m0, s61, 73728
s_mov_b32 s66, 2621440
buffer_load_dwordx4 v0, s[44:47], s66 offen nt lds
TR 32,58,24576
TR 34,58,25600
s_waitcnt lgkmcnt(12)
MA 184,16,88
ds_read_b128 v[72:75], v60 offset:16384
ds_read_b128 v[84:87], v61 offset:16384
MA 188,16,92
s_add_u32 m0, s61, 77824
s_mov_b32 s66, 2752512
buffer_load_dwordx4 v0, s[44:47], s66 offen nt lds
MA 192,16,96
TR 16,59,24576
TR 18,59,25600
s_waitcnt lgkmcnt(14)
MA 196,20,88
MA 200,20,92
MA 204,20,96
TR 20,52,32768
TR 22,52,33792
s_waitcnt lgkmcnt(14)
MA 208,24,88
MA 212,24,92
MA 216,24,96
TR 24,53,32768
TR 26,53,33792
s_waitcnt lgkmcnt(12)
MA 220,28,88
MA 224,28,92
MA 228,28,96
s_add_u32 m0, s61, 0
s_mov_b32 s66, 768
buffer_load_dwordx4 v1, s[40:43], s66 offen lds
TR 28,54,32768
TR 30,54,33792
s_add_u32 m0, s61, 36864
s_mul_i32 s72, s79, 18432
s_add_u32 s72, s72, 4096
buffer_load_dwordx4 v3, s[24:27], s72 offen lds
s_waitcnt lgkmcnt(10)
MA 232,32,88
MA 236,32,92
MA 240,32,96
TR 32,55,32768
TR 34,55,33792
s_waitcnt lgkmcnt(8)
MA 244,16,88
MA 248,16,92
MA 252,16,96
TR 16,56,32768
TR 18,56,33792
s_waitcnt lgkmcnt(8)
MA 160,20,100
MA 164,20,104
MA 168,20,108
TR 20,57,32768
TR 22,57,33792
s_waitcnt lgkmcnt(8)
MA 172,24,100
s_add_u32 m0, s61, 4096
s_mov_b32 s66, 37632
buffer_load_dwordx4 v1, s[40:43], s66 offen lds
MA 176,24,104
MA 180,24,108
TR 24,58,32768
TR 26,58,33792
s_waitcnt lgkmcnt(8)
MA 184,28,100
MA 188,28,104
MA 192,28,108
TR 28,59,32768
TR 30,59,33792
s_waitcnt lgkmcnt(8)
MA 196,32,100
MA 200,32,104
MA 204,32,108
TR 32,52,40960
TR 34,52,41984
s_waitcnt lgkmcnt(8)
MA 208,16,100
MA 212,16,104
s_add_u32 m0, s61, 8192
s_mov_b32 s66, 74496
buffer_load_dwordx4 v1, s[40:43], s66 offen lds
MA 216,16,108
TR 16,53,40960
TR 18,53,41984
s_waitcnt lgkmcnt(8)
MA 220,20,100
MA 224,20,104
MA 228,20,108
TR 20,54,40960
TR 22,54,41984
s_waitcnt lgkmcnt(8)
MA 232,24,100
MA 236,24,104
MA 240,24,108
TR 24,55,40960
TR 26,55,41984
s_waitcnt lgkmcnt(8)
MA 244,28,100
MA 248,28,104
MA 252,28,108
TR 28,56,40960
TR 30,56,41984
s_waitcnt vmcnt(3)
s_barrier
s_waitcnt lgkmcnt(8)
MA 160,32,64
ds_read_b128 v[88:91], v60 offset:24576
ds_read_b128 v[100:103], v61 offset:24576
MA 164,32,68
s_add_u32 m0, s61, 49152
s_mov_b32 s66, 2883584
buffer_load_dwordx4 v0, s[44:47], s66 offen nt lds
MA 168,32,72
TR 32,57,40960
TR 34,57,41984
s_waitcnt lgkmcnt(10)
MA 172,16,64
s_add_u32 m0, s61, 53248
s_mov_b32 s66, 3014656
buffer_load_dwordx4 v0, s[44:47], s66 offen nt lds
ds_read_b128 v[92:95], v60 offset:26624
ds_read_b128 v[104:107], v61 offset:26624
MA 176,16,68
MA 180,16,72
s_add_u32 m0, s61, 57344
s_mov_b32 s66, 3145728
buffer_load_dwordx4 v0, s[44:47], s66 offen nt lds
TR 16,58,40960
TR 18,58,41984
s_waitcnt lgkmcnt(12)
MA 184,20,64
ds_read_b128 v[96:99], v60 offset:28672
ds_read_b128 v[108:111], v61 offset:28672
MA 188,20,68
s_add_u32 m0, s61, 61440
s_mov_b32 s66, 3276800
buffer_load_dwordx4 v0, s[44:47], s66 offen nt lds
MA 192,20,72
TR 20,59,40960
TR 22,59,41984
s_waitcnt lgkmcnt(14)
MA 196,24,64
MA 200,24,68
MA 204,24,72
TR 24,52,16384
TR 26,52,17408
s_waitcnt lgkmcnt(14)
MA 208,28,64
MA 212,28,68
MA 216,28,72
TR 28,53,16384
TR 30,53,17408
s_waitcnt lgkmcnt(12)
MA 220,32,64
MA 224,32,68
MA 228,32,72
s_add_u32 m0, s61, 12288
s_mov_b32 s66, 896
buffer_load_dwordx4 v1, s[40:43], s66 offen lds
TR 32,54,16384
TR 34,54,17408
s_add_u32 m0, s61, 36864
s_mul_i32 s72, s79, 18432
s_add_u32 s72, s72, 8192
buffer_load_dwordx4 v3, s[24:27], s72 offen lds
s_waitcnt lgkmcnt(10)
MA 232,16,64
MA 236,16,68
MA 240,16,72
TR 16,55,16384
TR 18,55,17408
s_waitcnt lgkmcnt(8)
MA 244,20,64
MA 248,20,68
MA 252,20,72
TR 20,56,16384
TR 22,56,17408
s_waitcnt lgkmcnt(8)
MA 160,24,76
MA 164,24,80
MA 168,24,84
TR 24,57,16384
TR 26,57,17408
s_waitcnt lgkmcnt(8)
MA 172,28,76
s_add_u32 m0, s61, 16384
s_mov_b32 s66, 37760
buffer_load_dwordx4 v1, s[40:43], s66 offen lds
MA 176,28,80
MA 180,28,84
TR 28,58,16384
TR 30,58,17408
s_waitcnt lgkmcnt(8)
MA 184,32,76
MA 188,32,80
MA 192,32,84
TR 32,59,16384
TR 34,59,17408
s_waitcnt lgkmcnt(8)
MA 196,16,76
MA 200,16,80
MA 204,16,84
TR 16,52,49152
TR 18,52,50176
s_waitcnt lgkmcnt(8)
MA 208,20,76
MA 212,20,80
s_add_u32 m0, s61, 20480
s_mov_b32 s66, 74624
buffer_load_dwordx4 v1, s[40:43], s66 offen lds
MA 216,20,84
TR 20,53,49152
TR 22,53,50176
s_waitcnt lgkmcnt(8)
MA 220,24,76
MA 224,24,80
MA 228,24,84
TR 24,54,49152
TR 26,54,50176
s_waitcnt lgkmcnt(8)
MA 232,28,76
MA 236,28,80
MA 240,28,84
TR 28,55,49152
TR 30,55,50176
s_waitcnt lgkmcnt(8)
MA 244,32,76
MA 248,32,80
MA 252,32,84
TR 32,56,49152
TR 34,56,50176
s_waitcnt vmcnt(3)
s_barrier
s_waitcnt lgkmcnt(8)
MA 160,16,88
ds_read_b128 v[64:67], v60 offset:0
ds_read_b128 v[76:79], v61 offset:0
MA 164,16,92
s_add_u32 m0, s61, 40960
s_mov_b32 s66, 3407872
buffer_load_dwordx4 v0, s[44:47], s66 offen nt lds
MA 168,16,96
TR 16,57,49152
TR 18,57,50176
s_waitcnt lgkmcnt(10)
MA 172,20,88
s_add_u32 m0, s61, 45056
s_mov_b32 s66, 3538944
buffer_load_dwordx4 v0, s[44:47], s66 offen nt lds
ds_read_b128 v[68:71], v60 offset:2048
ds_read_b128 v[80:83], v61 offset:2048
MA 176,20,92
MA 180,20,96
s_add_u32 m0, s61, 65536
s_mov_b32 s66, 3670016
buffer_load_dwordx4 v0, s[44:47], s66 offen nt lds
TR 20,58,49152
TR 22,58,50176
s_waitcnt lgkmcnt(12)
MA 184,24,88
ds_read_b128 v[72:75], v60 offset:4096
ds_read_b128 v[84:87], v61 offset:4096
MA 188,24,92
s_add_u32 m0, s61, 69632
s_mov_b32 s66, 3801088
buffer_load_dwordx4 v0, s[44:47], s66 offen nt lds
MA 192,24,96
TR 24,59,49152
TR 26,59,50176
s_waitcnt lgkmcnt(14)
MA 196,28,88
MA 200,28,92
MA 204,28,96
TR 28,52,24576
TR 30,52,25600
s_waitcnt lgkmcnt(14)
MA 208,32,88
MA 212,32,92
MA 216,32,96
TR 32,53,24576
TR 34,53,25600
s_waitcnt lgkmcnt(12)
MA 220,16,88
MA 224,16,92
MA 228,16,96
s_add_u32 m0, s61, 24576
s_mov_b32 s66, 1024
buffer_load_dwordx4 v1, s[40:43], s66 offen lds
TR 16,54,24576
TR 18,54,25600
s_add_u32 m0, s61, 36864
s_mul_i32 s72, s79, 18432
s_add_u32 s72, s72, 12288
buffer_load_dwordx4 v3, s[24:27], s72 offen lds
s_waitcnt lgkmcnt(10)
MA 232,20,88
MA 236,20,92
MA 240,20,96
TR 20,55,24576
TR 22,55,25600
s_waitcnt lgkmcnt(8)
MA 244,24,88
MA 248,24,92
MA 252,24,96
TR 24,56,24576
TR 26,56,25600
s_waitcnt lgkmcnt(8)
MA 160,28,100
MA 164,28,104
MA 168,28,108
TR 28,57,24576
TR 30,57,25600
s_waitcnt lgkmcnt(8)
MA 172,32,100
s_add_u32 m0, s61, 28672
s_mov_b32 s66, 37888
buffer_load_dwordx4 v1, s[40:43], s66 offen lds
MA 176,32,104
MA 180,32,108
TR 32,58,24576
TR 34,58,25600
s_waitcnt lgkmcnt(8)
MA 184,16,100
MA 188,16,104
MA 192,16,108
TR 16,59,24576
TR 18,59,25600
s_waitcnt lgkmcnt(8)
MA 196,20,100
MA 200,20,104
MA 204,20,108
TR 20,52,32768
TR 22,52,33792
s_waitcnt lgkmcnt(8)
MA 208,24,100
MA 212,24,104
s_add_u32 m0, s61, 32768
s_mov_b32 s66, 74752
buffer_load_dwordx4 v1, s[40:43], s66 offen lds
MA 216,24,108
TR 24,53,32768
TR 26,53,33792
s_waitcnt lgkmcnt(8)
MA 220,28,100
MA 224,28,104
MA 228,28,108
TR 28,54,32768
TR 30,54,33792
s_waitcnt lgkmcnt(8)
MA 232,32,100
MA 236,32,104
MA 240,32,108
TR 32,55,32768
TR 34,55,33792
s_waitcnt lgkmcnt(8)
MA 244,16,100
MA 248,16,104
MA 252,16,108
TR 16,56,32768
TR 18,56,33792
s_waitcnt vmcnt(3)
s_barrier
s_waitcnt lgkmcnt(8)
MA 160,20,64
ds_read_b128 v[88:91], v60 offset:12288
ds_read_b128 v[100:103], v61 offset:12288
MA 164,20,68
s_add_u32 m0, s61, 49152
s_mov_b32 s66, 3932160
buffer_load_dwordx4 v0, s[44:47], s66 offen nt lds
MA 168,20,72
TR 20,57,32768
TR 22,57,33792
s_waitcnt lgkmcnt(10)
MA 172,24,64
s_add_u32 m0, s61, 53248
s_mov_b32 s66, 4063232
buffer_load_dwordx4 v0, s[44:47], s66 offen nt lds
ds_read_b128 v[92:95], v60 offset:14336
ds_read_b128 v[104:107], v61 offset:14336
MA 176,24,68
MA 180,24,72
s_add_u32 m0, s61, 73728
s_mov_b32 s66, 4194304
buffer_load_dwordx4 v0, s[44:47], s66 offen nt lds
TR 24,58,32768
TR 26,58,33792
s_waitcnt lgkmcnt(12)
MA 184,28,64
ds_read_b128 v[96:99], v60 offset:16384
ds_read_b128 v[108:111], v61 offset:16384
MA 188,28,68
s_add_u32 m0, s61, 77824
s_mov_b32 s66, 4325376
buffer_load_dwordx4 v0, s[44:47], s66 offen nt lds
MA 192,28,72
TR 28,59,32768
TR 30,59,33792
s_waitcnt lgkmcnt(14)
MA 196,32,64
MA 200,32,68
MA 204,32,72
TR 32,52,16384
TR 34,52,17408
s_waitcnt lgkmcnt(14)
MA 208,16,64
MA 212,16,68
MA 216,16,72
TR 16,53,16384
TR 18,53,17408
s_waitcnt lgkmcnt(12)
MA 220,20,64
MA 224,20,68
MA 228,20,72
TR 20,54,16384
TR 22,54,17408
s_add_u32 m0, s61, 36864
s_mul_i32 s72, s79, 18432
s_add_u32 s72, s72, 16384
buffer_load_dwordx4 v3, s[24:27], s72 offen lds
s_waitcnt lgkmcnt(10)
MA 232,24,64
MA 236,24,68
s_add_u32 m0, s61, 0
s_add_u32 s66, s98, 0
s_and_b32 s66, s66, 0x1ffff
buffer_load_dwordx4 v3, s[48:51], s66 offen nt lds
MA 240,24,72
TR 24,55,16384
TR 26,55,17408
s_waitcnt lgkmcnt(8)
MA 244,28,64
MA 248,28,68
MA 252,28,72
TR 28,56,16384
TR 30,56,17408
s_waitcnt lgkmcnt(8)
MA 160,32,76
MA 164,32,80
MA 168,32,84
TR 32,57,16384
TR 34,57,17408
s_waitcnt lgkmcnt(8)
MA 172,16,76
MA 176,16,80
MA 180,16,84
TR 16,58,16384
TR 18,58,17408
s_waitcnt lgkmcnt(8)
MA 184,20,76
MA 188,20,80
s_add_u32 m0, s61, 4096
s_add_u32 s66, s98, 4096
s_and_b32 s66, s66, 0x1ffff
buffer_load_dwordx4 v3, s[48:51], s66 offen nt lds
MA 192,20,84
TR 20,59,16384
TR 22,59,17408
s_waitcnt lgkmcnt(8)
MA 196,24,76
MA 200,24,80
MA 204,24,84
TR 24,52,40960
TR 26,52,41984
s_waitcnt lgkmcnt(8)
MA 208,28,76
MA 212,28,80
MA 216,28,84
TR 28,53,40960
TR 30,53,41984
s_waitcnt lgkmcnt(8)
MA 220,32,76
MA 224,32,80
MA 228,32,84
TR 32,54,40960
TR 34,54,41984
s_waitcnt lgkmcnt(8)
MA 232,16,76
MA 236,16,80
MA 240,16,84
TR 16,55,40960
TR 18,55,41984
s_waitcnt lgkmcnt(8)
MA 244,20,76
MA 248,20,80
MA 252,20,84
TR 20,56,40960
TR 22,56,41984
s_waitcnt vmcnt(2)
s_barrier
s_waitcnt lgkmcnt(8)
MA 160,24,88
ds_read_b128 v[64:67], v60 offset:24576
ds_read_b128 v[76:79], v61 offset:24576
MA 164,24,92
s_add_u32 m0, s61, 40960
s_mov_b32 s66, 4456448
buffer_load_dwordx4 v0, s[44:47], s66 offen nt lds
MA 168,24,96
TR 24,57,40960
TR 26,57,41984
s_waitcnt lgkmcnt(10)
MA 172,28,88
s_add_u32 m0, s61, 45056
s_mov_b32 s66, 4587520
buffer_load_dwordx4 v0, s[44:47], s66 offen nt lds
ds_read_b128 v[68:71], v60 offset:26624
ds_read_b128 v[80:83], v61 offset:26624
MA 176,28,92
MA 180,28,96
TR 28,58,40960
TR 30,58,41984
s_waitcnt lgkmcnt(12)
MA 184,32,88
ds_read_b128 v[72:75], v60 offset:28672
ds_read_b128 v[84:87], v61 offset:28672
MA 188,32,92
MA 192,32,96
TR 32,59,40960
TR 34,59,41984
s_waitcnt lgkmcnt(14)
MA 196,16,88
MA 200,16,92
MA 204,16,96
TR 16,52,24576
TR 18,52,25600
s_waitcnt lgkmcnt(14)
MA 208,20,88
MA 212,20,92
MA 216,20,96
TR 20,53,24576
TR 22,53,25600
s_waitcnt lgkmcnt(12)
MA 220,24,88
s_add_u32 m0, s61, 8192
s_add_u32 s66, s98, 8192
s_and_b32 s66, s66, 0x1ffff
buffer_load_dwordx4 v3, s[48:51], s66 offen nt lds
MA 224,24,92
MA 228,24,96
TR 24,54,24576
TR 26,54,25600
s_waitcnt lgkmcnt(10)
MA 232,28,88
MA 236,28,92
MA 240,28,96
TR 28,55,24576
TR 30,55,25600
s_waitcnt lgkmcnt(8)
MA 244,32,88
MA 248,32,92
MA 252,32,96
TR 32,56,24576
TR 34,56,25600
s_waitcnt lgkmcnt(8)
MA 160,16,100
MA 164,16,104
MA 168,16,108
TR 16,57,24576
TR 18,57,25600
s_waitcnt lgkmcnt(8)
MA 172,20,100
s_add_u32 m0, s61, 12288
s_add_u32 s66, s98, 12288
s_and_b32 s66, s66, 0x1ffff
buffer_load_dwordx4 v3, s[48:51], s66 offen nt lds
MA 176,20,104
MA 180,20,108
TR 20,58,24576
TR 22,58,25600
s_waitcnt lgkmcnt(8)
MA 184,24,100
MA 188,24,104
MA 192,24,108
TR 24,59,24576
TR 26,59,25600
s_waitcnt lgkmcnt(8)
MA 196,28,100
MA 200,28,104
MA 204,28,108
TR 28,52,49152
TR 30,52,50176
s_waitcnt lgkmcnt(8)
MA 208,32,100
MA 212,32,104
MA 216,32,108
TR 32,53,49152
TR 34,53,50176
s_waitcnt lgkmcnt(8)
MA 220,16,100
s_add_u32 m0, s61, 57344
s_add_u32 s66, s98, 0
s_and_b32 s66, s66, 0x1ffff
buffer_load_dwordx4 v2, s[52:55], s66 offen nt lds
MA 224,16,104
MA 228,16,108
TR 16,54,49152
TR 18,54,50176
s_waitcnt lgkmcnt(8)
MA 232,20,100
MA 236,20,104
MA 240,20,108
TR 20,55,49152
TR 22,55,50176
s_waitcnt lgkmcnt(8)
MA 244,24,100
MA 248,24,104
MA 252,24,108
TR 24,56,49152
TR 26,56,50176
s_waitcnt vmcnt(3)
s_barrier
s_waitcnt lgkmcnt(8)
MA 160,28,64
s_add_u32 m0, s61, 61440
s_add_u32 s66, s98, 4096
s_and_b32 s66, s66, 0x1ffff
buffer_load_dwordx4 v2, s[52:55], s66 offen nt lds
MA 164,28,68
MA 168,28,72
TR 28,57,49152
TR 30,57,50176
s_waitcnt lgkmcnt(8)
MA 172,32,64
MA 176,32,68
MA 180,32,72
TR 32,58,49152
TR 34,58,50176
s_waitcnt lgkmcnt(8)
MA 184,16,64
MA 188,16,68
MA 192,16,72
TR 16,59,49152
TR 18,59,50176
s_waitcnt lgkmcnt(8)
MA 196,20,64
MA 200,20,68
MA 204,20,72
TR 20,52,16384
TR 22,52,17408
s_waitcnt lgkmcnt(8)
MA 208,24,64
s_add_u32 m0, s61, 16384
s_add_u32 s66, s98, 16384
s_and_b32 s66, s66, 0x1ffff
buffer_load_dwordx4 v3, s[48:51], s66 offen nt lds
MA 212,24,68
MA 216,24,72
TR 24,53,16384
TR 26,53,17408
s_waitcnt lgkmcnt(8)
MA 220,28,64
MA 224,28,68
MA 228,28,72
TR 28,54,16384
TR 30,54,17408
s_waitcnt lgkmcnt(8)
MA 232,32,64
MA 236,32,68
MA 240,32,72
TR 32,55,16384
TR 34,55,17408
s_waitcnt lgkmcnt(8)
MA 244,16,64
MA 248,16,68
MA 252,16,72
TR 16,56,16384
TR 18,56,17408
s_waitcnt lgkmcnt(8)
MA 160,20,76
s_add_u32 m0, s61, 20480
s_add_u32 s66, s98, 20480
s_and_b32 s66, s66, 0x1ffff
buffer_load_dwordx4 v3, s[48:51], s66 offen nt lds
MA 164,20,80
MA 168,20,84
TR 20,57,16384
TR 22,57,17408
s_waitcnt lgkmcnt(8)
MA 172,24,76
MA 176,24,80
MA 180,24,84
TR 24,58,16384
v_pk_mul_f32 v[160:161], v[160:161], s[68:69]
TR 26,58,17408
v_pk_mul_f32 v[162:163], v[162:163], s[68:69]
s_waitcnt lgkmcnt(8)
MA 184,28,76
v_pk_mul_f32 v[172:173], v[172:173], s[68:69]
v_pk_mul_f32 v[174:175], v[174:175], s[68:69]
v_cvt_pk_bf16_f32 v112, v160, v161
MA 188,28,80
v_cvt_pk_bf16_f32 v113, v162, v163
v_cvt_pk_bf16_f32 v114, v172, v173
v_cvt_pk_bf16_f32 v115, v174, v175
MA 192,28,84
TR 28,59,16384
v_pk_mul_f32 v[164:165], v[164:165], s[68:69]
TR 30,59,17408
v_pk_mul_f32 v[166:167], v[166:167], s[68:69]
v_pk_mul_f32 v[176:177], v[176:177], s[68:69]
s_waitcnt lgkmcnt(8)
MA 196,32,76
v_pk_mul_f32 v[178:179], v[178:179], s[68:69]
v_cvt_pk_bf16_f32 v128, v164, v165
v_cvt_pk_bf16_f32 v129, v166, v167
MA 200,32,80
v_cvt_pk_bf16_f32 v130, v176, v177
v_cvt_pk_bf16_f32 v131, v178, v179
v_pk_mul_f32 v[168:169], v[168:169], s[68:69]
MA 204,32,84
ds_read_b128 v[32:35], v4 offset:0
v_pk_mul_f32 v[170:171], v[170:171], s[68:69]
v_pk_mul_f32 v[180:181], v[180:181], s[68:69]
v_pk_mul_f32 v[182:183], v[182:183], s[68:69]
s_waitcnt lgkmcnt(7)
MA 208,16,76
s_add_u32 m0, s61, 49152
s_add_u32 s66, s98, 8192
s_and_b32 s66, s66, 0x1ffff
buffer_load_dwordx4 v2, s[52:55], s66 offen nt lds
v_cvt_pk_bf16_f32 v144, v168, v169
v_cvt_pk_bf16_f32 v145, v170, v171
v_cvt_pk_bf16_f32 v146, v180, v181
MA 212,16,80
v_cvt_pk_bf16_f32 v147, v182, v183
v_permlane32_swap_b32 v112, v114
v_permlane32_swap_b32 v113, v115
MA 216,16,84
ds_read_b128 v[16:19], v4 offset:4096
v_permlane32_swap_b32 v128, v130
v_permlane32_swap_b32 v129, v131
v_permlane32_swap_b32 v144, v146
s_waitcnt lgkmcnt(6)
MA 220,20,76
v_permlane32_swap_b32 v145, v147
v_permlane16_swap_b32 v112, v114
v_permlane16_swap_b32 v113, v115
MA 224,20,80
v_permlane16_swap_b32 v128, v130
v_permlane16_swap_b32 v129, v131
v_permlane16_swap_b32 v144, v146
MA 228,20,84
ds_read_b128 v[20:23], v5 offset:0
v_permlane16_swap_b32 v145, v147
v_pk_mul_f32 v[184:185], v[184:185], s[68:69]
v_pk_mul_f32 v[186:187], v[186:187], s[68:69]
s_waitcnt lgkmcnt(5)
MA 232,24,76
v_pk_mul_f32 v[196:197], v[196:197], s[68:69]
v_pk_mul_f32 v[198:199], v[198:199], s[68:69]
v_cvt_pk_bf16_f32 v116, v184, v185
MA 236,24,80
v_cvt_pk_bf16_f32 v117, v186, v187
v_cvt_pk_bf16_f32 v118, v196, v197
v_cvt_pk_bf16_f32 v119, v198, v199
MA 240,24,84
ds_read_b128 v[24:27], v5 offset:4096
v_pk_mul_f32 v[188:189], v[188:189], s[68:69]
v_pk_mul_f32 v[190:191], v[190:191], s[68:69]
v_pk_mul_f32 v[200:201], v[200:201], s[68:69]
s_waitcnt lgkmcnt(4)
MA 244,28,76
v_pk_mul_f32 v[202:203], v[202:203], s[68:69]
v_cvt_pk_bf16_f32 v132, v188, v189
v_cvt_pk_bf16_f32 v133, v190, v191
MA 248,28,80
v_cvt_pk_bf16_f32 v134, v200, v201
v_cvt_pk_bf16_f32 v135, v202, v203
v_pk_mul_f32 v[192:193], v[192:193], s[68:69]
MA 252,28,84
ds_read_b128 v[28:31], v6 offset:0
v_pk_mul_f32 v[194:195], v[194:195], s[68:69]
v_pk_mul_f32 v[204:205], v[204:205], s[68:69]
v_pk_mul_f32 v[206:207], v[206:207], s[68:69]
s_waitcnt vmcnt(3)
s_barrier
s_waitcnt lgkmcnt(4)
MZ 64,32,112
s_add_u32 m0, s61, 53248
s_add_u32 s66, s98, 12288
s_and_b32 s66, s66, 0x1ffff
buffer_load_dwordx4 v2, s[52:55], s66 offen nt lds
v_cvt_pk_bf16_f32 v148, v192, v193
v_cvt_pk_bf16_f32 v149, v194, v195
v_cvt_pk_bf16_f32 v150, v204, v205
MZ 68,32,128
v_cvt_pk_bf16_f32 v151, v206, v207
v_permlane32_swap_b32 v116, v118
v_permlane32_swap_b32 v117, v119
MZ 72,32,144
ds_read_b128 v[32:35], v6 offset:4096
v_permlane32_swap_b32 v132, v134
v_permlane32_swap_b32 v133, v135
v_permlane32_swap_b32 v148, v150
s_waitcnt lgkmcnt(4)
MZ 76,16,112
v_permlane32_swap_b32 v149, v151
v_permlane16_swap_b32 v116, v118
v_permlane16_swap_b32 v117, v119
MZ 80,16,128
v_permlane16_swap_b32 v132, v134
v_permlane16_swap_b32 v133, v135
v_permlane16_swap_b32 v148, v150
MZ 84,16,144
ds_read_b128 v[16:19], v7 offset:0
v_permlane16_swap_b32 v149, v151
v_pk_mul_f32 v[208:209], v[208:209], s[68:69]
v_pk_mul_f32 v[210:211], v[210:211], s[68:69]
s_waitcnt lgkmcnt(4)
MA 64,20,116
v_pk_mul_f32 v[220:221], v[220:221], s[68:69]
v_pk_mul_f32 v[222:223], v[222:223], s[68:69]
v_cvt_pk_bf16_f32 v120, v208, v209
MA 68,20,132
v_cvt_pk_bf16_f32 v121, v210, v211
v_cvt_pk_bf16_f32 v122, v220, v221
v_cvt_pk_bf16_f32 v123, v222, v223
MA 72,20,148
ds_read_b128 v[20:23], v7 offset:4096
v_pk_mul_f32 v[212:213], v[212:213], s[68:69]
v_pk_mul_f32 v[214:215], v[214:215], s[68:69]
v_pk_mul_f32 v[224:225], v[224:225], s[68:69]
s_waitcnt lgkmcnt(4)
MA 76,24,116
v_pk_mul_f32 v[226:227], v[226:227], s[68:69]
v_cvt_pk_bf16_f32 v136, v212, v213
v_cvt_pk_bf16_f32 v137, v214, v215
MA 80,24,132
v_cvt_pk_bf16_f32 v138, v224, v225
v_cvt_pk_bf16_f32 v139, v226, v227
v_pk_mul_f32 v[216:217], v[216:217], s[68:69]
MA 84,24,148
ds_read_b128 v[24:27], v4 offset:8192
v_pk_mul_f32 v[218:219], v[218:219], s[68:69]
v_pk_mul_f32 v[228:229], v[228:229], s[68:69]
v_pk_mul_f32 v[230:231], v[230:231], s[68:69]
v_cvt_pk_bf16_f32 v152, v216, v217
v_cvt_pk_bf16_f32 v153, v218, v219
v_cvt_pk_bf16_f32 v154, v228, v229
v_cvt_pk_bf16_f32 v155, v230, v231
v_permlane32_swap_b32 v120, v122
v_permlane32_swap_b32 v121, v123
v_permlane32_swap_b32 v136, v138
v_permlane32_swap_b32 v137, v139
v_permlane32_swap_b32 v152, v154
v_permlane32_swap_b32 v153, v155
v_permlane16_swap_b32 v120, v122
v_permlane16_swap_b32 v121, v123
v_permlane16_swap_b32 v136, v138
v_permlane16_swap_b32 v137, v139
v_permlane16_swap_b32 v152, v154
v_permlane16_swap_b32 v153, v155
s_waitcnt lgkmcnt(4)
MA 64,28,120
s_add_u32 m0, s61, 24576
s_add_u32 s66, s98, 24576
s_waitcnt vmcnt(2)
s_and_b32 s66, s66, 0x1ffff
buffer_load_dwordx4 v3, s[48:51], s66 offen nt lds
v_pk_mul_f32 v[232:233], v[232:233], s[68:69]
v_pk_mul_f32 v[234:235], v[234:235], s[68:69]
v_pk_mul_f32 v[244:245], v[244:245], s[68:69]
MA 68,28,136
v_pk_mul_f32 v[246:247], v[246:247], s[68:69]
v_cvt_pk_bf16_f32 v124, v232, v233
v_cvt_pk_bf16_f32 v125, v234, v235
MA 72,28,152
ds_read_b128 v[28:31], v5 offset:8192
v_cvt_pk_bf16_f32 v126, v244, v245
v_cvt_pk_bf16_f32 v127, v246, v247
v_pk_mul_f32 v[236:237], v[236:237], s[68:69]
s_waitcnt lgkmcnt(4)
MA 76,32,120
v_pk_mul_f32 v[238:239], v[238:239], s[68:69]
v_pk_mul_f32 v[248:249], v[248:249], s[68:69]
v_pk_mul_f32 v[250:251], v[250:251], s[68:69]
MA 80,32,136
v_cvt_pk_bf16_f32 v140, v236, v237
v_cvt_pk_bf16_f32 v141, v238, v239
v_cvt_pk_bf16_f32 v142, v248, v249
MA 84,32,152
ds_read_b128 v[32:35], v6 offset:8192
v_cvt_pk_bf16_f32 v143, v250, v251
v_pk_mul_f32 v[240:241], v[240:241], s[68:69]
v_pk_mul_f32 v[242:243], v[242:243], s[68:69]
v_pk_mul_f32 v[252:253], v[252:253], s[68:69]
v_pk_mul_f32 v[254:255], v[254:255], s[68:69]
v_cvt_pk_bf16_f32 v156, v240, v241
v_cvt_pk_bf16_f32 v157, v242, v243
v_cvt_pk_bf16_f32 v158, v252, v253
v_cvt_pk_bf16_f32 v159, v254, v255
v_permlane32_swap_b32 v124, v126
v_permlane32_swap_b32 v125, v127
v_permlane32_swap_b32 v140, v142
v_permlane32_swap_b32 v141, v143
v_permlane32_swap_b32 v156, v158
v_permlane32_swap_b32 v157, v159
v_permlane16_swap_b32 v124, v126
v_permlane16_swap_b32 v125, v127
v_permlane16_swap_b32 v140, v142
v_permlane16_swap_b32 v141, v143
v_permlane16_swap_b32 v156, v158
v_permlane16_swap_b32 v157, v159
s_waitcnt lgkmcnt(4)
MA 64,16,124
MA 68,16,140
MA 72,16,156
ds_read_b128 v[16:19], v7 offset:8192
s_waitcnt lgkmcnt(4)
MA 76,20,124
MA 80,20,140
MA 84,20,156
ds_read_b128 v[20:23], v4 offset:12288
s_waitcnt lgkmcnt(4)
MZ 88,24,112
s_add_u32 m0, s61, 28672
s_add_u32 s66, s98, 28672
s_waitcnt vmcnt(2)
s_and_b32 s66, s66, 0x1ffff
buffer_load_dwordx4 v3, s[48:51], s66 offen nt lds
v_max3_f32 v53, v64, v65, v66
MZ 92,24,128
MZ 96,24,144
ds_read_b128 v[24:27], v5 offset:12288
v_max3_f32 v53, v53, v67, v76
v_max3_f32 v53, v53, v77, v78
v_max_f32 v53, v53, v79
s_waitcnt lgkmcnt(4)
MA 88,28,116
v_max3_f32 v57, v68, v69, v70
v_max3_f32 v57, v57, v71, v80
v_max3_f32 v57, v57, v81, v82
MA 92,28,132
v_max_f32 v57, v57, v83
v_max3_f32 v61, v72, v73, v74
v_max3_f32 v61, v61, v75, v84
MA 96,28,148
ds_read_b128 v[28:31], v6 offset:12288
v_max3_f32 v61, v61, v85, v86
v_max_f32 v61, v61, v87
v_mov_b32 v54, v53
s_waitcnt lgkmcnt(4)
MA 88,32,120
MA 92,32,136
v_permlane32_swap_b32 v53, v54
v_max_f32 v53, v53, v54
v_mov_b32 v54, v53
MA 96,32,152
ds_read_b128 v[32:35], v7 offset:12288
v_permlane16_swap_b32 v53, v54
v_max_f32 v53, v53, v54
v_mov_b32 v58, v57
s_waitcnt lgkmcnt(4)
MA 88,16,124
MA 92,16,140
v_permlane32_swap_b32 v57, v58
v_max_f32 v57, v57, v58
v_mov_b32 v58, v57
MA 96,16,156
TR 16,8,16384
v_permlane16_swap_b32 v57, v58
TR 18,8,20480
v_max_f32 v57, v57, v58
v_mov_b32 v62, v61
s_waitcnt lgkmcnt(5)
MZ 100,20,112
s_add_u32 m0, s61, 65536
s_add_u32 s66, s98, 16384
s_and_b32 s66, s66, 0x1ffff
buffer_load_dwordx4 v2, s[52:55], s66 offen nt lds
MZ 104,20,128
v_permlane32_swap_b32 v61, v62
v_max_f32 v61, v61, v62
v_mov_b32 v62, v61
MZ 108,20,144
TR 20,9,16384
v_permlane16_swap_b32 v61, v62
TR 22,9,20480
v_max_f32 v61, v61, v62
v_sub_f32 v52, 0, v53
s_waitcnt lgkmcnt(6)
MA 100,24,116
v_mov_b32 v53, v52
v_mov_b32 v54, v52
v_mov_b32 v55, v52
MA 104,24,132
v_sub_f32 v56, 0, v57
v_mov_b32 v57, v56
v_mov_b32 v58, v56
MA 108,24,148
TR 24,10,16384
v_mov_b32 v59, v56
TR 26,10,20480
v_sub_f32 v60, 0, v61
v_mov_b32 v61, v60
s_waitcnt lgkmcnt(7)
MA 100,28,120
v_mov_b32 v62, v60
v_mov_b32 v63, v60
v_add_f32 v64, v52, v64
MA 104,28,136
v_exp_f32 v64, v64
v_add_f32 v65, v52, v65
MA 108,28,152
TR 28,11,16384
v_exp_f32 v65, v65
TR 30,11,20480
v_cvt_pk_bf16_f32 v64, v64, v65
s_waitcnt lgkmcnt(8)
MA 100,32,124
v_add_f32 v66, v52, v66
v_exp_f32 v66, v66
MA 104,32,140
v_add_f32 v67, v52, v67
v_exp_f32 v67, v67
MA 108,32,156
TR 32,12,16384
v_cvt_pk_bf16_f32 v65, v66, v67
TR 34,12,20480
v_add_f32 v76, v52, v76
v_exp_f32 v76, v76
v_add_f32 v77, v52, v77
v_exp_f32 v77, v77
s_nop 0
v_cvt_pk_bf16_f32 v66, v76, v77
v_add_f32 v78, v52, v78
v_exp_f32 v78, v78
v_add_f32 v79, v52, v79
v_exp_f32 v79, v79
s_nop 0
v_cvt_pk_bf16_f32 v67, v78, v79
v_add_f32 v68, v56, v68
v_exp_f32 v68, v68
v_add_f32 v69, v56, v69
v_exp_f32 v69, v69
s_nop 0
v_cvt_pk_bf16_f32 v68, v68, v69
v_add_f32 v70, v56, v70
v_exp_f32 v70, v70
v_add_f32 v71, v56, v71
v_exp_f32 v71, v71
s_nop 0
v_cvt_pk_bf16_f32 v69, v70, v71
v_add_f32 v80, v56, v80
v_exp_f32 v80, v80
v_add_f32 v81, v56, v81
v_exp_f32 v81, v81
s_nop 0
v_cvt_pk_bf16_f32 v70, v80, v81
v_add_f32 v82, v56, v82
v_exp_f32 v82, v82
v_add_f32 v83, v56, v83
v_exp_f32 v83, v83
s_nop 0
v_cvt_pk_bf16_f32 v71, v82, v83
v_add_f32 v72, v60, v72
v_exp_f32 v72, v72
v_add_f32 v73, v60, v73
v_exp_f32 v73, v73
s_nop 0
v_cvt_pk_bf16_f32 v72, v72, v73
v_add_f32 v74, v60, v74
v_exp_f32 v74, v74
v_add_f32 v75, v60, v75
v_exp_f32 v75, v75
s_nop 0
v_cvt_pk_bf16_f32 v73, v74, v75
v_add_f32 v84, v60, v84
v_exp_f32 v84, v84
v_add_f32 v85, v60, v85
v_exp_f32 v85, v85
s_nop 0
v_cvt_pk_bf16_f32 v74, v84, v85
v_add_f32 v86, v60, v86
v_exp_f32 v86, v86
v_add_f32 v87, v60, v87
v_exp_f32 v87, v87
s_nop 0
v_cvt_pk_bf16_f32 v75, v86, v87
s_waitcnt vmcnt(3)
s_barrier
MZ 40,36,64
s_add_u32 m0, s61, 69632
s_add_u32 s66, s98, 20480
s_and_b32 s66, s66, 0x1ffff
buffer_load_dwordx4 v2, s[52:55], s66 offen nt lds
v_add_f32 v88, v52, v88
v_exp_f32 v88, v88
MZ 44,36,68
v_add_f32 v89, v52, v89
v_exp_f32 v89, v89
MZ 48,36,72
v_cvt_pk_bf16_f32 v88, v88, v89
v_add_f32 v90, v52, v90
s_waitcnt lgkmcnt(8)
MZ 160,16,64
v_exp_f32 v90, v90
v_add_f32 v91, v52, v91
MZ 164,16,68
v_exp_f32 v91, v91
MZ 168,16,72
TR 16,13,16384
v_cvt_pk_bf16_f32 v89, v90, v91
TR 18,13,20480
v_add_f32 v100, v52, v100
v_exp_f32 v100, v100
s_waitcnt lgkmcnt(8)
MZ 172,20,64
v_add_f32 v101, v52, v101
v_exp_f32 v101, v101
MZ 176,20,68
v_cvt_pk_bf16_f32 v90, v100, v101
v_add_f32 v102, v52, v102
MZ 180,20,72
TR 20,14,16384
v_exp_f32 v102, v102
TR 22,14,20480
v_add_f32 v103, v52, v103
s_waitcnt lgkmcnt(8)
MZ 184,24,64
v_exp_f32 v103, v103
MZ 188,24,68
v_cvt_pk_bf16_f32 v91, v102, v103
v_add_f32 v92, v56, v92
v_exp_f32 v92, v92
MZ 192,24,72
TR 24,15,16384
v_add_f32 v93, v56, v93
TR 26,15,20480
v_exp_f32 v93, v93
s_waitcnt lgkmcnt(8)
MZ 196,28,64
s_add_u32 m0, s61, 32768
s_add_u32 s66, s98, 32768
s_waitcnt vmcnt(2)
s_and_b32 s66, s66, 0x1ffff
buffer_load_dwordx4 v3, s[48:51], s66 offen nt lds
v_cvt_pk_bf16_f32 v92, v92, v93
v_add_f32 v94, v56, v94
MZ 200,28,68
v_exp_f32 v94, v94
v_add_f32 v95, v56, v95
MZ 204,28,72
ds_read_b128 v[28:31], v4 offset:16384
v_exp_f32 v95, v95
s_waitcnt lgkmcnt(7)
MZ 208,32,64
v_cvt_pk_bf16_f32 v93, v94, v95
v_add_f32 v104, v56, v104
v_exp_f32 v104, v104
MZ 212,32,68
v_add_f32 v105, v56, v105
v_exp_f32 v105, v105
MZ 216,32,72
ds_read_b128 v[32:35], v5 offset:16384
v_cvt_pk_bf16_f32 v94, v104, v105
v_add_f32 v106, v56, v106
s_waitcnt lgkmcnt(6)
MZ 220,16,64
v_exp_f32 v106, v106
v_add_f32 v107, v56, v107
MZ 224,16,68
v_exp_f32 v107, v107
MZ 228,16,72
ds_read_b128 v[16:19], v6 offset:16384
v_cvt_pk_bf16_f32 v95, v106, v107
v_add_f32 v96, v60, v96
v_exp_f32 v96, v96
s_waitcnt lgkmcnt(5)
MZ 232,20,64
v_add_f32 v97, v60, v97
v_exp_f32 v97, v97
MZ 236,20,68
v_cvt_pk_bf16_f32 v96, v96, v97
v_add_f32 v98, v60, v98
MZ 240,20,72
ds_read_b128 v[20:23], v7 offset:16384
v_exp_f32 v98, v98
v_add_f32 v99, v60, v99
s_waitcnt lgkmcnt(4)
MZ 244,24,64
s_add_u32 m0, s61, 36864
s_add_u32 s66, s98, 36864
s_waitcnt vmcnt(2)
s_and_b32 s66, s66, 0x1ffff
buffer_load_dwordx4 v3, s[48:51], s66 offen nt lds
v_exp_f32 v99, v99
MZ 248,24,68
v_cvt_pk_bf16_f32 v97, v98, v99
v_add_f32 v108, v60, v108
v_exp_f32 v108, v108
MZ 252,24,72
ds_read_b128 v[24:27], v4 offset:20480
v_add_f32 v109, v60, v109
v_exp_f32 v109, v109
s_waitcnt lgkmcnt(4)
MC 64,28,112,52
v_cvt_pk_bf16_f32 v98, v108, v109
v_add_f32 v110, v60, v110
MC 68,28,128,56
v_exp_f32 v110, v110
v_add_f32 v111, v60, v111
MC 72,28,144,60
ds_read_b128 v[28:31], v5 offset:20480
v_exp_f32 v111, v111
s_waitcnt lgkmcnt(4)
MA 64,32,116
v_cvt_pk_bf16_f32 v99, v110, v111
MA 68,32,132
MA 72,32,148
ds_read_b128 v[32:35], v6 offset:20480
s_waitcnt lgkmcnt(4)
MA 64,16,120
MA 68,16,136
MA 72,16,152
ds_read_b128 v[16:19], v7 offset:20480
s_waitcnt lgkmcnt(4)
MA 64,20,124
s_add_u32 m0, s61, 40960
s_add_u32 s66, s98, 24576
s_waitcnt vmcnt(1)
s_and_b32 s66, s66, 0x1ffff
buffer_load_dwordx4 v2, s[52:55], s66 offen nt lds
MA 68,20,140
MA 72,20,156
TR 20,8,8192
TR 22,8,12288
s_waitcnt lgkmcnt(5)
MC 76,24,112,52
MC 80,24,128,56
MC 84,24,144,60
TR 24,9,8192
v_exp_f32 v64, v64
TR 26,9,12288
v_exp_f32 v65, v65
s_waitcnt lgkmcnt(6)
MA 76,28,116
v_cvt_pk_bf16_f32 v64, v64, v65
v_exp_f32 v66, v66
MA 80,28,132
v_exp_f32 v67, v67
MA 84,28,148
TR 28,10,8192
v_cvt_pk_bf16_f32 v65, v66, v67
TR 30,10,12288
s_waitcnt lgkmcnt(7)
MA 76,32,120
MA 80,32,136
MA 84,32,152
TR 32,11,8192
TR 34,11,12288
s_waitcnt lgkmcnt(8)
MA 76,16,124
s_add_u32 m0, s61, 45056
s_add_u32 s66, s98, 28672
s_waitcnt vmcnt(2)
s_and_b32 s66, s66, 0x1ffff
buffer_load_dwordx4 v2, s[52:55], s66 offen nt lds
MA 80,16,140
MA 84,16,156
TR 16,12,8192
TR 18,12,12288
s_waitcnt vmcnt(4)
s_barrier
MA 40,36,88
MA 44,36,92
v_exp_f32 v76, v76
MA 48,36,96
v_exp_f32 v77, v77
s_waitcnt lgkmcnt(8)
MA 160,20,88
v_cvt_pk_bf16_f32 v66, v76, v77
v_exp_f32 v78, v78
MA 164,20,92
v_exp_f32 v79, v79
MA 168,20,96
TR 20,13,8192
v_cvt_pk_bf16_f32 v67, v78, v79
TR 22,13,12288
s_waitcnt lgkmcnt(8)
MA 172,24,88
v_exp_f32 v68, v68
MA 176,24,92
v_exp_f32 v69, v69
MA 180,24,96
TR 24,14,8192
v_cvt_pk_bf16_f32 v68, v68, v69
TR 26,14,12288
v_exp_f32 v70, v70
s_waitcnt lgkmcnt(8)
MA 184,28,88
v_exp_f32 v71, v71
MA 188,28,92
v_cvt_pk_bf16_f32 v69, v70, v71
MA 192,28,96
s_add_u32 m0, s61, 0
s_add_u32 s66, s98, 40960
s_waitcnt vmcnt(2)
s_and_b32 s66, s66, 0x1ffff
buffer_load_dwordx4 v3, s[48:51], s66 offen nt lds
TR 28,15,8192
v_exp_f32 v80, v80
TR 30,15,12288
s_waitcnt lgkmcnt(8)
MA 196,32,88
v_exp_f32 v81, v81
MA 200,32,92
v_cvt_pk_bf16_f32 v70, v80, v81
v_exp_f32 v82, v82
MA 204,32,96
ds_read_b128 v[32:35], v4 offset:24576
v_exp_f32 v83, v83
s_waitcnt lgkmcnt(7)
MA 208,16,88
v_cvt_pk_bf16_f32 v71, v82, v83
MA 212,16,92
v_exp_f32 v72, v72
MA 216,16,96
ds_read_b128 v[16:19], v5 offset:24576
v_exp_f32 v73, v73
s_waitcnt lgkmcnt(6)
MA 220,20,88
v_cvt_pk_bf16_f32 v72, v72, v73
v_exp_f32 v74, v74
MA 224,20,92
v_exp_f32 v75, v75
MA 228,20,96
ds_read_b128 v[20:23], v6 offset:24576
v_cvt_pk_bf16_f32 v73, v74, v75
s_waitcnt lgkmcnt(5)
MA 232,24,88
v_exp_f32 v84, v84
MA 236,24,92
v_exp_f32 v85, v85
MA 240,24,96
s_add_u32 m0, s61, 4096
s_add_u32 s66, s98, 45056
s_waitcnt vmcnt(2)
s_and_b32 s66, s66, 0x1ffff
buffer_load_dwordx4 v3, s[48:51], s66 offen nt lds
ds_read_b128 v[24:27], v7 offset:24576
v_cvt_pk_bf16_f32 v74, v84, v85
v_exp_f32 v86, v86
s_waitcnt lgkmcnt(4)
MA 244,28,88
v_exp_f32 v87, v87
MA 248,28,92
v_cvt_pk_bf16_f32 v75, v86, v87
MA 252,28,96
ds_read_b128 v[28:31], v4 offset:28672
s_waitcnt lgkmcnt(4)
MC 88,32,112,52
MC 92,32,128,56
MC 96,32,144,60
ds_read_b128 v[32:35], v5 offset:28672
s_waitcnt lgkmcnt(4)
MA 88,16,116
MA 92,16,132
MA 96,16,148
ds_read_b128 v[16:19], v6 offset:28672
s_waitcnt lgkmcnt(4)
MA 88,20,120
MA 92,20,136
MA 96,20,152
s_add_u32 m0, s61, 73728
s_add_u32 s66, s98, 32768
s_waitcnt vmcnt(1)
s_and_b32 s66, s66, 0x1ffff
buffer_load_dwordx4 v2, s[52:55], s66 offen nt lds
ds_read_b128 v[20:23], v7 offset:28672
s_waitcnt lgkmcnt(4)
MA 88,24,124
MA 92,24,140
MA 96,24,156
TR 24,8,24576
TR 26,8,28672
s_waitcnt lgkmcnt(5)
MC 100,28,112,52
MC 104,28,128,56
MC 108,28,144,60
TR 28,9,24576
v_exp_f32 v88, v88
TR 30,9,28672
s_waitcnt lgkmcnt(6)
MA 100,32,116
v_exp_f32 v89, v89
MA 104,32,132
v_cvt_pk_bf16_f32 v88, v88, v89
v_exp_f32 v90, v90
MA 108,32,148
TR 32,10,24576
v_exp_f32 v91, v91
TR 34,10,28672
s_waitcnt lgkmcnt(7)
MA 100,16,120
v_cvt_pk_bf16_f32 v89, v90, v91
MA 104,16,136
MA 108,16,152
s_add_u32 m0, s61, 77824
s_add_u32 s66, s98, 36864
s_waitcnt vmcnt(2)
s_and_b32 s66, s66, 0x1ffff
buffer_load_dwordx4 v2, s[52:55], s66 offen nt lds
TR 16,11,24576
TR 18,11,28672
s_waitcnt lgkmcnt(8)
MA 100,20,124
MA 104,20,140
MA 108,20,156
TR 20,12,24576
TR 22,12,28672
s_waitcnt vmcnt(4)
s_barrier
MA 40,36,64
MA 44,36,68
MA 48,36,72
v_exp_f32 v100, v100
s_waitcnt lgkmcnt(8)
MA 160,24,64
v_exp_f32 v101, v101
MA 164,24,68
v_cvt_pk_bf16_f32 v90, v100, v101
v_exp_f32 v102, v102
MA 168,24,72
TR 24,13,24576
v_exp_f32 v103, v103
TR 26,13,28672
s_waitcnt lgkmcnt(8)
MA 172,28,64
v_cvt_pk_bf16_f32 v91, v102, v103
MA 176,28,68
v_exp_f32 v92, v92
MA 180,28,72
TR 28,14,24576
v_exp_f32 v93, v93
TR 30,14,28672
s_waitcnt lgkmcnt(8)
MA 184,32,64
v_cvt_pk_bf16_f32 v92, v92, v93
v_exp_f32 v94, v94
MA 188,32,68
v_exp_f32 v95, v95
MA 192,32,72
s_add_u32 m0, s61, 8192
s_add_u32 s66, s98, 49152
s_waitcnt vmcnt(2)
s_and_b32 s66, s66, 0x1ffff
buffer_load_dwordx4 v3, s[48:51], s66 offen nt lds
TR 32,15,24576
v_cvt_pk_bf16_f32 v93, v94, v95
TR 34,15,28672
s_waitcnt lgkmcnt(8)
MA 196,16,64
v_exp_f32 v104, v104
MA 200,16,68
v_exp_f32 v105, v105
MA 204,16,72
ds_read_b128 v[16:19], v4 offset:32768
v_cvt_pk_bf16_f32 v94, v104, v105
v_exp_f32 v106, v106
s_waitcnt lgkmcnt(7)
MA 208,20,64
v_exp_f32 v107, v107
MA 212,20,68
v_cvt_pk_bf16_f32 v95, v106, v107
MA 216,20,72
ds_read_b128 v[20:23], v5 offset:32768
v_exp_f32 v96, v96
s_waitcnt lgkmcnt(6)
MA 220,24,64
v_exp_f32 v97, v97
MA 224,24,68
v_cvt_pk_bf16_f32 v96, v96, v97
v_exp_f32 v98, v98
MA 228,24,72
ds_read_b128 v[24:27], v6 offset:32768
v_exp_f32 v99, v99
s_waitcnt lgkmcnt(5)
MA 232,28,64
v_cvt_pk_bf16_f32 v97, v98, v99
MA 236,28,68
v_exp_f32 v108, v108
MA 240,28,72
s_add_u32 m0, s61, 12288
s_add_u32 s66, s98, 53248
s_waitcnt vmcnt(2)
s_and_b32 s66, s66, 0x1ffff
buffer_load_dwordx4 v3, s[48:51], s66 offen nt lds
ds_read_b128 v[28:31], v7 offset:32768
v_exp_f32 v109, v109
s_waitcnt lgkmcnt(4)
MA 244,32,64
v_cvt_pk_bf16_f32 v98, v108, v109
v_exp_f32 v110, v110
MA 248,32,68
v_exp_f32 v111, v111
MA 252,32,72
ds_read_b128 v[32:35], v4 offset:36864
v_cvt_pk_bf16_f32 v99, v110, v111
s_waitcnt lgkmcnt(4)
MC 64,16,112,52
MC 68,16,128,56
MC 72,16,144,60
ds_read_b128 v[16:19], v5 offset:36864
s_waitcnt lgkmcnt(4)
MA 64,20,116
MA 68,20,132
MA 72,20,148
ds_read_b128 v[20:23], v6 offset:36864
s_waitcnt lgkmcnt(4)
MA 64,24,120
MA 68,24,136
MA 72,24,152
s_add_u32 m0, s61, 57344
s_add_u32 s66, s98, 40960
s_waitcnt vmcnt(1)
s_and_b32 s66, s66, 0x1ffff
buffer_load_dwordx4 v2, s[52:55], s66 offen nt lds
ds_read_b128 v[24:27], v7 offset:36864
s_waitcnt lgkmcnt(4)
MA 64,28,124
MA 68,28,140
MA 72,28,156
TR 28,8,0
TR 30,8,4096
s_waitcnt lgkmcnt(5)
MC 76,32,112,52
MC 80,32,128,56
MC 84,32,144,60
TR 32,9,0
v_exp_f32 v64, v64
TR 34,9,4096
s_waitcnt lgkmcnt(6)
MA 76,16,116
v_exp_f32 v65, v65
MA 80,16,132
v_cvt_pk_bf16_f32 v64, v64, v65
v_exp_f32 v66, v66
MA 84,16,148
TR 16,10,0
v_exp_f32 v67, v67
TR 18,10,4096
s_waitcnt lgkmcnt(7)
MA 76,20,120
v_cvt_pk_bf16_f32 v65, v66, v67
MA 80,20,136
MA 84,20,152
s_add_u32 m0, s61, 61440
s_add_u32 s66, s98, 45056
s_waitcnt vmcnt(2)
s_and_b32 s66, s66, 0x1ffff
buffer_load_dwordx4 v2, s[52:55], s66 offen nt lds
TR 20,11,0
TR 22,11,4096
s_waitcnt lgkmcnt(8)
MA 76,24,124
MA 80,24,140
MA 84,24,156
TR 24,12,0
TR 26,12,4096
s_waitcnt vmcnt(4)
s_barrier
MA 40,36,88
MA 44,36,92
MA 48,36,96
v_exp_f32 v76, v76
s_waitcnt lgkmcnt(8)
MA 160,28,88
v_exp_f32 v77, v77
MA 164,28,92
v_cvt_pk_bf16_f32 v66, v76, v77
v_exp_f32 v78, v78
MA 168,28,96
TR 28,13,0
v_exp_f32 v79, v79
TR 30,13,4096
s_waitcnt lgkmcnt(8)
MA 172,32,88
v_cvt_pk_bf16_f32 v67, v78, v79
MA 176,32,92
v_exp_f32 v68, v68
MA 180,32,96
TR 32,14,0
v_exp_f32 v69, v69
TR 34,14,4096
s_waitcnt lgkmcnt(8)
MA 184,16,88
v_cvt_pk_bf16_f32 v68, v68, v69
v_exp_f32 v70, v70
MA 188,16,92
v_exp_f32 v71, v71
MA 192,16,96
s_add_u32 m0, s61, 16384
s_add_u32 s66, s98, 57344
s_waitcnt vmcnt(2)
s_and_b32 s66, s66, 0x1ffff
buffer_load_dwordx4 v3, s[48:51], s66 offen nt lds
TR 16,15,0
v_cvt_pk_bf16_f32 v69, v70, v71
TR 18,15,4096
s_waitcnt lgkmcnt(8)
MA 196,20,88
v_exp_f32 v80, v80
MA 200,20,92
v_exp_f32 v81, v81
MA 204,20,96
ds_read_b128 v[20:23], v4 offset:0
v_cvt_pk_bf16_f32 v70, v80, v81
v_exp_f32 v82, v82
s_waitcnt lgkmcnt(7)
MA 208,24,88
v_exp_f32 v83, v83
MA 212,24,92
v_cvt_pk_bf16_f32 v71, v82, v83
MA 216,24,96
ds_read_b128 v[24:27], v5 offset:0
v_exp_f32 v72, v72
s_waitcnt lgkmcnt(6)
MA 220,28,88
v_exp_f32 v73, v73
MA 224,28,92
v_cvt_pk_bf16_f32 v72, v72, v73
v_exp_f32 v74, v74
MA 228,28,96
ds_read_b128 v[28:31], v6 offset:0
v_exp_f32 v75, v75
s_waitcnt lgkmcnt(5)
MA 232,32,88
v_cvt_pk_bf16_f32 v73, v74, v75
MA 236,32,92
v_exp_f32 v84, v84
MA 240,32,96
s_add_u32 m0, s61, 20480
s_add_u32 s66, s98, 61440
s_waitcnt vmcnt(2)
s_and_b32 s66, s66, 0x1ffff
buffer_load_dwordx4 v3, s[48:51], s66 offen nt lds
ds_read_b128 v[32:35], v7 offset:0
v_exp_f32 v85, v85
s_waitcnt lgkmcnt(4)
MA 244,16,88
v_cvt_pk_bf16_f32 v74, v84, v85
v_exp_f32 v86, v86
MA 248,16,92
v_exp_f32 v87, v87
MA 252,16,96
ds_read_b128 v[16:19], v4 offset:4096
v_cvt_pk_bf16_f32 v75, v86, v87
s_waitcnt lgkmcnt(4)
MC 88,20,112,52
MC 92,20,128,56
MC 96,20,144,60
ds_read_b128 v[20:23], v5 offset:4096
s_waitcnt lgkmcnt(4)
MA 88,24,116
MA 92,24,132
MA 96,24,148
ds_read_b128 v[24:27], v6 offset:4096
s_waitcnt lgkmcnt(4)
MA 88,28,120
MA 92,28,136
MA 96,28,152
s_add_u32 m0, s61, 49152
s_add_u32 s66, s98, 49152
s_waitcnt vmcnt(1)
s_and_b32 s66, s66, 0x1ffff
buffer_load_dwordx4 v2, s[52:55], s66 offen nt lds
ds_read_b128 v[28:31], v7 offset:4096
s_waitcnt lgkmcnt(4)
MA 88,32,124
MA 92,32,140
MA 96,32,156
TR 32,8,32768
TR 34,8,36864
s_waitcnt lgkmcnt(5)
MC 100,16,112,52
MC 104,16,128,56
MC 108,16,144,60
TR 16,9,32768
v_exp_f32 v88, v88
TR 18,9,36864
s_waitcnt lgkmcnt(6)
MA 100,20,116
v_exp_f32 v89, v89
MA 104,20,132
v_cvt_pk_bf16_f32 v88, v88, v89
v_exp_f32 v90, v90
MA 108,20,148
TR 20,10,32768
v_exp_f32 v91, v91
TR 22,10,36864
s_waitcnt lgkmcnt(7)
MA 100,24,120
v_cvt_pk_bf16_f32 v89, v90, v91
MA 104,24,136
MA 108,24,152
s_add_u32 m0, s61, 53248
s_add_u32 s66, s98, 53248
s_waitcnt vmcnt(2)
s_and_b32 s66, s66, 0x1ffff
buffer_load_dwordx4 v2, s[52:55], s66 offen nt lds
TR 24,11,32768
TR 26,11,36864
s_waitcnt lgkmcnt(8)
MA 100,28,124
MA 104,28,140
MA 108,28,156
TR 28,12,32768
TR 30,12,36864
s_waitcnt vmcnt(4)
s_barrier
MA 40,36,64
MA 44,36,68
MA 48,36,72
v_exp_f32 v100, v100
s_waitcnt lgkmcnt(8)
MA 160,32,64
v_exp_f32 v101, v101
MA 164,32,68
v_cvt_pk_bf16_f32 v90, v100, v101
v_exp_f32 v102, v102
MA 168,32,72
TR 32,13,32768
v_exp_f32 v103, v103
TR 34,13,36864
s_waitcnt lgkmcnt(8)
MA 172,16,64
v_cvt_pk_bf16_f32 v91, v102, v103
MA 176,16,68
v_exp_f32 v92, v92
MA 180,16,72
TR 16,14,32768
v_exp_f32 v93, v93
TR 18,14,36864
s_waitcnt lgkmcnt(8)
MA 184,20,64
v_cvt_pk_bf16_f32 v92, v92, v93
v_exp_f32 v94, v94
MA 188,20,68
v_exp_f32 v95, v95
MA 192,20,72
s_add_u32 m0, s61, 24576
s_add_u32 s66, s98, 65536
s_waitcnt vmcnt(2)
s_and_b32 s66, s66, 0x1ffff
buffer_load_dwordx4 v3, s[48:51], s66 offen nt lds
TR 20,15,32768
v_cvt_pk_bf16_f32 v93, v94, v95
TR 22,15,36864
s_waitcnt lgkmcnt(8)
MA 196,24,64
v_exp_f32 v104, v104
MA 200,24,68
v_exp_f32 v105, v105
MA 204,24,72
ds_read_b128 v[24:27], v4 offset:8192
v_cvt_pk_bf16_f32 v94, v104, v105
v_exp_f32 v106, v106
s_waitcnt lgkmcnt(7)
MA 208,28,64
v_exp_f32 v107, v107
MA 212,28,68
v_cvt_pk_bf16_f32 v95, v106, v107
MA 216,28,72
ds_read_b128 v[28:31], v5 offset:8192
v_exp_f32 v96, v96
s_waitcnt lgkmcnt(6)
MA 220,32,64
v_exp_f32 v97, v97
MA 224,32,68
v_cvt_pk_bf16_f32 v96, v96, v97
v_exp_f32 v98, v98
MA 228,32,72
ds_read_b128 v[32:35], v6 offset:8192
v_exp_f32 v99, v99
s_waitcnt lgkmcnt(5)
MA 232,16,64
v_cvt_pk_bf16_f32 v97, v98, v99
MA 236,16,68
v_exp_f32 v108, v108
MA 240,16,72
s_add_u32 m0, s61, 28672
s_add_u32 s66, s98, 69632
s_waitcnt vmcnt(2)
s_and_b32 s66, s66, 0x1ffff
buffer_load_dwordx4 v3, s[48:51], s66 offen nt lds
ds_read_b128 v[16:19], v7 offset:8192
v_exp_f32 v109, v109
s_waitcnt lgkmcnt(4)
MA 244,20,64
v_cvt_pk_bf16_f32 v98, v108, v109
v_exp_f32 v110, v110
MA 248,20,68
v_exp_f32 v111, v111
MA 252,20,72
ds_read_b128 v[20:23], v4 offset:12288
v_cvt_pk_bf16_f32 v99, v110, v111
s_waitcnt lgkmcnt(4)
MC 64,24,112,52
MC 68,24,128,56
MC 72,24,144,60
ds_read_b128 v[24:27], v5 offset:12288
s_waitcnt lgkmcnt(4)
MA 64,28,116
MA 68,28,132
MA 72,28,148
ds_read_b128 v[28:31], v6 offset:12288
s_waitcnt lgkmcnt(4)
MA 64,32,120
MA 68,32,136
MA 72,32,152
s_add_u32 m0, s61, 65536
s_add_u32 s66, s98, 57344
s_waitcnt vmcnt(1)
s_and_b32 s66, s66, 0x1ffff
buffer_load_dwordx4 v2, s[52:55], s66 offen nt lds
ds_read_b128 v[32:35], v7 offset:12288
s_waitcnt lgkmcnt(4)
MA 64,16,124
MA 68,16,140
MA 72,16,156
TR 16,8,16384
TR 18,8,20480
s_waitcnt lgkmcnt(5)
MC 76,20,112,52
MC 80,20,128,56
MC 84,20,144,60
TR 20,9,16384
v_exp_f32 v64, v64
TR 22,9,20480
s_waitcnt lgkmcnt(6)
MA 76,24,116
v_exp_f32 v65, v65
MA 80,24,132
v_cvt_pk_bf16_f32 v64, v64, v65
v_exp_f32 v66, v66
MA 84,24,148
TR 24,10,16384
v_exp_f32 v67, v67
TR 26,10,20480
s_waitcnt lgkmcnt(7)
MA 76,28,120
v_cvt_pk_bf16_f32 v65, v66, v67
MA 80,28,136
MA 84,28,152
s_add_u32 m0, s61, 69632
s_add_u32 s66, s98, 61440
s_waitcnt vmcnt(2)
s_and_b32 s66, s66, 0x1ffff
buffer_load_dwordx4 v2, s[52:55], s66 offen nt lds
TR 28,11,16384
TR 30,11,20480
s_waitcnt lgkmcnt(8)
MA 76,32,124
MA 80,32,140
MA 84,32,156
TR 32,12,16384
TR 34,12,20480
s_waitcnt vmcnt(4)
s_barrier
MA 40,36,88
MA 44,36,92
MA 48,36,96
v_exp_f32 v76, v76
s_waitcnt lgkmcnt(8)
MA 160,16,88
v_exp_f32 v77, v77
MA 164,16,92
v_cvt_pk_bf16_f32 v66, v76, v77
v_exp_f32 v78, v78
MA 168,16,96
TR 16,13,16384
v_exp_f32 v79, v79
TR 18,13,20480
s_waitcnt lgkmcnt(8)
MA 172,20,88
v_cvt_pk_bf16_f32 v67, v78, v79
MA 176,20,92
v_exp_f32 v68, v68
MA 180,20,96
TR 20,14,16384
v_exp_f32 v69, v69
TR 22,14,20480
s_waitcnt lgkmcnt(8)
MA 184,24,88
v_cvt_pk_bf16_f32 v68, v68, v69
v_exp_f32 v70, v70
MA 188,24,92
v_exp_f32 v71, v71
MA 192,24,96
s_add_u32 m0, s61, 32768
s_add_u32 s66, s98, 73728
s_waitcnt vmcnt(2)
s_and_b32 s66, s66, 0x1ffff
buffer_load_dwordx4 v3, s[48:51], s66 offen nt lds
TR 24,15,16384
v_cvt_pk_bf16_f32 v69, v70, v71
TR 26,15,20480
s_waitcnt lgkmcnt(8)
MA 196,28,88
v_exp_f32 v80, v80
MA 200,28,92
v_exp_f32 v81, v81
MA 204,28,96
ds_read_b128 v[28:31], v4 offset:16384
v_cvt_pk_bf16_f32 v70, v80, v81
v_exp_f32 v82, v82
s_waitcnt lgkmcnt(7)
MA 208,32,88
v_exp_f32 v83, v83
MA 212,32,92
v_cvt_pk_bf16_f32 v71, v82, v83
MA 216,32,96
ds_read_b128 v[32:35], v5 offset:16384
v_exp_f32 v72, v72
s_waitcnt lgkmcnt(6)
MA 220,16,88
v_exp_f32 v73, v73
MA 224,16,92
v_cvt_pk_bf16_f32 v72, v72, v73
v_exp_f32 v74, v74
MA 228,16,96
ds_read_b128 v[16:19], v6 offset:16384
v_exp_f32 v75, v75
s_waitcnt lgkmcnt(5)
MA 232,20,88
v_cvt_pk_bf16_f32 v73, v74, v75
MA 236,20,92
v_exp_f32 v84, v84
MA 240,20,96
s_add_u32 m0, s61, 36864
s_add_u32 s66, s98, 77824
s_waitcnt vmcnt(2)
s_and_b32 s66, s66, 0x1ffff
buffer_load_dwordx4 v3, s[48:51], s66 offen nt lds
ds_read_b128 v[20:23], v7 offset:16384
v_exp_f32 v85, v85
s_waitcnt lgkmcnt(4)
MA 244,24,88
v_cvt_pk_bf16_f32 v74, v84, v85
v_exp_f32 v86, v86
MA 248,24,92
v_exp_f32 v87, v87
MA 252,24,96
ds_read_b128 v[24:27], v4 offset:20480
v_cvt_pk_bf16_f32 v75, v86, v87
s_waitcnt lgkmcnt(4)
MC 88,28,112,52
MC 92,28,128,56
MC 96,28,144,60
ds_read_b128 v[28:31], v5 offset:20480
s_waitcnt lgkmcnt(4)
MA 88,32,116
MA 92,32,132
MA 96,32,148
ds_read_b128 v[32:35], v6 offset:20480
s_waitcnt lgkmcnt(4)
MA 88,16,120
MA 92,16,136
MA 96,16,152
s_add_u32 m0, s61, 40960
s_add_u32 s66, s98, 65536
s_waitcnt vmcnt(1)
s_and_b32 s66, s66, 0x1ffff
buffer_load_dwordx4 v2, s[52:55], s66 offen nt lds
ds_read_b128 v[16:19], v7 offset:20480
s_waitcnt lgkmcnt(4)
MA 88,20,124
MA 92,20,140
MA 96,20,156
TR 20,8,8192
TR 22,8,12288
s_waitcnt lgkmcnt(5)
MC 100,24,112,52
MC 104,24,128,56
MC 108,24,144,60
TR 24,9,8192
v_exp_f32 v88, v88
TR 26,9,12288
s_waitcnt lgkmcnt(6)
MA 100,28,116
v_exp_f32 v89, v89
MA 104,28,132
v_cvt_pk_bf16_f32 v88, v88, v89
v_exp_f32 v90, v90
MA 108,28,148
TR 28,10,8192
v_exp_f32 v91, v91
TR 30,10,12288
s_waitcnt lgkmcnt(7)
MA 100,32,120
v_cvt_pk_bf16_f32 v89, v90, v91
MA 104,32,136
MA 108,32,152
s_add_u32 m0, s61, 45056
s_add_u32 s66, s98, 69632
s_waitcnt vmcnt(2)
s_and_b32 s66, s66, 0x1ffff
buffer_load_dwordx4 v2, s[52:55], s66 offen nt lds
TR 32,11,8192
TR 34,11,12288
s_waitcnt lgkmcnt(8)
MA 100,16,124
MA 104,16,140
MA 108,16,156
TR 16,12,8192
TR 18,12,12288
s_waitcnt vmcnt(4)
s_barrier
MA 40,36,64
MA 44,36,68
MA 48,36,72
v_exp_f32 v100, v100
s_waitcnt lgkmcnt(8)
MA 160,20,64
v_exp_f32 v101, v101
MA 164,20,68
v_cvt_pk_bf16_f32 v90, v100, v101
v_exp_f32 v102, v102
MA 168,20,72
TR 20,13,8192
v_exp_f32 v103, v103
TR 22,13,12288
s_waitcnt lgkmcnt(8)
MA 172,24,64
v_cvt_pk_bf16_f32 v91, v102, v103
MA 176,24,68
v_exp_f32 v92, v92
MA 180,24,72
TR 24,14,8192
v_exp_f32 v93, v93
TR 26,14,12288
s_waitcnt lgkmcnt(8)
MA 184,28,64
v_cvt_pk_bf16_f32 v92, v92, v93
v_exp_f32 v94, v94
MA 188,28,68
v_exp_f32 v95, v95
MA 192,28,72
s_add_u32 m0, s61, 0
s_add_u32 s66, s98, 81920
s_waitcnt vmcnt(2)
s_and_b32 s66, s66, 0x1ffff
buffer_load_dwordx4 v3, s[48:51], s66 offen nt lds
TR 28,15,8192
v_cvt_pk_bf16_f32 v93, v94, v95
TR 30,15,12288
s_waitcnt lgkmcnt(8)
MA 196,32,64
v_exp_f32 v104, v104
MA 200,32,68
v_exp_f32 v105, v105
MA 204,32,72
ds_read_b128 v[32:35], v4 offset:24576
v_cvt_pk_bf16_f32 v94, v104, v105
v_exp_f32 v106, v106
s_waitcnt lgkmcnt(7)
MA 208,16,64
v_exp_f32 v107, v107
MA 212,16,68
v_cvt_pk_bf16_f32 v95, v106, v107
MA 216,16,72
ds_read_b128 v[16:19], v5 offset:24576
v_exp_f32 v96, v96
s_waitcnt lgkmcnt(6)
MA 220,20,64
v_exp_f32 v97, v97
MA 224,20,68
v_cvt_pk_bf16_f32 v96, v96, v97
v_exp_f32 v98, v98
MA 228,20,72
ds_read_b128 v[20:23], v6 offset:24576
v_exp_f32 v99, v99
s_waitcnt lgkmcnt(5)
MA 232,24,64
v_cvt_pk_bf16_f32 v97, v98, v99
MA 236,24,68
v_exp_f32 v108, v108
MA 240,24,72
s_add_u32 m0, s61, 4096
s_add_u32 s66, s98, 86016
s_waitcnt vmcnt(2)
s_and_b32 s66, s66, 0x1ffff
buffer_load_dwordx4 v3, s[48:51], s66 offen nt lds
ds_read_b128 v[24:27], v7 offset:24576
v_exp_f32 v109, v109
s_waitcnt lgkmcnt(4)
MA 244,28,64
v_cvt_pk_bf16_f32 v98, v108, v109
v_exp_f32 v110, v110
MA 248,28,68
v_exp_f32 v111, v111
MA 252,28,72
ds_read_b128 v[28:31], v4 offset:28672
v_cvt_pk_bf16_f32 v99, v110, v111
s_waitcnt lgkmcnt(4)
MC 64,32,112,52
MC 68,32,128,56
MC 72,32,144,60
ds_read_b128 v[32:35], v5 offset:28672
s_waitcnt lgkmcnt(4)
MA 64,16,116
MA 68,16,132
MA 72,16,148
ds_read_b128 v[16:19], v6 offset:28672
s_waitcnt lgkmcnt(4)
MA 64,20,120
MA 68,20,136
MA 72,20,152
s_add_u32 m0, s61, 73728
s_add_u32 s66, s98, 73728
s_waitcnt vmcnt(1)
s_and_b32 s66, s66, 0x1ffff
buffer_load_dwordx4 v2, s[52:55], s66 offen nt lds
ds_read_b128 v[20:23], v7 offset:28672
s_waitcnt lgkmcnt(4)
MA 64,24,124
MA 68,24,140
MA 72,24,156
TR 24,8,24576
TR 26,8,28672
s_waitcnt lgkmcnt(5)
MC 76,28,112,52
MC 80,28,128,56
MC 84,28,144,60
TR 28,9,24576
v_exp_f32 v64, v64
TR 30,9,28672
s_waitcnt lgkmcnt(6)
MA 76,32,116
v_exp_f32 v65, v65
MA 80,32,132
v_cvt_pk_bf16_f32 v64, v64, v65
v_exp_f32 v66, v66
MA 84,32,148
TR 32,10,24576
v_exp_f32 v67, v67
TR 34,10,28672
s_waitcnt lgkmcnt(7)
MA 76,16,120
v_cvt_pk_bf16_f32 v65, v66, v67
MA 80,16,136
MA 84,16,152
s_add_u32 m0, s61, 77824
s_add_u32 s66, s98, 77824
s_waitcnt vmcnt(2)
s_and_b32 s66, s66, 0x1ffff
buffer_load_dwordx4 v2, s[52:55], s66 offen nt lds
TR 16,11,24576
TR 18,11,28672
s_waitcnt lgkmcnt(8)
MA 76,20,124
MA 80,20,140
MA 84,20,156
TR 20,12,24576
TR 22,12,28672
s_waitcnt vmcnt(4)
s_barrier
MA 40,36,88
MA 44,36,92
MA 48,36,96
v_exp_f32 v76, v76
s_waitcnt lgkmcnt(8)
MA 160,24,88
v_exp_f32 v77, v77
MA 164,24,92
v_cvt_pk_bf16_f32 v66, v76, v77
v_exp_f32 v78, v78
MA 168,24,96
TR 24,13,24576
v_exp_f32 v79, v79
TR 26,13,28672
s_waitcnt lgkmcnt(8)
MA 172,28,88
v_cvt_pk_bf16_f32 v67, v78, v79
MA 176,28,92
v_exp_f32 v68, v68
MA 180,28,96
TR 28,14,24576
v_exp_f32 v69, v69
TR 30,14,28672
s_waitcnt lgkmcnt(8)
MA 184,32,88
v_cvt_pk_bf16_f32 v68, v68, v69
v_exp_f32 v70, v70
MA 188,32,92
v_exp_f32 v71, v71
MA 192,32,96
s_add_u32 m0, s61, 8192
s_add_u32 s66, s98, 90112
s_waitcnt vmcnt(2)
s_and_b32 s66, s66, 0x1ffff
buffer_load_dwordx4 v3, s[48:51], s66 offen nt lds
TR 32,15,24576
v_cvt_pk_bf16_f32 v69, v70, v71
TR 34,15,28672
s_waitcnt lgkmcnt(8)
MA 196,16,88
v_exp_f32 v80, v80
MA 200,16,92
v_exp_f32 v81, v81
MA 204,16,96
ds_read_b128 v[16:19], v4 offset:32768
v_cvt_pk_bf16_f32 v70, v80, v81
v_exp_f32 v82, v82
s_waitcnt lgkmcnt(7)
MA 208,20,88
v_exp_f32 v83, v83
MA 212,20,92
v_cvt_pk_bf16_f32 v71, v82, v83
MA 216,20,96
ds_read_b128 v[20:23], v5 offset:32768
v_exp_f32 v72, v72
s_waitcnt lgkmcnt(6)
MA 220,24,88
v_exp_f32 v73, v73
MA 224,24,92
v_cvt_pk_bf16_f32 v72, v72, v73
v_exp_f32 v74, v74
MA 228,24,96
ds_read_b128 v[24:27], v6 offset:32768
v_exp_f32 v75, v75
s_waitcnt lgkmcnt(5)
MA 232,28,88
v_cvt_pk_bf16_f32 v73, v74, v75
MA 236,28,92
v_exp_f32 v84, v84
MA 240,28,96
s_add_u32 m0, s61, 12288
s_add_u32 s66, s98, 94208
s_waitcnt vmcnt(2)
s_and_b32 s66, s66, 0x1ffff
buffer_load_dwordx4 v3, s[48:51], s66 offen nt lds
ds_read_b128 v[28:31], v7 offset:32768
v_exp_f32 v85, v85
s_waitcnt lgkmcnt(4)
MA 244,32,88
v_cvt_pk_bf16_f32 v74, v84, v85
v_exp_f32 v86, v86
MA 248,32,92
v_exp_f32 v87, v87
MA 252,32,96
ds_read_b128 v[32:35], v4 offset:36864
v_cvt_pk_bf16_f32 v75, v86, v87
s_waitcnt lgkmcnt(4)
MC 88,16,112,52
MC 92,16,128,56
MC 96,16,144,60
ds_read_b128 v[16:19], v5 offset:36864
s_waitcnt lgkmcnt(4)
MA 88,20,116
MA 92,20,132
MA 96,20,148
ds_read_b128 v[20:23], v6 offset:36864
s_waitcnt lgkmcnt(4)
MA 88,24,120
MA 92,24,136
MA 96,24,152
s_add_u32 m0, s61, 57344
s_add_u32 s66, s98, 81920
s_waitcnt vmcnt(1)
s_and_b32 s66, s66, 0x1ffff
buffer_load_dwordx4 v2, s[52:55], s66 offen nt lds
ds_read_b128 v[24:27], v7 offset:36864
s_waitcnt lgkmcnt(4)
MA 88,28,124
MA 92,28,140
MA 96,28,156
TR 28,8,0
TR 30,8,4096
s_waitcnt lgkmcnt(5)
MC 100,32,112,52
MC 104,32,128,56
MC 108,32,144,60
TR 32,9,0
v_exp_f32 v88, v88
TR 34,9,4096
s_waitcnt lgkmcnt(6)
MA 100,16,116
v_exp_f32 v89, v89
MA 104,16,132
v_cvt_pk_bf16_f32 v88, v88, v89
v_exp_f32 v90, v90
MA 108,16,148
TR 16,10,0
v_exp_f32 v91, v91
TR 18,10,4096
s_waitcnt lgkmcnt(7)
MA 100,20,120
v_cvt_pk_bf16_f32 v89, v90, v91
MA 104,20,136
MA 108,20,152
s_add_u32 m0, s61, 61440
s_add_u32 s66, s98, 86016
s_waitcnt vmcnt(2)
s_and_b32 s66, s66, 0x1ffff
buffer_load_dwordx4 v2, s[52:55], s66 offen nt lds
TR 20,11,0
TR 22,11,4096
s_waitcnt lgkmcnt(8)
MA 100,24,124
MA 104,24,140
MA 108,24,156
TR 24,12,0
TR 26,12,4096
s_waitcnt vmcnt(4)
s_barrier
MA 40,36,64
MA 44,36,68
MA 48,36,72
v_exp_f32 v100, v100
s_waitcnt lgkmcnt(8)
MA 160,28,64
v_exp_f32 v101, v101
MA 164,28,68
v_cvt_pk_bf16_f32 v90, v100, v101
v_exp_f32 v102, v102
MA 168,28,72
TR 28,13,0
v_exp_f32 v103, v103
TR 30,13,4096
s_waitcnt lgkmcnt(8)
MA 172,32,64
v_cvt_pk_bf16_f32 v91, v102, v103
MA 176,32,68
v_exp_f32 v92, v92
MA 180,32,72
TR 32,14,0
v_exp_f32 v93, v93
TR 34,14,4096
s_waitcnt lgkmcnt(8)
MA 184,16,64
v_cvt_pk_bf16_f32 v92, v92, v93
v_exp_f32 v94, v94
MA 188,16,68
v_exp_f32 v95, v95
MA 192,16,72
s_add_u32 m0, s61, 16384
s_add_u32 s66, s98, 98304
s_waitcnt vmcnt(2)
s_and_b32 s66, s66, 0x1ffff
buffer_load_dwordx4 v3, s[48:51], s66 offen nt lds
TR 16,15,0
v_cvt_pk_bf16_f32 v93, v94, v95
TR 18,15,4096
s_waitcnt lgkmcnt(8)
MA 196,20,64
v_exp_f32 v104, v104
MA 200,20,68
v_exp_f32 v105, v105
MA 204,20,72
ds_read_b128 v[20:23], v4 offset:0
v_cvt_pk_bf16_f32 v94, v104, v105
v_exp_f32 v106, v106
s_waitcnt lgkmcnt(7)
MA 208,24,64
v_exp_f32 v107, v107
MA 212,24,68
v_cvt_pk_bf16_f32 v95, v106, v107
MA 216,24,72
ds_read_b128 v[24:27], v5 offset:0
v_exp_f32 v96, v96
s_waitcnt lgkmcnt(6)
MA 220,28,64
v_exp_f32 v97, v97
MA 224,28,68
v_cvt_pk_bf16_f32 v96, v96, v97
v_exp_f32 v98, v98
MA 228,28,72
ds_read_b128 v[28:31], v6 offset:0
v_exp_f32 v99, v99
s_waitcnt lgkmcnt(5)
MA 232,32,64
v_cvt_pk_bf16_f32 v97, v98, v99
MA 236,32,68
v_exp_f32 v108, v108
MA 240,32,72
s_add_u32 m0, s61, 20480
s_add_u32 s66, s98, 102400
s_waitcnt vmcnt(2)
s_and_b32 s66, s66, 0x1ffff
buffer_load_dwordx4 v3, s[48:51], s66 offen nt lds
ds_read_b128 v[32:35], v7 offset:0
v_exp_f32 v109, v109
s_waitcnt lgkmcnt(4)
MA 244,16,64
v_cvt_pk_bf16_f32 v98, v108, v109
v_exp_f32 v110, v110
MA 248,16,68
v_exp_f32 v111, v111
MA 252,16,72
ds_read_b128 v[16:19], v4 offset:4096
v_cvt_pk_bf16_f32 v99, v110, v111
s_waitcnt lgkmcnt(4)
MC 64,20,112,52
MC 68,20,128,56
MC 72,20,144,60
ds_read_b128 v[20:23], v5 offset:4096
s_waitcnt lgkmcnt(4)
MA 64,24,116
MA 68,24,132
MA 72,24,148
ds_read_b128 v[24:27], v6 offset:4096
s_waitcnt lgkmcnt(4)
MA 64,28,120
MA 68,28,136
MA 72,28,152
s_add_u32 m0, s61, 49152
s_add_u32 s66, s98, 90112
s_waitcnt vmcnt(1)
s_and_b32 s66, s66, 0x1ffff
buffer_load_dwordx4 v2, s[52:55], s66 offen nt lds
ds_read_b128 v[28:31], v7 offset:4096
s_waitcnt lgkmcnt(4)
MA 64,32,124
MA 68,32,140
MA 72,32,156
TR 32,8,32768
TR 34,8,36864
s_waitcnt lgkmcnt(5)
MC 76,16,112,52
MC 80,16,128,56
MC 84,16,144,60
TR 16,9,32768
v_exp_f32 v64, v64
TR 18,9,36864
s_waitcnt lgkmcnt(6)
MA 76,20,116
v_exp_f32 v65, v65
MA 80,20,132
v_cvt_pk_bf16_f32 v64, v64, v65
v_exp_f32 v66, v66
MA 84,20,148
TR 20,10,32768
v_exp_f32 v67, v67
TR 22,10,36864
s_waitcnt lgkmcnt(7)
MA 76,24,120
v_cvt_pk_bf16_f32 v65, v66, v67
MA 80,24,136
MA 84,24,152
s_add_u32 m0, s61, 53248
s_add_u32 s66, s98, 94208
s_waitcnt vmcnt(2)
s_and_b32 s66, s66, 0x1ffff
buffer_load_dwordx4 v2, s[52:55], s66 offen nt lds
TR 24,11,32768
TR 26,11,36864
s_waitcnt lgkmcnt(8)
MA 76,28,124
MA 80,28,140
MA 84,28,156
TR 28,12,32768
TR 30,12,36864
s_waitcnt vmcnt(4)
s_barrier
MA 40,36,88
MA 44,36,92
MA 48,36,96
v_exp_f32 v76, v76
s_waitcnt lgkmcnt(8)
MA 160,32,88
v_exp_f32 v77, v77
MA 164,32,92
v_cvt_pk_bf16_f32 v66, v76, v77
v_exp_f32 v78, v78
MA 168,32,96
TR 32,13,32768
v_exp_f32 v79, v79
TR 34,13,36864
s_waitcnt lgkmcnt(8)
MA 172,16,88
v_cvt_pk_bf16_f32 v67, v78, v79
MA 176,16,92
v_exp_f32 v68, v68
MA 180,16,96
TR 16,14,32768
v_exp_f32 v69, v69
TR 18,14,36864
s_waitcnt lgkmcnt(8)
MA 184,20,88
v_cvt_pk_bf16_f32 v68, v68, v69
v_exp_f32 v70, v70
MA 188,20,92
v_exp_f32 v71, v71
MA 192,20,96
s_add_u32 m0, s61, 24576
s_add_u32 s66, s98, 106496
s_waitcnt vmcnt(2)
s_and_b32 s66, s66, 0x1ffff
buffer_load_dwordx4 v3, s[48:51], s66 offen nt lds
TR 20,15,32768
v_cvt_pk_bf16_f32 v69, v70, v71
TR 22,15,36864
s_waitcnt lgkmcnt(8)
MA 196,24,88
v_exp_f32 v80, v80
MA 200,24,92
v_exp_f32 v81, v81
MA 204,24,96
ds_read_b128 v[24:27], v4 offset:8192
v_cvt_pk_bf16_f32 v70, v80, v81
v_exp_f32 v82, v82
s_waitcnt lgkmcnt(7)
MA 208,28,88
v_exp_f32 v83, v83
MA 212,28,92
v_cvt_pk_bf16_f32 v71, v82, v83
MA 216,28,96
ds_read_b128 v[28:31], v5 offset:8192
v_exp_f32 v72, v72
s_waitcnt lgkmcnt(6)
MA 220,32,88
v_exp_f32 v73, v73
MA 224,32,92
v_cvt_pk_bf16_f32 v72, v72, v73
v_exp_f32 v74, v74
MA 228,32,96
ds_read_b128 v[32:35], v6 offset:8192
v_exp_f32 v75, v75
s_waitcnt lgkmcnt(5)
MA 232,16,88
v_cvt_pk_bf16_f32 v73, v74, v75
MA 236,16,92
v_exp_f32 v84, v84
MA 240,16,96
s_add_u32 m0, s61, 28672
s_add_u32 s66, s98, 110592
s_waitcnt vmcnt(2)
s_and_b32 s66, s66, 0x1ffff
buffer_load_dwordx4 v3, s[48:51], s66 offen nt lds
ds_read_b128 v[16:19], v7 offset:8192
v_exp_f32 v85, v85
s_waitcnt lgkmcnt(4)
MA 244,20,88
v_cvt_pk_bf16_f32 v74, v84, v85
v_exp_f32 v86, v86
MA 248,20,92
v_exp_f32 v87, v87
MA 252,20,96
ds_read_b128 v[20:23], v4 offset:12288
v_cvt_pk_bf16_f32 v75, v86, v87
s_waitcnt lgkmcnt(4)
MC 88,24,112,52
MC 92,24,128,56
MC 96,24,144,60
ds_read_b128 v[24:27], v5 offset:12288
s_waitcnt lgkmcnt(4)
MA 88,28,116
MA 92,28,132
MA 96,28,148
ds_read_b128 v[28:31], v6 offset:12288
s_waitcnt lgkmcnt(4)
MA 88,32,120
MA 92,32,136
MA 96,32,152
s_add_u32 m0, s61, 65536
s_add_u32 s66, s98, 98304
s_waitcnt vmcnt(1)
s_and_b32 s66, s66, 0x1ffff
buffer_load_dwordx4 v2, s[52:55], s66 offen nt lds
ds_read_b128 v[32:35], v7 offset:12288
s_waitcnt lgkmcnt(4)
MA 88,16,124
MA 92,16,140
MA 96,16,156
TR 16,8,16384
TR 18,8,20480
s_waitcnt lgkmcnt(5)
MC 100,20,112,52
MC 104,20,128,56
MC 108,20,144,60
TR 20,9,16384
v_exp_f32 v88, v88
TR 22,9,20480
s_waitcnt lgkmcnt(6)
MA 100,24,116
v_exp_f32 v89, v89
MA 104,24,132
v_cvt_pk_bf16_f32 v88, v88, v89
v_exp_f32 v90, v90
MA 108,24,148
TR 24,10,16384
v_exp_f32 v91, v91
TR 26,10,20480
s_waitcnt lgkmcnt(7)
MA 100,28,120
v_cvt_pk_bf16_f32 v89, v90, v91
MA 104,28,136
MA 108,28,152
s_add_u32 m0, s61, 69632
s_add_u32 s66, s98, 102400
s_waitcnt vmcnt(2)
s_and_b32 s66, s66, 0x1ffff
buffer_load_dwordx4 v2, s[52:55], s66 offen nt lds
TR 28,11,16384
TR 30,11,20480
s_waitcnt lgkmcnt(8)
MA 100,32,124
MA 104,32,140
MA 108,32,156
TR 32,12,16384
TR 34,12,20480
s_waitcnt vmcnt(4)
s_barrier
MA 40,36,64
MA 44,36,68
MA 48,36,72
v_exp_f32 v100, v100
s_waitcnt lgkmcnt(8)
MA 160,16,64
v_exp_f32 v101, v101
MA 164,16,68
v_cvt_pk_bf16_f32 v90, v100, v101
v_exp_f32 v102, v102
MA 168,16,72
TR 16,13,16384
v_exp_f32 v103, v103
TR 18,13,20480
s_waitcnt lgkmcnt(8)
MA 172,20,64
v_cvt_pk_bf16_f32 v91, v102, v103
MA 176,20,68
v_exp_f32 v92, v92
MA 180,20,72
TR 20,14,16384
v_exp_f32 v93, v93
TR 22,14,20480
s_waitcnt lgkmcnt(8)
MA 184,24,64
v_cvt_pk_bf16_f32 v92, v92, v93
v_exp_f32 v94, v94
MA 188,24,68
v_exp_f32 v95, v95
MA 192,24,72
s_add_u32 m0, s61, 32768
s_add_u32 s66, s98, 114688
s_waitcnt vmcnt(2)
s_and_b32 s66, s66, 0x1ffff
buffer_load_dwordx4 v3, s[48:51], s66 offen nt lds
TR 24,15,16384
v_cvt_pk_bf16_f32 v93, v94, v95
TR 26,15,20480
s_waitcnt lgkmcnt(8)
MA 196,28,64
v_exp_f32 v104, v104
MA 200,28,68
v_exp_f32 v105, v105
MA 204,28,72
ds_read_b128 v[28:31], v4 offset:16384
v_cvt_pk_bf16_f32 v94, v104, v105
v_exp_f32 v106, v106
s_waitcnt lgkmcnt(7)
MA 208,32,64
v_exp_f32 v107, v107
MA 212,32,68
v_cvt_pk_bf16_f32 v95, v106, v107
MA 216,32,72
ds_read_b128 v[32:35], v5 offset:16384
v_exp_f32 v96, v96
s_waitcnt lgkmcnt(6)
MA 220,16,64
v_exp_f32 v97, v97
MA 224,16,68
v_cvt_pk_bf16_f32 v96, v96, v97
v_exp_f32 v98, v98
MA 228,16,72
ds_read_b128 v[16:19], v6 offset:16384
v_exp_f32 v99, v99
s_waitcnt lgkmcnt(5)
MA 232,20,64
v_cvt_pk_bf16_f32 v97, v98, v99
MA 236,20,68
v_exp_f32 v108, v108
MA 240,20,72
s_add_u32 m0, s61, 36864
s_add_u32 s66, s98, 118784
s_waitcnt vmcnt(2)
s_and_b32 s66, s66, 0x1ffff
buffer_load_dwordx4 v3, s[48:51], s66 offen nt lds
ds_read_b128 v[20:23], v7 offset:16384
v_exp_f32 v109, v109
s_waitcnt lgkmcnt(4)
MA 244,24,64
v_cvt_pk_bf16_f32 v98, v108, v109
v_exp_f32 v110, v110
MA 248,24,68
v_exp_f32 v111, v111
MA 252,24,72
ds_read_b128 v[24:27], v4 offset:20480
v_cvt_pk_bf16_f32 v99, v110, v111
s_waitcnt lgkmcnt(4)
MC 64,28,112,52
MC 68,28,128,56
MC 72,28,144,60
ds_read_b128 v[28:31], v5 offset:20480
s_waitcnt lgkmcnt(4)
MA 64,32,116
MA 68,32,132
MA 72,32,148
ds_read_b128 v[32:35], v6 offset:20480
s_waitcnt lgkmcnt(4)
MA 64,16,120
MA 68,16,136
MA 72,16,152
s_add_u32 m0, s61, 40960
s_add_u32 s66, s98, 106496
s_waitcnt vmcnt(1)
s_and_b32 s66, s66, 0x1ffff
buffer_load_dwordx4 v2, s[52:55], s66 offen nt lds
ds_read_b128 v[16:19], v7 offset:20480
s_waitcnt lgkmcnt(4)
MA 64,20,124
MA 68,20,140
MA 72,20,156
TR 20,8,8192
TR 22,8,12288
s_waitcnt lgkmcnt(5)
MC 76,24,112,52
MC 80,24,128,56
MC 84,24,144,60
TR 24,9,8192
v_exp_f32 v64, v64
TR 26,9,12288
s_waitcnt lgkmcnt(6)
MA 76,28,116
v_exp_f32 v65, v65
MA 80,28,132
v_cvt_pk_bf16_f32 v64, v64, v65
v_exp_f32 v66, v66
MA 84,28,148
TR 28,10,8192
v_exp_f32 v67, v67
TR 30,10,12288
s_waitcnt lgkmcnt(7)
MA 76,32,120
v_cvt_pk_bf16_f32 v65, v66, v67
MA 80,32,136
MA 84,32,152
s_add_u32 m0, s61, 45056
s_add_u32 s66, s98, 110592
s_waitcnt vmcnt(2)
s_and_b32 s66, s66, 0x1ffff
buffer_load_dwordx4 v2, s[52:55], s66 offen nt lds
TR 32,11,8192
TR 34,11,12288
s_waitcnt lgkmcnt(8)
MA 76,16,124
MA 80,16,140
MA 84,16,156
TR 16,12,8192
TR 18,12,12288
s_waitcnt vmcnt(4)
s_barrier
MA 40,36,88
MA 44,36,92
MA 48,36,96
v_exp_f32 v76, v76
s_waitcnt lgkmcnt(8)
MA 160,20,88
v_exp_f32 v77, v77
MA 164,20,92
v_cvt_pk_bf16_f32 v66, v76, v77
v_exp_f32 v78, v78
MA 168,20,96
TR 20,13,8192
v_exp_f32 v79, v79
TR 22,13,12288
s_waitcnt lgkmcnt(8)
MA 172,24,88
v_cvt_pk_bf16_f32 v67, v78, v79
MA 176,24,92
v_exp_f32 v68, v68
MA 180,24,96
TR 24,14,8192
v_exp_f32 v69, v69
TR 26,14,12288
s_waitcnt lgkmcnt(8)
MA 184,28,88
v_cvt_pk_bf16_f32 v68, v68, v69
v_exp_f32 v70, v70
MA 188,28,92
v_exp_f32 v71, v71
MA 192,28,96
s_add_u32 m0, s61, 0
s_add_u32 s66, s98, 122880
s_waitcnt vmcnt(2)
s_and_b32 s66, s66, 0x1ffff
buffer_load_dwordx4 v3, s[48:51], s66 offen nt lds
TR 28,15,8192
v_cvt_pk_bf16_f32 v69, v70, v71
TR 30,15,12288
s_waitcnt lgkmcnt(8)
MA 196,32,88
v_exp_f32 v80, v80
MA 200,32,92
v_exp_f32 v81, v81
MA 204,32,96
ds_read_b128 v[32:35], v4 offset:24576
v_cvt_pk_bf16_f32 v70, v80, v81
v_exp_f32 v82, v82
s_waitcnt lgkmcnt(7)
MA 208,16,88
v_exp_f32 v83, v83
MA 212,16,92
v_cvt_pk_bf16_f32 v71, v82, v83
MA 216,16,96
ds_read_b128 v[16:19], v5 offset:24576
v_exp_f32 v72, v72
s_waitcnt lgkmcnt(6)
MA 220,20,88
v_exp_f32 v73, v73
MA 224,20,92
v_cvt_pk_bf16_f32 v72, v72, v73
v_exp_f32 v74, v74
MA 228,20,96
ds_read_b128 v[20:23], v6 offset:24576
v_exp_f32 v75, v75
s_waitcnt lgkmcnt(5)
MA 232,24,88
v_cvt_pk_bf16_f32 v73, v74, v75
MA 236,24,92
v_exp_f32 v84, v84
MA 240,24,96
s_add_u32 m0, s61, 4096
s_add_u32 s66, s98, 126976
s_waitcnt vmcnt(2)
s_and_b32 s66, s66, 0x1ffff
buffer_load_dwordx4 v3, s[48:51], s66 offen nt lds
ds_read_b128 v[24:27], v7 offset:24576
v_exp_f32 v85, v85
s_waitcnt lgkmcnt(4)
MA 244,28,88
v_cvt_pk_bf16_f32 v74, v84, v85
v_exp_f32 v86, v86
MA 248,28,92
v_exp_f32 v87, v87
MA 252,28,96
ds_read_b128 v[28:31], v4 offset:28672
v_cvt_pk_bf16_f32 v75, v86, v87
s_waitcnt lgkmcnt(4)
MC 88,32,112,52
MC 92,32,128,56
MC 96,32,144,60
ds_read_b128 v[32:35], v5 offset:28672
s_waitcnt lgkmcnt(4)
MA 88,16,116
MA 92,16,132
MA 96,16,148
ds_read_b128 v[16:19], v6 offset:28672
s_waitcnt lgkmcnt(4)
MA 88,20,120
MA 92,20,136
MA 96,20,152
s_add_u32 m0, s61, 73728
s_add_u32 s66, s98, 114688
s_waitcnt vmcnt(1)
s_and_b32 s66, s66, 0x1ffff
buffer_load_dwordx4 v2, s[52:55], s66 offen nt lds
ds_read_b128 v[20:23], v7 offset:28672
s_waitcnt lgkmcnt(4)
MA 88,24,124
MA 92,24,140
MA 96,24,156
TR 24,8,24576
TR 26,8,28672
s_waitcnt lgkmcnt(5)
MC 100,28,112,52
MC 104,28,128,56
MC 108,28,144,60
TR 28,9,24576
v_exp_f32 v88, v88
TR 30,9,28672
s_waitcnt lgkmcnt(6)
MA 100,32,116
v_exp_f32 v89, v89
MA 104,32,132
v_cvt_pk_bf16_f32 v88, v88, v89
v_exp_f32 v90, v90
MA 108,32,148
TR 32,10,24576
v_exp_f32 v91, v91
TR 34,10,28672
s_waitcnt lgkmcnt(7)
MA 100,16,120
v_cvt_pk_bf16_f32 v89, v90, v91
MA 104,16,136
MA 108,16,152
s_add_u32 m0, s61, 77824
s_add_u32 s66, s98, 118784
s_waitcnt vmcnt(2)
s_and_b32 s66, s66, 0x1ffff
buffer_load_dwordx4 v2, s[52:55], s66 offen nt lds
TR 16,11,24576
TR 18,11,28672
s_waitcnt lgkmcnt(8)
MA 100,20,124
MA 104,20,140
MA 108,20,156
TR 20,12,24576
TR 22,12,28672
s_waitcnt vmcnt(4)
s_barrier
MA 40,36,64
MA 44,36,68
MA 48,36,72
v_exp_f32 v100, v100
s_waitcnt lgkmcnt(8)
MA 160,24,64
v_exp_f32 v101, v101
MA 164,24,68
v_cvt_pk_bf16_f32 v90, v100, v101
v_exp_f32 v102, v102
MA 168,24,72
TR 24,13,24576
v_exp_f32 v103, v103
TR 26,13,28672
s_waitcnt lgkmcnt(8)
MA 172,28,64
v_cvt_pk_bf16_f32 v91, v102, v103
MA 176,28,68
v_exp_f32 v92, v92
MA 180,28,72
s_add_u32 m0, s61, 57344
s_add_u32 s66, s98, 122880
s_waitcnt vmcnt(1)
s_and_b32 s66, s66, 0x1ffff
buffer_load_dwordx4 v2, s[52:55], s66 offen nt lds
TR 28,14,24576
v_exp_f32 v93, v93
TR 30,14,28672
s_waitcnt lgkmcnt(8)
MA 184,32,64
v_cvt_pk_bf16_f32 v92, v92, v93
v_exp_f32 v94, v94
MA 188,32,68
v_exp_f32 v95, v95
MA 192,32,72
TR 32,15,24576
v_cvt_pk_bf16_f32 v93, v94, v95
TR 34,15,28672
s_waitcnt lgkmcnt(8)
MA 196,16,64
v_exp_f32 v104, v104
MA 200,16,68
v_exp_f32 v105, v105
MA 204,16,72
ds_read_b128 v[16:19], v4 offset:32768
v_cvt_pk_bf16_f32 v94, v104, v105
v_exp_f32 v106, v106
s_waitcnt lgkmcnt(7)
MA 208,20,64
v_exp_f32 v107, v107
MA 212,20,68
v_cvt_pk_bf16_f32 v95, v106, v107
MA 216,20,72
ds_read_b128 v[20:23], v5 offset:32768
v_exp_f32 v96, v96
s_waitcnt lgkmcnt(6)
MA 220,24,64
v_exp_f32 v97, v97
MA 224,24,68
v_cvt_pk_bf16_f32 v96, v96, v97
v_exp_f32 v98, v98
MA 228,24,72
s_add_u32 m0, s61, 61440
s_add_u32 s66, s98, 126976
s_waitcnt vmcnt(2)
s_and_b32 s66, s66, 0x1ffff
buffer_load_dwordx4 v2, s[52:55], s66 offen nt lds
ds_read_b128 v[24:27], v6 offset:32768
v_exp_f32 v99, v99
s_waitcnt lgkmcnt(5)
MA 232,28,64
v_cvt_pk_bf16_f32 v97, v98, v99
MA 236,28,68
v_exp_f32 v108, v108
MA 240,28,72
ds_read_b128 v[28:31], v7 offset:32768
v_exp_f32 v109, v109
s_waitcnt lgkmcnt(4)
MA 244,32,64
v_cvt_pk_bf16_f32 v98, v108, v109
v_exp_f32 v110, v110
MA 248,32,68
v_exp_f32 v111, v111
MA 252,32,72
ds_read_b128 v[32:35], v4 offset:36864
v_cvt_pk_bf16_f32 v99, v110, v111
s_waitcnt lgkmcnt(4)
MC 64,16,112,52
MC 68,16,128,56
MC 72,16,144,60
ds_read_b128 v[16:19], v5 offset:36864
s_waitcnt lgkmcnt(4)
MA 64,20,116
s_add_u32 m0, s61, 12288
s_mov_b32 s66, 0
buffer_load_dwordx4 v1, s[40:43], s66 offen lds
MA 68,20,132
MA 72,20,148
ds_read_b128 v[20:23], v6 offset:36864
s_waitcnt lgkmcnt(4)
MA 64,24,120
MA 68,24,136
MA 72,24,152
ds_read_b128 v[24:27], v7 offset:36864
s_waitcnt lgkmcnt(4)
MA 64,28,124
MA 68,28,140
MA 72,28,156
TR 28,8,0
TR 30,8,4096
s_waitcnt lgkmcnt(5)
MC 76,32,112,52
MC 80,32,128,56
s_add_u32 m0, s61, 16384
s_mov_b32 s66, 36864
buffer_load_dwordx4 v1, s[40:43], s66 offen lds
MC 84,32,144,60
TR 32,9,0
v_exp_f32 v64, v64
TR 34,9,4096
s_waitcnt lgkmcnt(6)
MA 76,16,116
v_exp_f32 v65, v65
MA 80,16,132
v_cvt_pk_bf16_f32 v64, v64, v65
v_exp_f32 v66, v66
MA 84,16,148
TR 16,10,0
v_exp_f32 v67, v67
TR 18,10,4096
s_waitcnt lgkmcnt(7)
MA 76,20,120
v_cvt_pk_bf16_f32 v65, v66, v67
MA 80,20,136
MA 84,20,152
TR 20,11,0
TR 22,11,4096
s_waitcnt lgkmcnt(8)
MA 76,24,124
MA 80,24,140
MA 84,24,156
s_add_u32 m0, s61, 20480
s_mov_b32 s66, 73728
buffer_load_dwordx4 v1, s[40:43], s66 offen lds
TR 24,12,0
TR 26,12,4096
s_waitcnt vmcnt(5)
s_barrier
MA 40,36,88
MA 44,36,92
MA 48,36,96
v_exp_f32 v76, v76
s_waitcnt lgkmcnt(8)
MA 160,28,88
v_exp_f32 v77, v77
MA 164,28,92
v_cvt_pk_bf16_f32 v66, v76, v77
v_exp_f32 v78, v78
MA 168,28,96
TR 28,13,0
v_exp_f32 v79, v79
TR 30,13,4096
s_waitcnt lgkmcnt(8)
MA 172,32,88
v_cvt_pk_bf16_f32 v67, v78, v79
MA 176,32,92
v_exp_f32 v68, v68
MA 180,32,96
TR 32,14,0
v_exp_f32 v69, v69
TR 34,14,4096
s_waitcnt lgkmcnt(8)
MA 184,16,88
s_add_u32 m0, s61, 49152
s_mov_b32 s66, 4096
buffer_load_dwordx4 v0, s[44:47], s66 offen lds
v_cvt_pk_bf16_f32 v68, v68, v69
v_exp_f32 v70, v70
MA 188,16,92
v_exp_f32 v71, v71
MA 192,16,96
TR 16,15,0
v_cvt_pk_bf16_f32 v69, v70, v71
TR 18,15,4096
s_waitcnt lgkmcnt(8)
MA 196,20,88
v_exp_f32 v80, v80
MA 200,20,92
v_exp_f32 v81, v81
MA 204,20,96
ds_read_b128 v[20:23], v4 offset:0
v_cvt_pk_bf16_f32 v70, v80, v81
v_exp_f32 v82, v82
s_waitcnt lgkmcnt(7)
MA 208,24,88
v_exp_f32 v83, v83
MA 212,24,92
v_cvt_pk_bf16_f32 v71, v82, v83
MA 216,24,96
ds_read_b128 v[24:27], v5 offset:0
v_exp_f32 v72, v72
s_waitcnt lgkmcnt(6)
MA 220,28,88
v_exp_f32 v73, v73
MA 224,28,92
s_add_u32 m0, s61, 53248
s_mov_b32 s66, 135168
buffer_load_dwordx4 v0, s[44:47], s66 offen lds
v_cvt_pk_bf16_f32 v72, v72, v73
v_exp_f32 v74, v74
MA 228,28,96
ds_read_b128 v[28:31], v6 offset:0
v_exp_f32 v75, v75
s_waitcnt lgkmcnt(5)
MA 232,32,88
v_cvt_pk_bf16_f32 v73, v74, v75
MA 236,32,92
v_exp_f32 v84, v84
MA 240,32,96
ds_read_b128 v[32:35], v7 offset:0
v_exp_f32 v85, v85
s_waitcnt lgkmcnt(4)
MA 244,16,88
v_cvt_pk_bf16_f32 v74, v84, v85
v_exp_f32 v86, v86
MA 248,16,92
v_exp_f32 v87, v87
MA 252,16,96
ds_read_b128 v[16:19], v4 offset:4096
v_cvt_pk_bf16_f32 v75, v86, v87
s_waitcnt lgkmcnt(4)
MC 88,20,112,52
MC 92,20,128,56
MC 96,20,144,60
s_add_u32 m0, s61, 24576
s_mov_b32 s66, 128
buffer_load_dwordx4 v1, s[40:43], s66 offen lds
ds_read_b128 v[20:23], v5 offset:4096
s_waitcnt lgkmcnt(4)
MA 88,24,116
MA 92,24,132
MA 96,24,148
ds_read_b128 v[24:27], v6 offset:4096
s_waitcnt lgkmcnt(4)
MA 88,28,120
MA 92,28,136
MA 96,28,152
ds_read_b128 v[28:31], v7 offset:4096
s_waitcnt lgkmcnt(4)
MA 88,32,124
MA 92,32,140
MA 96,32,156
TR 32,8,32768
TR 34,8,36864
s_waitcnt lgkmcnt(5)
MC 100,16,112,52
s_add_u32 m0, s61, 28672
s_mov_b32 s66, 36992
buffer_load_dwordx4 v1, s[40:43], s66 offen lds
MC 104,16,128,56
MC 108,16,144,60
TR 16,9,32768
TR 18,9,36864
s_waitcnt lgkmcnt(6)
MA 100,20,116
MA 104,20,132
MA 108,20,148
TR 20,10,32768
TR 22,10,36864
s_waitcnt lgkmcnt(7)
MA 100,24,120
v_mbcnt_lo_u32_b32 v120, -1, 0
v_mbcnt_hi_u32_b32 v120, -1, v120
MA 104,24,136
v_and_b32 v117, 15, v120
v_lshrrev_b32 v119, 4, v120
MA 108,24,152
TR 24,11,32768
v_lshrrev_b32 v118, 1, v117
TR 26,11,36864
v_xor_b32 v118, v118, v119
s_waitcnt lgkmcnt(8)
MA 100,28,124
v_lshlrev_b32 v118, 4, v118
v_lshl_add_u32 v118, v117, 7, v118
MA 104,28,140
s_add_u32 m0, s61, 32768
s_mov_b32 s66, 73856
buffer_load_dwordx4 v1, s[40:43], s66 offen lds
v_add_u32 v60, s32, v118
v_xor_b32 v61, 64, v60
MA 108,28,156
TR 28,12,32768
v_lshrrev_b32 v116, 2, v120
TR 30,12,36864
v_and_b32 v116, 3, v116
s_waitcnt vmcnt(8)
s_barrier
v_mbcnt_lo_u32_b32 v113, -1, 0
v_mbcnt_hi_u32_b32 v113, -1, v113
s_and_b32 s72, s86, 7
s_lshl_b32 s72, s72, 2
s_add_u32 s72, s72, s60
s_mul_i32 s72, s72, 36
s_mov_b32 s73, 4096
v_min_u32 v112, 35, v113
v_add_u32 v112, s72, v112
v_and_b32 v114, 1, v112
v_lshrrev_b32 v112, 1, v112
v_lshlrev_b32 v112, 13, v112
v_lshl_add_u32 v112, v114, 7, v112
buffer_load_dword v156, v112, s[44:47], s73 offen
v_lshl_add_u32 v117, v119, 3, v116
v_and_b32 v118, 1, v119
v_lshl_add_u32 v118, v118, 2, v116
v_lshlrev_b32 v118, 5, v118
v_lshl_add_u32 v118, v117, 8, v118
v_and_b32 v120, 3, v120
v_lshl_add_u32 v118, v120, 3, v118
v_add_u32 v118, 24576, v118
v_add_u32 v52, s63, v118
v_xor_b32 v53, 32, v52
v_xor_b32 v54, 64, v52
v_xor_b32 v55, 96, v52
v_xor_b32 v56, 128, v52
v_xor_b32 v57, 160, v52
v_xor_b32 v58, 192, v52
v_xor_b32 v59, 224, v52
MA 40,36,64
s_add_u32 m0, s61, 65536
s_mov_b32 s66, 266240
buffer_load_dwordx4 v0, s[44:47], s66 offen lds
v_exp_f32 v88, v88
MA 44,36,68
v_exp_f32 v89, v89
MA 48,36,72
s_add_u32 m0, s61, 69632
s_mov_b32 s66, 397312
buffer_load_dwordx4 v0, s[44:47], s66 offen lds
v_cvt_pk_bf16_f32 v88, v88, v89
v_exp_f32 v90, v90
s_waitcnt lgkmcnt(8)
MA 160,32,64
v_exp_f32 v91, v91
MA 164,32,68
s_add_u32 m0, s61, 40960
s_mov_b32 s66, 528384
buffer_load_dwordx4 v0, s[44:47], s66 offen lds
v_cvt_pk_bf16_f32 v89, v90, v91
MA 168,32,72
TR 32,13,32768
v_exp_f32 v100, v100
TR 34,13,36864
s_waitcnt lgkmcnt(8)
MA 172,16,64
s_add_u32 m0, s61, 45056
s_mov_b32 s66, 659456
buffer_load_dwordx4 v0, s[44:47], s66 offen lds
v_exp_f32 v101, v101
MA 176,16,68
v_cvt_pk_bf16_f32 v90, v100, v101
v_exp_f32 v102, v102
MA 180,16,72
TR 16,14,32768
v_exp_f32 v103, v103
TR 18,14,36864
s_waitcnt lgkmcnt(8)
MA 184,20,64
v_cvt_pk_bf16_f32 v91, v102, v103
MA 188,20,68
v_exp_f32 v92, v92
MA 192,20,72
TR 20,15,32768
v_exp_f32 v93, v93
TR 22,15,36864
s_waitcnt lgkmcnt(8)
MA 196,24,64
v_cvt_pk_bf16_f32 v92, v92, v93
v_exp_f32 v94, v94
MA 200,24,68
v_exp_f32 v95, v95
MA 204,24,72
TR 24,8,16384
v_cvt_pk_bf16_f32 v93, v94, v95
TR 26,8,20480
s_waitcnt lgkmcnt(8)
MA 208,28,64
v_exp_f32 v104, v104
MA 212,28,68
s_add_u32 m0, s61, 0
s_mov_b32 s66, 256
buffer_load_dwordx4 v1, s[40:43], s66 offen lds
v_exp_f32 v105, v105
MA 216,28,72
TR 28,9,16384
v_cvt_pk_bf16_f32 v94, v104, v105
TR 30,9,20480
v_exp_f32 v106, v106
s_waitcnt lgkmcnt(8)
MA 220,32,64
v_exp_f32 v107, v107
MA 224,32,68
v_cvt_pk_bf16_f32 v95, v106, v107
MA 228,32,72
TR 32,10,16384
v_exp_f32 v96, v96
TR 34,10,20480
s_waitcnt lgkmcnt(8)
MA 232,16,64
v_exp_f32 v97, v97
MA 236,16,68
v_cvt_pk_bf16_f32 v96, v96, v97
v_exp_f32 v98, v98
MA 240,16,72
v_exp_f32 v99, v99
s_waitcnt lgkmcnt(6)
MA 244,20,64
v_cvt_pk_bf16_f32 v97, v98, v99
MA 248,20,68
v_exp_f32 v108, v108
MA 252,20,72
s_add_u32 m0, s61, 4096
s_mov_b32 s66, 37120
buffer_load_dwordx4 v1, s[40:43], s66 offen lds
v_exp_f32 v109, v109
s_nop 0
v_cvt_pk_bf16_f32 v98, v108, v109
v_exp_f32 v110, v110
v_exp_f32 v111, v111
s_nop 0
v_cvt_pk_bf16_f32 v99, v110, v111
MA 40,36,88
MA 44,36,92
MA 48,36,96
s_waitcnt lgkmcnt(4)
MA 160,24,88
MA 164,24,92
MA 168,24,96
s_waitcnt lgkmcnt(2)
MA 172,28,88
MA 176,28,92
MA 180,28,96
v_rcp_f32 v42, v40
s_waitcnt lgkmcnt(0)
MA 184,32,88
s_add_u32 m0, s61, 8192
s_mov_b32 s66, 73984
buffer_load_dwordx4 v1, s[40:43], s66 offen lds
v_mov_b32 v43, v42
v_rcp_f32 v46, v44
MA 188,32,92
v_mov_b32 v47, v46
v_rcp_f32 v50, v48
MA 192,32,96
v_mov_b32 v51, v50
v_pk_mul_f32 v[160:161], v[160:161], v[42:43]
v_pk_mul_f32 v[162:163], v[162:163], v[42:43]
v_cmp_nge_f32 vcc, s67, v40
v_cmp_nge_f32 s[72:73], s67, v44
v_cmp_nge_f32 s[74:75], s67, v48
s_nop 4
s_or_b64 s[72:73], s[72:73], s[74:75]
s_or_b64 s[72:73], s[72:73], vcc
s_cmp_lg_u64 s[72:73], 0
s_cselect_b32 s72, 1, 0
s_lshl_b32 s73, s62, 2
v_mov_b32 v62, s73
v_mov_b32 v63, s72
ds_write_b32 v62, v63 offset:36864
TR 16,11,16384
TR 18,11,20480
s_waitcnt lgkmcnt(0)
MA 196,16,88
TR 20,12,16384
v_pk_mul_f32 v[172:173], v[172:173], v[42:43]
TR 22,12,20480
v_pk_mul_f32 v[174:175], v[174:175], v[42:43]
v_cvt_pk_bf16_f32 v112, v160, v161
MA 200,16,92
TR 24,13,16384
v_cvt_pk_bf16_f32 v113, v162, v163
TR 26,13,20480
v_cvt_pk_bf16_f32 v114, v172, v173
v_cvt_pk_bf16_f32 v115, v174, v175
MA 204,16,96
TR 28,14,16384
v_pk_mul_f32 v[164:165], v[164:165], v[46:47]
TR 30,14,20480
v_pk_mul_f32 v[166:167], v[166:167], v[46:47]
v_pk_mul_f32 v[176:177], v[176:177], v[46:47]
s_waitcnt lgkmcnt(4)
MA 208,20,88
TR 32,15,16384
v_pk_mul_f32 v[178:179], v[178:179], v[46:47]
TR 34,15,20480
v_cvt_pk_bf16_f32 v128, v164, v165
v_cvt_pk_bf16_f32 v129, v166, v167
MA 212,20,92
v_cvt_pk_bf16_f32 v130, v176, v177
v_cvt_pk_bf16_f32 v131, v178, v179
v_pk_mul_f32 v[168:169], v[168:169], v[50:51]
MA 216,20,96
v_pk_mul_f32 v[170:171], v[170:171], v[50:51]
v_pk_mul_f32 v[180:181], v[180:181], v[50:51]
v_pk_mul_f32 v[182:183], v[182:183], v[50:51]
s_waitcnt lgkmcnt(4)
MA 220,24,88
v_cvt_pk_bf16_f32 v144, v168, v169
v_cvt_pk_bf16_f32 v145, v170, v171
v_cvt_pk_bf16_f32 v146, v180, v181
MA 224,24,92
v_cvt_pk_bf16_f32 v147, v182, v183
v_pk_mul_f32 v[184:185], v[184:185], v[42:43]
v_pk_mul_f32 v[186:187], v[186:187], v[42:43]
MA 228,24,96
v_pk_mul_f32 v[196:197], v[196:197], v[42:43]
v_pk_mul_f32 v[198:199], v[198:199], v[42:43]
v_cvt_pk_bf16_f32 v116, v184, v185
s_waitcnt lgkmcnt(2)
MA 232,28,88
v_cvt_pk_bf16_f32 v117, v186, v187
v_cvt_pk_bf16_f32 v118, v196, v197
v_cvt_pk_bf16_f32 v119, v198, v199
MA 236,28,92
v_pk_mul_f32 v[188:189], v[188:189], v[46:47]
v_pk_mul_f32 v[190:191], v[190:191], v[46:47]
v_pk_mul_f32 v[200:201], v[200:201], v[46:47]
MA 240,28,96
v_pk_mul_f32 v[202:203], v[202:203], v[46:47]
v_cvt_pk_bf16_f32 v132, v188, v189
v_cvt_pk_bf16_f32 v133, v190, v191
s_waitcnt lgkmcnt(0)
MA 244,32,88
v_cvt_pk_bf16_f32 v134, v200, v201
v_cvt_pk_bf16_f32 v135, v202, v203
v_pk_mul_f32 v[192:193], v[192:193], v[50:51]
MA 248,32,92
v_pk_mul_f32 v[194:195], v[194:195], v[50:51]
v_pk_mul_f32 v[204:205], v[204:205], v[50:51]
v_pk_mul_f32 v[206:207], v[206:207], v[50:51]
MA 252,32,96
v_cvt_pk_bf16_f32 v148, v192, v193
v_cvt_pk_bf16_f32 v149, v194, v195
v_cvt_pk_bf16_f32 v150, v204, v205
v_cvt_pk_bf16_f32 v151, v206, v207
v_pk_mul_f32 v[208:209], v[208:209], v[42:43]
v_pk_mul_f32 v[210:211], v[210:211], v[42:43]
v_pk_mul_f32 v[220:221], v[220:221], v[42:43]
v_pk_mul_f32 v[222:223], v[222:223], v[42:43]
v_cvt_pk_bf16_f32 v120, v208, v209
v_cvt_pk_bf16_f32 v121, v210, v211
v_cvt_pk_bf16_f32 v122, v220, v221
v_cvt_pk_bf16_f32 v123, v222, v223
v_pk_mul_f32 v[212:213], v[212:213], v[46:47]
v_pk_mul_f32 v[214:215], v[214:215], v[46:47]
v_pk_mul_f32 v[224:225], v[224:225], v[46:47]
v_pk_mul_f32 v[226:227], v[226:227], v[46:47]
v_cvt_pk_bf16_f32 v136, v212, v213
v_cvt_pk_bf16_f32 v137, v214, v215
v_cvt_pk_bf16_f32 v138, v224, v225
v_cvt_pk_bf16_f32 v139, v226, v227
v_pk_mul_f32 v[216:217], v[216:217], v[50:51]
v_pk_mul_f32 v[218:219], v[218:219], v[50:51]
v_pk_mul_f32 v[228:229], v[228:229], v[50:51]
v_pk_mul_f32 v[230:231], v[230:231], v[50:51]
v_cvt_pk_bf16_f32 v152, v216, v217
v_cvt_pk_bf16_f32 v153, v218, v219
v_cvt_pk_bf16_f32 v154, v228, v229
v_cvt_pk_bf16_f32 v155, v230, v231
v_pk_mul_f32 v[232:233], v[232:233], v[42:43]
v_pk_mul_f32 v[234:235], v[234:235], v[42:43]
v_pk_mul_f32 v[244:245], v[244:245], v[42:43]
v_pk_mul_f32 v[246:247], v[246:247], v[42:43]
v_cvt_pk_bf16_f32 v124, v232, v233
v_cvt_pk_bf16_f32 v125, v234, v235
v_cvt_pk_bf16_f32 v126, v244, v245
v_cvt_pk_bf16_f32 v127, v246, v247
v_pk_mul_f32 v[236:237], v[236:237], v[46:47]
v_pk_mul_f32 v[238:239], v[238:239], v[46:47]
v_pk_mul_f32 v[248:249], v[248:249], v[46:47]
v_pk_mul_f32 v[250:251], v[250:251], v[46:47]
v_cvt_pk_bf16_f32 v140, v236, v237
v_cvt_pk_bf16_f32 v141, v238, v239
v_cvt_pk_bf16_f32 v142, v248, v249
v_cvt_pk_bf16_f32 v143, v250, v251
v_pk_mul_f32 v[240:241], v[240:241], v[50:51]
v_pk_mul_f32 v[242:243], v[242:243], v[50:51]
v_pk_mul_f32 v[252:253], v[252:253], v[50:51]
v_pk_mul_f32 v[254:255], v[254:255], v[50:51]
s_waitcnt vmcnt(7)
v_cvt_pk_bf16_f32 v156, v240, v241
v_cvt_pk_bf16_f32 v157, v242, v243
v_cvt_pk_bf16_f32 v158, v252, v253
v_cvt_pk_bf16_f32 v159, v254, v255
L_after0:
s_waitcnt lgkmcnt(0)
v_mbcnt_lo_u32_b32 v40, -1, 0
v_mbcnt_hi_u32_b32 v40, -1, v40
s_add_u32 s72, s89, 0
v_lshl_add_u32 v40, v40, 4, s72
s_waitcnt vmcnt(3)
s_barrier
v_mbcnt_lo_u32_b32 v45, -1, 0
v_mbcnt_hi_u32_b32 v45, -1, v45
v_and_b32 v45, 7, v45
v_lshlrev_b32 v45, 2, v45
ds_read_b32 v45, v45 offset:36864
ds_read_b128 v[64:67], v60 offset:12288
ds_read_b128 v[76:79], v61 offset:12288
ds_read_b128 v[68:71], v60 offset:14336
ds_read_b128 v[80:83], v61 offset:14336
ds_read_b128 v[72:75], v60 offset:16384
ds_read_b128 v[84:87], v61 offset:16384
TR 16,52,24576
TR 18,52,25600
s_waitcnt lgkmcnt(0)
MZ 160,16,64
TR 20,53,24576
TR 22,53,25600
MZ 164,16,68
s_add_u32 m0, s61, 57344
s_mov_b32 s66, 790528
buffer_load_dwordx4 v0, s[44:47], s66 offen lds
TR 24,54,24576
TR 26,54,25600
MZ 168,16,72
s_waitcnt lgkmcnt(2)
MZ 172,20,64
s_add_u32 m0, s61, 61440
s_mov_b32 s66, 921600
buffer_load_dwordx4 v0, s[44:47], s66 offen lds
MZ 176,20,68
MZ 180,20,72
s_add_u32 m0, s61, 73728
s_mov_b32 s66, 1052672
buffer_load_dwordx4 v0, s[44:47], s66 offen lds
s_waitcnt lgkmcnt(0)
MZ 184,24,64
MZ 188,24,68
s_add_u32 m0, s61, 77824
s_mov_b32 s66, 1183744
buffer_load_dwordx4 v0, s[44:47], s66 offen lds
MZ 192,24,72
v_cmp_ne_u32 vcc, 0, v45
s_mov_b32 s78, 36864
s_mov_b32 s99, 0
s_nop 3
s_cmp_lg_u64 vcc, 0
s_cbranch_scc1 L_fallback
TR 28,55,24576
TR 30,55,25600
s_waitcnt lgkmcnt(0)
MZ 196,28,64
TR 32,56,24576
TR 34,56,25600
MZ 200,28,68
ds_read_b128 v[88:91], v60 offset:24576
ds_read_b128 v[100:103], v61 offset:24576
MZ 204,28,72
TR 16,57,24576
TR 18,57,25600
s_waitcnt lgkmcnt(4)
MZ 208,32,64
ds_read_b128 v[92:95], v60 offset:26624
ds_read_b128 v[104:107], v61 offset:26624
MZ 212,32,68
TR 20,58,24576
TR 22,58,25600
MZ 216,32,72
ds_read_b128 v[96:99], v60 offset:28672
ds_read_b128 v[108:111], v61 offset:28672
s_waitcnt lgkmcnt(6)
MZ 220,16,64
TR 24,59,24576
TR 26,59,25600
buffer_store_dwordx4 v[112:115], v40, s[56:59], 0 offen offset:0 sc1
MZ 224,16,68
TR 28,52,40960
TR 30,52,41984
MZ 228,16,72
TR 32,53,40960
TR 34,53,41984
s_waitcnt lgkmcnt(8)
MZ 232,20,64
TR 16,54,40960
TR 18,54,41984
buffer_store_dwordx4 v[128:131], v40, s[56:59], s64 offen offset:0 sc1
MZ 236,20,68
MZ 240,20,72
TR 20,55,40960
TR 22,55,41984
s_waitcnt lgkmcnt(8)
MZ 244,24,64
MZ 248,24,68
MZ 252,24,72
TR 24,56,40960
TR 26,56,41984
s_waitcnt lgkmcnt(8)
MA 160,28,76
MA 164,28,80
MA 168,28,84
TR 28,57,40960
TR 30,57,41984
s_waitcnt lgkmcnt(8)
MA 172,32,76
MA 176,32,80
MA 180,32,84
TR 32,58,40960
TR 34,58,41984
s_waitcnt lgkmcnt(8)
MA 184,16,76
MA 188,16,80
MA 192,16,84
TR 16,59,40960
TR 18,59,41984
s_waitcnt lgkmcnt(8)
MA 196,20,76
MA 200,20,80
MA 204,20,84
TR 20,52,16384
TR 22,52,17408
s_waitcnt lgkmcnt(8)
MA 208,24,76
MA 212,24,80
MA 216,24,84
TR 24,53,16384
TR 26,53,17408
s_waitcnt lgkmcnt(8)
MA 220,28,76
MA 224,28,80
MA 228,28,84
TR 28,54,16384
TR 30,54,17408
s_waitcnt lgkmcnt(8)
MA 232,32,76
MA 236,32,80
MA 240,32,84
TR 32,55,16384
TR 34,55,17408
s_waitcnt lgkmcnt(8)
MA 244,16,76
MA 248,16,80
MA 252,16,84
TR 16,56,16384
TR 18,56,17408
s_waitcnt vmcnt(2)
s_barrier
s_waitcnt lgkmcnt(8)
MA 160,20,88
ds_read_b128 v[64:67], v60 offset:0
ds_read_b128 v[76:79], v61 offset:0
MA 164,20,92
s_add_u32 m0, s61, 12288
s_mov_b32 s66, 384
buffer_load_dwordx4 v1, s[40:43], s66 offen lds
MA 168,20,96
TR 20,57,16384
TR 22,57,17408
s_waitcnt lgkmcnt(10)
MA 172,24,88
s_add_u32 m0, s61, 16384
s_mov_b32 s66, 37248
buffer_load_dwordx4 v1, s[40:43], s66 offen lds
ds_read_b128 v[68:71], v60 offset:2048
ds_read_b128 v[80:83], v61 offset:2048
MA 176,24,92
MA 180,24,96
s_add_u32 m0, s61, 20480
s_mov_b32 s66, 74112
buffer_load_dwordx4 v1, s[40:43], s66 offen lds
TR 24,58,16384
TR 26,58,17408
s_waitcnt lgkmcnt(12)
MA 184,28,88
ds_read_b128 v[72:75], v60 offset:4096
ds_read_b128 v[84:87], v61 offset:4096
MA 188,28,92
s_add_u32 m0, s61, 49152
s_mov_b32 s66, 1314816
buffer_load_dwordx4 v0, s[44:47], s66 offen lds
MA 192,28,96
TR 28,59,16384
TR 30,59,17408
s_waitcnt lgkmcnt(14)
MA 196,32,88
s_add_u32 m0, s61, 53248
s_mov_b32 s66, 1445888
buffer_load_dwordx4 v0, s[44:47], s66 offen lds
MA 200,32,92
MA 204,32,96
s_add_u32 m0, s61, 65536
s_mov_b32 s66, 1576960
buffer_load_dwordx4 v0, s[44:47], s66 offen lds
TR 32,52,32768
TR 34,52,33792
s_waitcnt lgkmcnt(14)
MA 208,16,88
MA 212,16,92
s_add_u32 m0, s61, 69632
s_mov_b32 s66, 1708032
buffer_load_dwordx4 v0, s[44:47], s66 offen lds
MA 216,16,96
TR 16,53,32768
TR 18,53,33792
s_waitcnt lgkmcnt(12)
MA 220,20,88
buffer_store_dwordx4 v[144:147], v40, s[56:59], s65 offen offset:0 sc1
MA 224,20,92
MA 228,20,96
TR 20,54,32768
TR 22,54,33792
s_waitcnt lgkmcnt(10)
MA 232,24,88
buffer_store_dwordx4 v[116:119], v40, s[56:59], 0 offen offset:1024 sc1
MA 236,24,92
MA 240,24,96
TR 24,55,32768
TR 26,55,33792
s_waitcnt lgkmcnt(8)
MA 244,28,88
MA 248,28,92
MA 252,28,96
s_add_u32 m0, s61, 24576
s_mov_b32 s66, 512
buffer_load_dwordx4 v1, s[40:43], s66 offen lds
TR 28,56,32768
TR 30,56,33792
s_waitcnt lgkmcnt(8)
MA 160,32,100
MA 164,32,104
MA 168,32,108
TR 32,57,32768
TR 34,57,33792
s_waitcnt lgkmcnt(8)
MA 172,16,100
MA 176,16,104
MA 180,16,108
TR 16,58,32768
TR 18,58,33792
s_waitcnt lgkmcnt(8)
MA 184,20,100
MA 188,20,104
MA 192,20,108
TR 20,59,32768
TR 22,59,33792
s_waitcnt lgkmcnt(8)
MA 196,24,100
s_add_u32 m0, s61, 28672
s_mov_b32 s66, 37376
buffer_load_dwordx4 v1, s[40:43], s66 offen lds
MA 200,24,104
MA 204,24,108
TR 24,52,49152
TR 26,52,50176
s_waitcnt lgkmcnt(8)
MA 208,28,100
MA 212,28,104
MA 216,28,108
TR 28,53,49152
TR 30,53,50176
s_waitcnt lgkmcnt(8)
MA 220,32,100
MA 224,32,104
MA 228,32,108
TR 32,54,49152
TR 34,54,50176
s_waitcnt lgkmcnt(8)
MA 232,16,100
MA 236,16,104
s_add_u32 m0, s61, 32768
s_mov_b32 s66, 74240
buffer_load_dwordx4 v1, s[40:43], s66 offen lds
MA 240,16,108
TR 16,55,49152
TR 18,55,50176
s_waitcnt lgkmcnt(8)
MA 244,20,100
MA 248,20,104
MA 252,20,108
TR 20,56,49152
TR 22,56,50176
s_waitcnt vmcnt(5)
s_barrier
s_waitcnt lgkmcnt(8)
MA 160,24,64
ds_read_b128 v[88:91], v60 offset:12288
ds_read_b128 v[100:103], v61 offset:12288
MA 164,24,68
s_add_u32 m0, s61, 40960
s_mov_b32 s66, 1839104
buffer_load_dwordx4 v0, s[44:47], s66 offen lds
MA 168,24,72
TR 24,57,49152
TR 26,57,50176
s_waitcnt lgkmcnt(10)
MA 172,28,64
s_add_u32 m0, s61, 45056
s_mov_b32 s66, 1970176
buffer_load_dwordx4 v0, s[44:47], s66 offen lds
ds_read_b128 v[92:95], v60 offset:14336
ds_read_b128 v[104:107], v61 offset:14336
MA 176,28,68
MA 180,28,72
s_add_u32 m0, s61, 57344
s_mov_b32 s66, 2101248
buffer_load_dwordx4 v0, s[44:47], s66 offen lds
TR 28,58,49152
TR 30,58,50176
s_waitcnt lgkmcnt(12)
MA 184,32,64
ds_read_b128 v[96:99], v60 offset:16384
ds_read_b128 v[108:111], v61 offset:16384
MA 188,32,68
s_add_u32 m0, s61, 61440
s_mov_b32 s66, 2232320
buffer_load_dwordx4 v0, s[44:47], s66 offen lds
MA 192,32,72
TR 32,59,49152
TR 34,59,50176
s_waitcnt lgkmcnt(14)
MA 196,16,64
MA 200,16,68
MA 204,16,72
TR 16,52,24576
TR 18,52,25600
s_waitcnt lgkmcnt(14)
MA 208,20,64
MA 212,20,68
MA 216,20,72
TR 20,53,24576
TR 22,53,25600
s_waitcnt lgkmcnt(12)
MA 220,24,64
buffer_store_dwordx4 v[132:135], v40, s[56:59], s64 offen offset:1024 sc1
MA 224,24,68
MA 228,24,72
s_add_u32 m0, s61, 0
s_mov_b32 s66, 640
buffer_load_dwordx4 v1, s[40:43], s66 offen lds
TR 24,54,24576
TR 26,54,25600
s_waitcnt lgkmcnt(10)
MA 232,28,64
buffer_store_dwordx4 v[148:151], v40, s[56:59], s65 offen offset:1024 sc1
MA 236,28,68
MA 240,28,72
TR 28,55,24576
TR 30,55,25600
s_waitcnt lgkmcnt(8)
MA 244,32,64
MA 248,32,68
MA 252,32,72
TR 32,56,24576
TR 34,56,25600
s_waitcnt lgkmcnt(8)
MA 160,16,76
MA 164,16,80
MA 168,16,84
TR 16,57,24576
TR 18,57,25600
s_waitcnt lgkmcnt(8)
MA 172,20,76
s_add_u32 m0, s61, 4096
s_mov_b32 s66, 37504
buffer_load_dwordx4 v1, s[40:43], s66 offen lds
MA 176,20,80
MA 180,20,84
TR 20,58,24576
TR 22,58,25600
s_waitcnt lgkmcnt(8)
MA 184,24,76
MA 188,24,80
MA 192,24,84
TR 24,59,24576
TR 26,59,25600
s_waitcnt lgkmcnt(8)
MA 196,28,76
MA 200,28,80
MA 204,28,84
TR 28,52,40960
TR 30,52,41984
s_waitcnt lgkmcnt(8)
MA 208,32,76
MA 212,32,80
s_add_u32 m0, s61, 8192
s_mov_b32 s66, 74368
buffer_load_dwordx4 v1, s[40:43], s66 offen lds
MA 216,32,84
TR 32,53,40960
TR 34,53,41984
s_waitcnt lgkmcnt(8)
MA 220,16,76
MA 224,16,80
MA 228,16,84
TR 16,54,40960
TR 18,54,41984
s_waitcnt lgkmcnt(8)
MA 232,20,76
MA 236,20,80
MA 240,20,84
TR 20,55,40960
TR 22,55,41984
s_waitcnt lgkmcnt(8)
MA 244,24,76
MA 248,24,80
MA 252,24,84
TR 24,56,40960
TR 26,56,41984
s_waitcnt vmcnt(5)
s_barrier
s_waitcnt lgkmcnt(8)
MA 160,28,88
ds_read_b128 v[64:67], v60 offset:24576
ds_read_b128 v[76:79], v61 offset:24576
MA 164,28,92
s_add_u32 m0, s61, 49152
s_mov_b32 s66, 2363392
buffer_load_dwordx4 v0, s[44:47], s66 offen lds
MA 168,28,96
TR 28,57,40960
TR 30,57,41984
s_waitcnt lgkmcnt(10)
MA 172,32,88
s_add_u32 m0, s61, 53248
s_mov_b32 s66, 2494464
buffer_load_dwordx4 v0, s[44:47], s66 offen lds
ds_read_b128 v[68:71], v60 offset:26624
ds_read_b128 v[80:83], v61 offset:26624
MA 176,32,92
MA 180,32,96
s_add_u32 m0, s61, 73728
s_mov_b32 s66, 2625536
buffer_load_dwordx4 v0, s[44:47], s66 offen lds
TR 32,58,40960
TR 34,58,41984
s_waitcnt lgkmcnt(12)
MA 184,16,88
ds_read_b128 v[72:75], v60 offset:28672
ds_read_b128 v[84:87], v61 offset:28672
MA 188,16,92
s_add_u32 m0, s61, 77824
s_mov_b32 s66, 2756608
buffer_load_dwordx4 v0, s[44:47], s66 offen lds
MA 192,16,96
TR 16,59,40960
TR 18,59,41984
s_waitcnt lgkmcnt(14)
MA 196,20,88
MA 200,20,92
MA 204,20,96
TR 20,52,16384
TR 22,52,17408
s_waitcnt lgkmcnt(14)
MA 208,24,88
MA 212,24,92
MA 216,24,96
TR 24,53,16384
TR 26,53,17408
s_waitcnt lgkmcnt(12)
MA 220,28,88
buffer_store_dwordx4 v[120:123], v40, s[56:59], 0 offen offset:2048 sc1
MA 224,28,92
MA 228,28,96
s_add_u32 m0, s61, 12288
s_mov_b32 s66, 768
buffer_load_dwordx4 v1, s[40:43], s66 offen lds
TR 28,54,16384
TR 30,54,17408
s_waitcnt lgkmcnt(10)
MA 232,32,88
buffer_store_dwordx4 v[136:139], v40, s[56:59], s64 offen offset:2048 sc1
MA 236,32,92
MA 240,32,96
TR 32,55,16384
TR 34,55,17408
s_waitcnt lgkmcnt(8)
MA 244,16,88
MA 248,16,92
MA 252,16,96
TR 16,56,16384
TR 18,56,17408
s_waitcnt lgkmcnt(8)
MA 160,20,100
MA 164,20,104
MA 168,20,108
TR 20,57,16384
TR 22,57,17408
s_waitcnt lgkmcnt(8)
MA 172,24,100
s_add_u32 m0, s61, 16384
s_mov_b32 s66, 37632
buffer_load_dwordx4 v1, s[40:43], s66 offen lds
MA 176,24,104
MA 180,24,108
TR 24,58,16384
TR 26,58,17408
s_waitcnt lgkmcnt(8)
MA 184,28,100
MA 188,28,104
MA 192,28,108
TR 28,59,16384
TR 30,59,17408
s_waitcnt lgkmcnt(8)
MA 196,32,100
MA 200,32,104
MA 204,32,108
TR 32,52,32768
TR 34,52,33792
s_waitcnt lgkmcnt(8)
MA 208,16,100
MA 212,16,104
s_add_u32 m0, s61, 20480
s_mov_b32 s66, 74496
buffer_load_dwordx4 v1, s[40:43], s66 offen lds
MA 216,16,108
TR 16,53,32768
TR 18,53,33792
s_waitcnt lgkmcnt(8)
MA 220,20,100
MA 224,20,104
MA 228,20,108
TR 20,54,32768
TR 22,54,33792
s_waitcnt lgkmcnt(8)
MA 232,24,100
MA 236,24,104
MA 240,24,108
TR 24,55,32768
TR 26,55,33792
s_waitcnt lgkmcnt(8)
MA 244,28,100
MA 248,28,104
MA 252,28,108
TR 28,56,32768
TR 30,56,33792
s_waitcnt vmcnt(5)
s_barrier
s_waitcnt lgkmcnt(8)
MA 160,32,64
ds_read_b128 v[88:91], v60 offset:0
ds_read_b128 v[100:103], v61 offset:0
MA 164,32,68
s_add_u32 m0, s61, 40960
s_mov_b32 s66, 2887680
buffer_load_dwordx4 v0, s[44:47], s66 offen lds
MA 168,32,72
TR 32,57,32768
TR 34,57,33792
s_waitcnt lgkmcnt(10)
MA 172,16,64
s_add_u32 m0, s61, 45056
s_mov_b32 s66, 3018752
buffer_load_dwordx4 v0, s[44:47], s66 offen lds
ds_read_b128 v[92:95], v60 offset:2048
ds_read_b128 v[104:107], v61 offset:2048
MA 176,16,68
MA 180,16,72
s_add_u32 m0, s61, 65536
s_mov_b32 s66, 3149824
buffer_load_dwordx4 v0, s[44:47], s66 offen lds
TR 16,58,32768
TR 18,58,33792
s_waitcnt lgkmcnt(12)
MA 184,20,64
ds_read_b128 v[96:99], v60 offset:4096
ds_read_b128 v[108:111], v61 offset:4096
MA 188,20,68
s_add_u32 m0, s61, 69632
s_mov_b32 s66, 3280896
buffer_load_dwordx4 v0, s[44:47], s66 offen lds
MA 192,20,72
TR 20,59,32768
TR 22,59,33792
s_waitcnt lgkmcnt(14)
MA 196,24,64
MA 200,24,68
MA 204,24,72
TR 24,52,24576
TR 26,52,25600
s_waitcnt lgkmcnt(14)
MA 208,28,64
MA 212,28,68
MA 216,28,72
TR 28,53,24576
TR 30,53,25600
s_waitcnt lgkmcnt(12)
MA 220,32,64
buffer_store_dwordx4 v[152:155], v40, s[56:59], s65 offen offset:2048 sc1
MA 224,32,68
MA 228,32,72
s_add_u32 m0, s61, 24576
s_mov_b32 s66, 896
buffer_load_dwordx4 v1, s[40:43], s66 offen lds
TR 32,54,24576
TR 34,54,25600
s_waitcnt lgkmcnt(10)
MA 232,16,64
buffer_store_dwordx4 v[124:127], v40, s[56:59], 0 offen offset:3072 sc1
MA 236,16,68
MA 240,16,72
TR 16,55,24576
TR 18,55,25600
s_waitcnt lgkmcnt(8)
MA 244,20,64
MA 248,20,68
MA 252,20,72
TR 20,56,24576
TR 22,56,25600
s_waitcnt lgkmcnt(8)
MA 160,24,76
MA 164,24,80
MA 168,24,84
TR 24,57,24576
TR 26,57,25600
s_waitcnt lgkmcnt(8)
MA 172,28,76
s_add_u32 m0, s61, 28672
s_mov_b32 s66, 37760
buffer_load_dwordx4 v1, s[40:43], s66 offen lds
MA 176,28,80
MA 180,28,84
TR 28,58,24576
TR 30,58,25600
s_waitcnt lgkmcnt(8)
MA 184,32,76
MA 188,32,80
MA 192,32,84
TR 32,59,24576
TR 34,59,25600
s_waitcnt lgkmcnt(8)
MA 196,16,76
MA 200,16,80
MA 204,16,84
TR 16,52,49152
TR 18,52,50176
s_waitcnt lgkmcnt(8)
MA 208,20,76
MA 212,20,80
s_add_u32 m0, s61, 32768
s_mov_b32 s66, 74624
buffer_load_dwordx4 v1, s[40:43], s66 offen lds
MA 216,20,84
TR 20,53,49152
TR 22,53,50176
s_waitcnt lgkmcnt(8)
MA 220,24,76
MA 224,24,80
MA 228,24,84
TR 24,54,49152
TR 26,54,50176
s_waitcnt lgkmcnt(8)
MA 232,28,76
MA 236,28,80
MA 240,28,84
TR 28,55,49152
TR 30,55,50176
s_waitcnt lgkmcnt(8)
MA 244,32,76
MA 248,32,80
MA 252,32,84
TR 32,56,49152
TR 34,56,50176
s_waitcnt vmcnt(5)
s_barrier
s_waitcnt lgkmcnt(8)
MA 160,16,88
ds_read_b128 v[64:67], v60 offset:12288
ds_read_b128 v[76:79], v61 offset:12288
MA 164,16,92
s_add_u32 m0, s61, 49152
s_mov_b32 s66, 3411968
buffer_load_dwordx4 v0, s[44:47], s66 offen lds
MA 168,16,96
TR 16,57,49152
TR 18,57,50176
s_waitcnt lgkmcnt(10)
MA 172,20,88
s_add_u32 m0, s61, 53248
s_mov_b32 s66, 3543040
buffer_load_dwordx4 v0, s[44:47], s66 offen lds
ds_read_b128 v[68:71], v60 offset:14336
ds_read_b128 v[80:83], v61 offset:14336
MA 176,20,92
MA 180,20,96
s_add_u32 m0, s61, 57344
s_mov_b32 s66, 3674112
buffer_load_dwordx4 v0, s[44:47], s66 offen lds
TR 20,58,49152
TR 22,58,50176
s_waitcnt lgkmcnt(12)
MA 184,24,88
ds_read_b128 v[72:75], v60 offset:16384
ds_read_b128 v[84:87], v61 offset:16384
MA 188,24,92
s_add_u32 m0, s61, 61440
s_mov_b32 s66, 3805184
buffer_load_dwordx4 v0, s[44:47], s66 offen lds
MA 192,24,96
TR 24,59,49152
TR 26,59,50176
s_waitcnt lgkmcnt(14)
MA 196,28,88
MA 200,28,92
MA 204,28,96
TR 28,52,16384
TR 30,52,17408
s_waitcnt lgkmcnt(14)
MA 208,32,88
MA 212,32,92
MA 216,32,96
TR 32,53,16384
TR 34,53,17408
s_waitcnt lgkmcnt(12)
MA 220,16,88
buffer_store_dwordx4 v[140:143], v40, s[56:59], s64 offen offset:3072 sc1
MA 224,16,92
MA 228,16,96
s_add_u32 m0, s61, 0
s_mov_b32 s66, 1024
buffer_load_dwordx4 v1, s[40:43], s66 offen lds
TR 16,54,16384
TR 18,54,17408
s_waitcnt lgkmcnt(10)
MA 232,20,88
buffer_store_dwordx4 v[156:159], v40, s[56:59], s65 offen offset:3072 sc1
MA 236,20,92
MA 240,20,96
TR 20,55,16384
TR 22,55,17408
s_waitcnt lgkmcnt(8)
MA 244,24,88
MA 248,24,92
MA 252,24,96
TR 24,56,16384
TR 26,56,17408
s_waitcnt lgkmcnt(8)
MA 160,28,100
MA 164,28,104
MA 168,28,108
TR 28,57,16384
TR 30,57,17408
s_waitcnt lgkmcnt(8)
MA 172,32,100
s_add_u32 m0, s61, 4096
s_mov_b32 s66, 37888
buffer_load_dwordx4 v1, s[40:43], s66 offen lds
MA 176,32,104
MA 180,32,108
TR 32,58,16384
TR 34,58,17408
s_waitcnt lgkmcnt(8)
MA 184,16,100
MA 188,16,104
MA 192,16,108
TR 16,59,16384
TR 18,59,17408
s_waitcnt lgkmcnt(8)
MA 196,20,100
MA 200,20,104
MA 204,20,108
TR 20,52,40960
TR 22,52,41984
s_waitcnt lgkmcnt(8)
MA 208,24,100
MA 212,24,104
s_add_u32 m0, s61, 8192
s_mov_b32 s66, 74752
buffer_load_dwordx4 v1, s[40:43], s66 offen lds
MA 216,24,108
TR 24,53,40960
TR 26,53,41984
s_waitcnt lgkmcnt(8)
MA 220,28,100
MA 224,28,104
MA 228,28,108
TR 28,54,40960
TR 30,54,41984
s_waitcnt lgkmcnt(8)
MA 232,32,100
MA 236,32,104
MA 240,32,108
TR 32,55,40960
TR 34,55,41984
s_waitcnt lgkmcnt(8)
MA 244,16,100
MA 248,16,104
MA 252,16,108
TR 16,56,40960
TR 18,56,41984
s_waitcnt vmcnt(5)
s_barrier
s_waitcnt lgkmcnt(8)
MA 160,20,64
ds_read_b128 v[88:91], v60 offset:24576
ds_read_b128 v[100:103], v61 offset:24576
MA 164,20,68
s_add_u32 m0, s61, 40960
s_mov_b32 s66, 3936256
buffer_load_dwordx4 v0, s[44:47], s66 offen lds
MA 168,20,72
TR 20,57,40960
TR 22,57,41984
s_waitcnt lgkmcnt(10)
MA 172,24,64
s_add_u32 m0, s61, 45056
s_mov_b32 s66, 4067328
buffer_load_dwordx4 v0, s[44:47], s66 offen lds
ds_read_b128 v[92:95], v60 offset:26624
ds_read_b128 v[104:107], v61 offset:26624
MA 176,24,68
MA 180,24,72
s_add_u32 m0, s61, 73728
s_mov_b32 s66, 4198400
buffer_load_dwordx4 v0, s[44:47], s66 offen lds
TR 24,58,40960
TR 26,58,41984
s_waitcnt lgkmcnt(12)
MA 184,28,64
ds_read_b128 v[96:99], v60 offset:28672
ds_read_b128 v[108:111], v61 offset:28672
MA 188,28,68
s_add_u32 m0, s61, 77824
s_mov_b32 s66, 4329472
buffer_load_dwordx4 v0, s[44:47], s66 offen lds
MA 192,28,72
TR 28,59,40960
TR 30,59,41984
s_waitcnt lgkmcnt(14)
MA 196,32,64
MA 200,32,68
MA 204,32,72
TR 32,52,24576
TR 34,52,25600
s_waitcnt lgkmcnt(14)
MA 208,16,64
MA 212,16,68
MA 216,16,72
TR 16,53,24576
TR 18,53,25600
s_waitcnt lgkmcnt(12)
MA 220,20,64
MA 224,20,68
MA 228,20,72
TR 20,54,24576
TR 22,54,25600
s_waitcnt lgkmcnt(10)
MA 232,24,64
MA 236,24,68
s_add_u32 m0, s61, 16384
s_add_u32 s66, s98, 0
s_and_b32 s66, s66, 0x1ffff
s_add_u32 s66, s66, 2097152
buffer_load_dwordx4 v3, s[48:51], s66 offen nt lds
MA 240,24,72
TR 24,55,24576
TR 26,55,25600
s_waitcnt lgkmcnt(8)
MA 244,28,64
MA 248,28,68
MA 252,28,72
TR 28,56,24576
TR 30,56,25600
s_waitcnt lgkmcnt(8)
MA 160,32,76
MA 164,32,80
MA 168,32,84
TR 32,57,24576
TR 34,57,25600
s_waitcnt lgkmcnt(8)
MA 172,16,76
MA 176,16,80
MA 180,16,84
TR 16,58,24576
TR 18,58,25600
s_waitcnt lgkmcnt(8)
MA 184,20,76
MA 188,20,80
s_add_u32 m0, s61, 20480
s_add_u32 s66, s98, 4096
s_and_b32 s66, s66, 0x1ffff
s_add_u32 s66, s66, 2097152
buffer_load_dwordx4 v3, s[48:51], s66 offen nt lds
MA 192,20,84
TR 20,59,24576
TR 22,59,25600
s_waitcnt lgkmcnt(8)
MA 196,24,76
MA 200,24,80
MA 204,24,84
TR 24,52,32768
TR 26,52,33792
s_waitcnt lgkmcnt(8)
MA 208,28,76
MA 212,28,80
MA 216,28,84
TR 28,53,32768
TR 30,53,33792
s_waitcnt lgkmcnt(8)
MA 220,32,76
MA 224,32,80
MA 228,32,84
TR 32,54,32768
TR 34,54,33792
s_waitcnt lgkmcnt(8)
MA 232,16,76
MA 236,16,80
MA 240,16,84
TR 16,55,32768
TR 18,55,33792
s_waitcnt lgkmcnt(8)
MA 244,20,76
MA 248,20,80
MA 252,20,84
TR 20,56,32768
TR 22,56,33792
s_waitcnt vmcnt(2)
s_barrier
s_cmp_lg_u32 s62, 0
s_cbranch_scc1 L1s
s_lshl_b32 s73, s71, 2
v_mov_b32 v41, s73
v_mov_b32 v42, 1
s_mov_b64 exec, 1
global_store_dword v41, v42, s[96:97] sc0 sc1
s_mov_b64 exec, -1
L1s:
s_waitcnt lgkmcnt(8)
MA 160,24,88
ds_read_b128 v[64:67], v60 offset:0
ds_read_b128 v[76:79], v61 offset:0
MA 164,24,92
s_add_u32 m0, s61, 49152
s_mov_b32 s66, 4460544
buffer_load_dwordx4 v0, s[44:47], s66 offen lds
MA 168,24,96
TR 24,57,32768
TR 26,57,33792
s_waitcnt lgkmcnt(10)
MA 172,28,88
s_add_u32 m0, s61, 53248
s_mov_b32 s66, 4591616
buffer_load_dwordx4 v0, s[44:47], s66 offen lds
ds_read_b128 v[68:71], v60 offset:2048
ds_read_b128 v[80:83], v61 offset:2048
MA 176,28,92
MA 180,28,96
TR 28,58,32768
TR 30,58,33792
s_waitcnt lgkmcnt(12)
MA 184,32,88
ds_read_b128 v[72:75], v60 offset:4096
ds_read_b128 v[84:87], v61 offset:4096
MA 188,32,92
MA 192,32,96
TR 32,59,32768
TR 34,59,33792
s_waitcnt lgkmcnt(14)
MA 196,16,88
MA 200,16,92
MA 204,16,96
TR 16,52,16384
TR 18,52,17408
s_waitcnt lgkmcnt(14)
MA 208,20,88
MA 212,20,92
MA 216,20,96
TR 20,53,16384
TR 22,53,17408
s_waitcnt lgkmcnt(12)
MA 220,24,88
s_add_u32 m0, s61, 24576
s_add_u32 s66, s98, 8192
s_and_b32 s66, s66, 0x1ffff
s_add_u32 s66, s66, 2097152
buffer_load_dwordx4 v3, s[48:51], s66 offen nt lds
MA 224,24,92
MA 228,24,96
TR 24,54,16384
TR 26,54,17408
s_waitcnt lgkmcnt(10)
MA 232,28,88
MA 236,28,92
MA 240,28,96
TR 28,55,16384
TR 30,55,17408
s_waitcnt lgkmcnt(8)
MA 244,32,88
MA 248,32,92
MA 252,32,96
TR 32,56,16384
TR 34,56,17408
s_waitcnt lgkmcnt(8)
MA 160,16,100
MA 164,16,104
MA 168,16,108
TR 16,57,16384
TR 18,57,17408
s_waitcnt lgkmcnt(8)
MA 172,20,100
s_add_u32 m0, s61, 28672
s_add_u32 s66, s98, 12288
s_and_b32 s66, s66, 0x1ffff
s_add_u32 s66, s66, 2097152
buffer_load_dwordx4 v3, s[48:51], s66 offen nt lds
MA 176,20,104
MA 180,20,108
TR 20,58,16384
TR 22,58,17408
s_waitcnt lgkmcnt(8)
MA 184,24,100
MA 188,24,104
MA 192,24,108
TR 24,59,16384
TR 26,59,17408
s_waitcnt lgkmcnt(8)
MA 196,28,100
MA 200,28,104
MA 204,28,108
TR 28,52,49152
TR 30,52,50176
s_waitcnt lgkmcnt(8)
MA 208,32,100
MA 212,32,104
MA 216,32,108
TR 32,53,49152
TR 34,53,50176
s_waitcnt lgkmcnt(8)
MA 220,16,100
s_add_u32 m0, s61, 65536
s_add_u32 s66, s98, 0
s_and_b32 s66, s66, 0x1ffff
s_add_u32 s66, s66, 2097152
buffer_load_dwordx4 v2, s[52:55], s66 offen nt lds
MA 224,16,104
MA 228,16,108
TR 16,54,49152
TR 18,54,50176
s_waitcnt lgkmcnt(8)
MA 232,20,100
MA 236,20,104
MA 240,20,108
TR 20,55,49152
TR 22,55,50176
s_waitcnt lgkmcnt(8)
MA 244,24,100
MA 248,24,104
MA 252,24,108
TR 24,56,49152
TR 26,56,50176
s_waitcnt vmcnt(3)
s_barrier
s_waitcnt lgkmcnt(8)
MA 160,28,64
s_add_u32 m0, s61, 69632
s_add_u32 s66, s98, 4096
s_and_b32 s66, s66, 0x1ffff
s_add_u32 s66, s66, 2097152
buffer_load_dwordx4 v2, s[52:55], s66 offen nt lds
MA 164,28,68
MA 168,28,72
TR 28,57,49152
TR 30,57,50176
s_waitcnt lgkmcnt(8)
MA 172,32,64
MA 176,32,68
MA 180,32,72
TR 32,58,49152
TR 34,58,50176
s_waitcnt lgkmcnt(8)
MA 184,16,64
MA 188,16,68
MA 192,16,72
TR 16,59,49152
TR 18,59,50176
s_waitcnt lgkmcnt(8)
MA 196,20,64
MA 200,20,68
MA 204,20,72
TR 20,52,24576
TR 22,52,25600
s_waitcnt lgkmcnt(8)
MA 208,24,64
s_add_u32 m0, s61, 32768
s_add_u32 s66, s98, 16384
s_and_b32 s66, s66, 0x1ffff
s_add_u32 s66, s66, 2097152
buffer_load_dwordx4 v3, s[48:51], s66 offen nt lds
MA 212,24,68
MA 216,24,72
TR 24,53,24576
TR 26,53,25600
s_waitcnt lgkmcnt(8)
MA 220,28,64
MA 224,28,68
MA 228,28,72
TR 28,54,24576
TR 30,54,25600
s_waitcnt lgkmcnt(8)
MA 232,32,64
MA 236,32,68
MA 240,32,72
TR 32,55,24576
TR 34,55,25600
s_waitcnt lgkmcnt(8)
MA 244,16,64
MA 248,16,68
MA 252,16,72
TR 16,56,24576
TR 18,56,25600
s_waitcnt lgkmcnt(8)
MA 160,20,76
s_add_u32 m0, s61, 36864
s_add_u32 s66, s98, 20480
s_and_b32 s66, s66, 0x1ffff
s_add_u32 s66, s66, 2097152
buffer_load_dwordx4 v3, s[48:51], s66 offen nt lds
MA 164,20,80
MA 168,20,84
TR 20,57,24576
TR 22,57,25600
s_waitcnt lgkmcnt(8)
MA 172,24,76
MA 176,24,80
MA 180,24,84
TR 24,58,24576
v_pk_mul_f32 v[160:161], v[160:161], s[68:69]
TR 26,58,25600
v_pk_mul_f32 v[162:163], v[162:163], s[68:69]
s_waitcnt lgkmcnt(8)
MA 184,28,76
MA 188,28,80
v_pk_mul_f32 v[172:173], v[172:173], s[68:69]
v_pk_mul_f32 v[174:175], v[174:175], s[68:69]
v_cvt_pk_bf16_f32 v112, v160, v161
MA 192,28,84
TR 28,59,24576
v_cvt_pk_bf16_f32 v113, v162, v163
TR 30,59,25600
v_cvt_pk_bf16_f32 v114, v172, v173
v_cvt_pk_bf16_f32 v115, v174, v175
s_waitcnt lgkmcnt(8)
MA 196,32,76
v_pk_mul_f32 v[164:165], v[164:165], s[68:69]
v_pk_mul_f32 v[166:167], v[166:167], s[68:69]
v_pk_mul_f32 v[176:177], v[176:177], s[68:69]
MA 200,32,80
v_pk_mul_f32 v[178:179], v[178:179], s[68:69]
v_cvt_pk_bf16_f32 v128, v164, v165
v_cvt_pk_bf16_f32 v129, v166, v167
MA 204,32,84
ds_read_b128 v[32:35], v4 offset:16384
v_cvt_pk_bf16_f32 v130, v176, v177
v_cvt_pk_bf16_f32 v131, v178, v179
v_pk_mul_f32 v[168:169], v[168:169], s[68:69]
s_waitcnt lgkmcnt(7)
MA 208,16,76
s_add_u32 m0, s61, 40960
s_add_u32 s66, s98, 8192
s_and_b32 s66, s66, 0x1ffff
s_add_u32 s66, s66, 2097152
buffer_load_dwordx4 v2, s[52:55], s66 offen nt lds
v_pk_mul_f32 v[170:171], v[170:171], s[68:69]
v_pk_mul_f32 v[180:181], v[180:181], s[68:69]
v_pk_mul_f32 v[182:183], v[182:183], s[68:69]
MA 212,16,80
v_cvt_pk_bf16_f32 v144, v168, v169
v_cvt_pk_bf16_f32 v145, v170, v171
v_cvt_pk_bf16_f32 v146, v180, v181
MA 216,16,84
ds_read_b128 v[16:19], v4 offset:20480
v_cvt_pk_bf16_f32 v147, v182, v183
v_permlane32_swap_b32 v112, v114
v_permlane32_swap_b32 v113, v115
s_waitcnt lgkmcnt(6)
MA 220,20,76
v_permlane32_swap_b32 v128, v130
v_permlane32_swap_b32 v129, v131
v_permlane32_swap_b32 v144, v146
MA 224,20,80
v_permlane32_swap_b32 v145, v147
v_permlane16_swap_b32 v112, v114
v_permlane16_swap_b32 v113, v115
MA 228,20,84
ds_read_b128 v[20:23], v5 offset:16384
v_permlane16_swap_b32 v128, v130
v_permlane16_swap_b32 v129, v131
v_permlane16_swap_b32 v144, v146
s_waitcnt lgkmcnt(5)
MA 232,24,76
v_permlane16_swap_b32 v145, v147
v_pk_mul_f32 v[184:185], v[184:185], s[68:69]
v_pk_mul_f32 v[186:187], v[186:187], s[68:69]
MA 236,24,80
v_pk_mul_f32 v[196:197], v[196:197], s[68:69]
v_pk_mul_f32 v[198:199], v[198:199], s[68:69]
v_cvt_pk_bf16_f32 v116, v184, v185
MA 240,24,84
ds_read_b128 v[24:27], v5 offset:20480
v_cvt_pk_bf16_f32 v117, v186, v187
v_cvt_pk_bf16_f32 v118, v196, v197
v_cvt_pk_bf16_f32 v119, v198, v199
s_waitcnt lgkmcnt(4)
MA 244,28,76
v_pk_mul_f32 v[188:189], v[188:189], s[68:69]
v_pk_mul_f32 v[190:191], v[190:191], s[68:69]
v_pk_mul_f32 v[200:201], v[200:201], s[68:69]
MA 248,28,80
v_pk_mul_f32 v[202:203], v[202:203], s[68:69]
v_cvt_pk_bf16_f32 v132, v188, v189
v_cvt_pk_bf16_f32 v133, v190, v191
MA 252,28,84
ds_read_b128 v[28:31], v6 offset:16384
v_cvt_pk_bf16_f32 v134, v200, v201
v_cvt_pk_bf16_f32 v135, v202, v203
v_pk_mul_f32 v[192:193], v[192:193], s[68:69]
s_waitcnt vmcnt(3)
s_barrier
s_waitcnt lgkmcnt(4)
MZ 64,32,112
s_add_u32 m0, s61, 45056
s_add_u32 s66, s98, 12288
s_and_b32 s66, s66, 0x1ffff
s_add_u32 s66, s66, 2097152
buffer_load_dwordx4 v2, s[52:55], s66 offen nt lds
v_pk_mul_f32 v[194:195], v[194:195], s[68:69]
v_pk_mul_f32 v[204:205], v[204:205], s[68:69]
v_pk_mul_f32 v[206:207], v[206:207], s[68:69]
MZ 68,32,128
v_cvt_pk_bf16_f32 v148, v192, v193
v_cvt_pk_bf16_f32 v149, v194, v195
v_cvt_pk_bf16_f32 v150, v204, v205
MZ 72,32,144
ds_read_b128 v[32:35], v6 offset:20480
v_cvt_pk_bf16_f32 v151, v206, v207
v_permlane32_swap_b32 v116, v118
v_permlane32_swap_b32 v117, v119
s_waitcnt lgkmcnt(4)
MZ 76,16,112
v_permlane32_swap_b32 v132, v134
v_permlane32_swap_b32 v133, v135
v_permlane32_swap_b32 v148, v150
MZ 80,16,128
v_permlane32_swap_b32 v149, v151
v_permlane16_swap_b32 v116, v118
v_permlane16_swap_b32 v117, v119
MZ 84,16,144
ds_read_b128 v[16:19], v7 offset:16384
v_permlane16_swap_b32 v132, v134
v_permlane16_swap_b32 v133, v135
v_permlane16_swap_b32 v148, v150
v_permlane16_swap_b32 v149, v151
s_waitcnt lgkmcnt(4)
MA 64,20,116
v_pk_mul_f32 v[208:209], v[208:209], s[68:69]
v_pk_mul_f32 v[210:211], v[210:211], s[68:69]
v_pk_mul_f32 v[220:221], v[220:221], s[68:69]
MA 68,20,132
v_pk_mul_f32 v[222:223], v[222:223], s[68:69]
v_cvt_pk_bf16_f32 v120, v208, v209
v_cvt_pk_bf16_f32 v121, v210, v211
MA 72,20,148
ds_read_b128 v[20:23], v7 offset:20480
v_cvt_pk_bf16_f32 v122, v220, v221
v_cvt_pk_bf16_f32 v123, v222, v223
v_pk_mul_f32 v[212:213], v[212:213], s[68:69]
s_waitcnt lgkmcnt(4)
MA 76,24,116
v_pk_mul_f32 v[214:215], v[214:215], s[68:69]
v_pk_mul_f32 v[224:225], v[224:225], s[68:69]
v_pk_mul_f32 v[226:227], v[226:227], s[68:69]
MA 80,24,132
v_cvt_pk_bf16_f32 v136, v212, v213
v_cvt_pk_bf16_f32 v137, v214, v215
v_cvt_pk_bf16_f32 v138, v224, v225
MA 84,24,148
ds_read_b128 v[24:27], v4 offset:24576
v_cvt_pk_bf16_f32 v139, v226, v227
v_pk_mul_f32 v[216:217], v[216:217], s[68:69]
v_pk_mul_f32 v[218:219], v[218:219], s[68:69]
v_pk_mul_f32 v[228:229], v[228:229], s[68:69]
v_pk_mul_f32 v[230:231], v[230:231], s[68:69]
v_cvt_pk_bf16_f32 v152, v216, v217
v_cvt_pk_bf16_f32 v153, v218, v219
v_cvt_pk_bf16_f32 v154, v228, v229
v_cvt_pk_bf16_f32 v155, v230, v231
v_permlane32_swap_b32 v120, v122
v_permlane32_swap_b32 v121, v123
v_permlane32_swap_b32 v136, v138
v_permlane32_swap_b32 v137, v139
v_permlane32_swap_b32 v152, v154
v_permlane32_swap_b32 v153, v155
v_permlane16_swap_b32 v120, v122
v_permlane16_swap_b32 v121, v123
v_permlane16_swap_b32 v136, v138
v_permlane16_swap_b32 v137, v139
v_permlane16_swap_b32 v152, v154
v_permlane16_swap_b32 v153, v155
s_waitcnt lgkmcnt(4)
MA 64,28,120
s_add_u32 m0, s61, 0
s_add_u32 s66, s98, 24576
s_and_b32 s66, s66, 0x1ffff
s_waitcnt vmcnt(2)
s_add_u32 s66, s66, 2097152
buffer_load_dwordx4 v3, s[48:51], s66 offen nt lds
v_pk_mul_f32 v[232:233], v[232:233], s[68:69]
v_pk_mul_f32 v[234:235], v[234:235], s[68:69]
v_pk_mul_f32 v[244:245], v[244:245], s[68:69]
MA 68,28,136
v_pk_mul_f32 v[246:247], v[246:247], s[68:69]
v_cvt_pk_bf16_f32 v124, v232, v233
v_cvt_pk_bf16_f32 v125, v234, v235
MA 72,28,152
ds_read_b128 v[28:31], v5 offset:24576
v_cvt_pk_bf16_f32 v126, v244, v245
v_cvt_pk_bf16_f32 v127, v246, v247
v_pk_mul_f32 v[236:237], v[236:237], s[68:69]
s_waitcnt lgkmcnt(4)
MA 76,32,120
v_pk_mul_f32 v[238:239], v[238:239], s[68:69]
v_pk_mul_f32 v[248:249], v[248:249], s[68:69]
v_pk_mul_f32 v[250:251], v[250:251], s[68:69]
MA 80,32,136
v_cvt_pk_bf16_f32 v140, v236, v237
v_cvt_pk_bf16_f32 v141, v238, v239
v_cvt_pk_bf16_f32 v142, v248, v249
MA 84,32,152
ds_read_b128 v[32:35], v6 offset:24576
v_cvt_pk_bf16_f32 v143, v250, v251
v_pk_mul_f32 v[240:241], v[240:241], s[68:69]
v_pk_mul_f32 v[242:243], v[242:243], s[68:69]
v_pk_mul_f32 v[252:253], v[252:253], s[68:69]
v_pk_mul_f32 v[254:255], v[254:255], s[68:69]
v_cvt_pk_bf16_f32 v156, v240, v241
v_cvt_pk_bf16_f32 v157, v242, v243
v_cvt_pk_bf16_f32 v158, v252, v253
v_cvt_pk_bf16_f32 v159, v254, v255
v_permlane32_swap_b32 v124, v126
v_permlane32_swap_b32 v125, v127
v_permlane32_swap_b32 v140, v142
v_permlane32_swap_b32 v141, v143
v_permlane32_swap_b32 v156, v158
v_permlane32_swap_b32 v157, v159
v_permlane16_swap_b32 v124, v126
v_permlane16_swap_b32 v125, v127
v_permlane16_swap_b32 v140, v142
v_permlane16_swap_b32 v141, v143
v_permlane16_swap_b32 v156, v158
v_permlane16_swap_b32 v157, v159
s_waitcnt lgkmcnt(4)
MA 64,16,124
MA 68,16,140
MA 72,16,156
ds_read_b128 v[16:19], v7 offset:24576
s_waitcnt lgkmcnt(4)
MA 76,20,124
MA 80,20,140
MA 84,20,156
ds_read_b128 v[20:23], v4 offset:28672
s_waitcnt lgkmcnt(4)
MZ 88,24,112
s_add_u32 m0, s61, 4096
s_add_u32 s66, s98, 28672
s_and_b32 s66, s66, 0x1ffff
s_waitcnt vmcnt(2)
s_add_u32 s66, s66, 2097152
buffer_load_dwordx4 v3, s[48:51], s66 offen nt lds
v_max3_f32 v53, v64, v65, v66
MZ 92,24,128
MZ 96,24,144
ds_read_b128 v[24:27], v5 offset:28672
v_max3_f32 v53, v53, v67, v76
v_max3_f32 v53, v53, v77, v78
v_max_f32 v53, v53, v79
s_waitcnt lgkmcnt(4)
MA 88,28,116
v_max3_f32 v57, v68, v69, v70
v_max3_f32 v57, v57, v71, v80
v_max3_f32 v57, v57, v81, v82
MA 92,28,132
v_max_f32 v57, v57, v83
v_max3_f32 v61, v72, v73, v74
v_max3_f32 v61, v61, v75, v84
MA 96,28,148
ds_read_b128 v[28:31], v6 offset:28672
v_max3_f32 v61, v61, v85, v86
v_max_f32 v61, v61, v87
v_mov_b32 v54, v53
s_waitcnt lgkmcnt(4)
MA 88,32,120
MA 92,32,136
v_permlane32_swap_b32 v53, v54
v_max_f32 v53, v53, v54
v_mov_b32 v54, v53
MA 96,32,152
ds_read_b128 v[32:35], v7 offset:28672
v_permlane16_swap_b32 v53, v54
v_max_f32 v53, v53, v54
v_mov_b32 v58, v57
s_waitcnt lgkmcnt(4)
MA 88,16,124
MA 92,16,140
v_permlane32_swap_b32 v57, v58
v_max_f32 v57, v57, v58
v_mov_b32 v58, v57
MA 96,16,156
TR 16,8,24576
v_permlane16_swap_b32 v57, v58
TR 18,8,28672
v_max_f32 v57, v57, v58
v_mov_b32 v62, v61
s_waitcnt lgkmcnt(5)
MZ 100,20,112
s_add_u32 m0, s61, 57344
s_add_u32 s66, s98, 16384
s_and_b32 s66, s66, 0x1ffff
s_add_u32 s66, s66, 2097152
buffer_load_dwordx4 v2, s[52:55], s66 offen nt lds
MZ 104,20,128
v_permlane32_swap_b32 v61, v62
v_max_f32 v61, v61, v62
v_mov_b32 v62, v61
MZ 108,20,144
TR 20,9,24576
v_permlane16_swap_b32 v61, v62
TR 22,9,28672
v_max_f32 v61, v61, v62
v_sub_f32 v52, 0, v53
s_waitcnt lgkmcnt(6)
MA 100,24,116
v_mov_b32 v53, v52
v_mov_b32 v54, v52
v_mov_b32 v55, v52
MA 104,24,132
v_sub_f32 v56, 0, v57
v_mov_b32 v57, v56
v_mov_b32 v58, v56
MA 108,24,148
TR 24,10,24576
v_mov_b32 v59, v56
TR 26,10,28672
v_sub_f32 v60, 0, v61
v_mov_b32 v61, v60
s_waitcnt lgkmcnt(7)
MA 100,28,120
v_mov_b32 v62, v60
v_mov_b32 v63, v60
v_add_f32 v64, v52, v64
MA 104,28,136
v_exp_f32 v64, v64
v_add_f32 v65, v52, v65
MA 108,28,152
TR 28,11,24576
v_exp_f32 v65, v65
TR 30,11,28672
v_cvt_pk_bf16_f32 v64, v64, v65
s_waitcnt lgkmcnt(8)
MA 100,32,124
v_add_f32 v66, v52, v66
v_exp_f32 v66, v66
MA 104,32,140
v_add_f32 v67, v52, v67
v_exp_f32 v67, v67
MA 108,32,156
TR 32,12,24576
v_cvt_pk_bf16_f32 v65, v66, v67
TR 34,12,28672
v_add_f32 v76, v52, v76
v_exp_f32 v76, v76
v_add_f32 v77, v52, v77
v_exp_f32 v77, v77
s_nop 0
v_cvt_pk_bf16_f32 v66, v76, v77
v_add_f32 v78, v52, v78
v_exp_f32 v78, v78
v_add_f32 v79, v52, v79
v_exp_f32 v79, v79
s_nop 0
v_cvt_pk_bf16_f32 v67, v78, v79
v_add_f32 v68, v56, v68
v_exp_f32 v68, v68
v_add_f32 v69, v56, v69
v_exp_f32 v69, v69
s_nop 0
v_cvt_pk_bf16_f32 v68, v68, v69
v_add_f32 v70, v56, v70
v_exp_f32 v70, v70
v_add_f32 v71, v56, v71
v_exp_f32 v71, v71
s_nop 0
v_cvt_pk_bf16_f32 v69, v70, v71
v_add_f32 v80, v56, v80
v_exp_f32 v80, v80
v_add_f32 v81, v56, v81
v_exp_f32 v81, v81
s_nop 0
v_cvt_pk_bf16_f32 v70, v80, v81
v_add_f32 v82, v56, v82
v_exp_f32 v82, v82
v_add_f32 v83, v56, v83
v_exp_f32 v83, v83
s_nop 0
v_cvt_pk_bf16_f32 v71, v82, v83
v_add_f32 v72, v60, v72
v_exp_f32 v72, v72
v_add_f32 v73, v60, v73
v_exp_f32 v73, v73
s_nop 0
v_cvt_pk_bf16_f32 v72, v72, v73
v_add_f32 v74, v60, v74
v_exp_f32 v74, v74
v_add_f32 v75, v60, v75
v_exp_f32 v75, v75
s_nop 0
v_cvt_pk_bf16_f32 v73, v74, v75
v_add_f32 v84, v60, v84
v_exp_f32 v84, v84
v_add_f32 v85, v60, v85
v_exp_f32 v85, v85
s_nop 0
v_cvt_pk_bf16_f32 v74, v84, v85
v_add_f32 v86, v60, v86
v_exp_f32 v86, v86
v_add_f32 v87, v60, v87
v_exp_f32 v87, v87
s_nop 0
v_cvt_pk_bf16_f32 v75, v86, v87
s_waitcnt vmcnt(3)
s_barrier
MZ 40,36,64
s_add_u32 m0, s61, 61440
s_add_u32 s66, s98, 20480
s_and_b32 s66, s66, 0x1ffff
s_add_u32 s66, s66, 2097152
buffer_load_dwordx4 v2, s[52:55], s66 offen nt lds
v_add_f32 v88, v52, v88
v_exp_f32 v88, v88
MZ 44,36,68
v_add_f32 v89, v52, v89
v_exp_f32 v89, v89
MZ 48,36,72
v_cvt_pk_bf16_f32 v88, v88, v89
v_add_f32 v90, v52, v90
s_waitcnt lgkmcnt(8)
MZ 160,16,64
v_exp_f32 v90, v90
v_add_f32 v91, v52, v91
MZ 164,16,68
v_exp_f32 v91, v91
MZ 168,16,72
TR 16,13,24576
v_cvt_pk_bf16_f32 v89, v90, v91
TR 18,13,28672
v_add_f32 v100, v52, v100
v_exp_f32 v100, v100
s_waitcnt lgkmcnt(8)
MZ 172,20,64
v_add_f32 v101, v52, v101
v_exp_f32 v101, v101
MZ 176,20,68
v_cvt_pk_bf16_f32 v90, v100, v101
v_add_f32 v102, v52, v102
MZ 180,20,72
TR 20,14,24576
v_exp_f32 v102, v102
TR 22,14,28672
v_add_f32 v103, v52, v103
s_waitcnt lgkmcnt(8)
MZ 184,24,64
v_exp_f32 v103, v103
MZ 188,24,68
v_cvt_pk_bf16_f32 v91, v102, v103
v_add_f32 v92, v56, v92
v_exp_f32 v92, v92
MZ 192,24,72
TR 24,15,24576
v_add_f32 v93, v56, v93
TR 26,15,28672
v_exp_f32 v93, v93
s_waitcnt lgkmcnt(8)
MZ 196,28,64
s_add_u32 m0, s61, 8192
s_add_u32 s66, s98, 32768
s_and_b32 s66, s66, 0x1ffff
s_waitcnt vmcnt(2)
s_add_u32 s66, s66, 2097152
buffer_load_dwordx4 v3, s[48:51], s66 offen nt lds
v_cvt_pk_bf16_f32 v92, v92, v93
v_add_f32 v94, v56, v94
MZ 200,28,68
v_exp_f32 v94, v94
v_add_f32 v95, v56, v95
MZ 204,28,72
ds_read_b128 v[28:31], v4 offset:32768
v_exp_f32 v95, v95
s_waitcnt lgkmcnt(7)
MZ 208,32,64
v_cvt_pk_bf16_f32 v93, v94, v95
v_add_f32 v104, v56, v104
v_exp_f32 v104, v104
MZ 212,32,68
v_add_f32 v105, v56, v105
v_exp_f32 v105, v105
MZ 216,32,72
ds_read_b128 v[32:35], v5 offset:32768
v_cvt_pk_bf16_f32 v94, v104, v105
v_add_f32 v106, v56, v106
s_waitcnt lgkmcnt(6)
MZ 220,16,64
v_exp_f32 v106, v106
v_add_f32 v107, v56, v107
MZ 224,16,68
v_exp_f32 v107, v107
MZ 228,16,72
ds_read_b128 v[16:19], v6 offset:32768
v_cvt_pk_bf16_f32 v95, v106, v107
v_add_f32 v96, v60, v96
v_exp_f32 v96, v96
s_waitcnt lgkmcnt(5)
MZ 232,20,64
v_add_f32 v97, v60, v97
v_exp_f32 v97, v97
MZ 236,20,68
v_cvt_pk_bf16_f32 v96, v96, v97
v_add_f32 v98, v60, v98
MZ 240,20,72
ds_read_b128 v[20:23], v7 offset:32768
v_exp_f32 v98, v98
v_add_f32 v99, v60, v99
s_waitcnt lgkmcnt(4)
MZ 244,24,64
s_add_u32 m0, s61, 12288
s_add_u32 s66, s98, 36864
s_and_b32 s66, s66, 0x1ffff
s_waitcnt vmcnt(2)
s_add_u32 s66, s66, 2097152
buffer_load_dwordx4 v3, s[48:51], s66 offen nt lds
v_exp_f32 v99, v99
MZ 248,24,68
v_cvt_pk_bf16_f32 v97, v98, v99
v_add_f32 v108, v60, v108
v_exp_f32 v108, v108
MZ 252,24,72
ds_read_b128 v[24:27], v4 offset:36864
v_add_f32 v109, v60, v109
v_exp_f32 v109, v109
s_waitcnt lgkmcnt(4)
MC 64,28,112,52
v_cvt_pk_bf16_f32 v98, v108, v109
v_add_f32 v110, v60, v110
MC 68,28,128,56
v_exp_f32 v110, v110
v_add_f32 v111, v60, v111
MC 72,28,144,60
ds_read_b128 v[28:31], v5 offset:36864
v_exp_f32 v111, v111
s_waitcnt lgkmcnt(4)
MA 64,32,116
v_cvt_pk_bf16_f32 v99, v110, v111
MA 68,32,132
MA 72,32,148
ds_read_b128 v[32:35], v6 offset:36864
s_waitcnt lgkmcnt(4)
MA 64,16,120
MA 68,16,136
MA 72,16,152
ds_read_b128 v[16:19], v7 offset:36864
s_waitcnt lgkmcnt(4)
MA 64,20,124
s_add_u32 m0, s61, 49152
s_add_u32 s66, s98, 24576
s_and_b32 s66, s66, 0x1ffff
s_waitcnt vmcnt(2)
s_add_u32 s66, s66, 2097152
buffer_load_dwordx4 v2, s[52:55], s66 offen nt lds
MA 68,20,140
MA 72,20,156
TR 20,8,0
TR 22,8,4096
s_waitcnt lgkmcnt(5)
MC 76,24,112,52
MC 80,24,128,56
MC 84,24,144,60
TR 24,9,0
v_exp_f32 v64, v64
TR 26,9,4096
v_exp_f32 v65, v65
s_waitcnt lgkmcnt(6)
MA 76,28,116
v_cvt_pk_bf16_f32 v64, v64, v65
v_exp_f32 v66, v66
MA 80,28,132
v_exp_f32 v67, v67
MA 84,28,148
TR 28,10,0
v_cvt_pk_bf16_f32 v65, v66, v67
TR 30,10,4096
s_waitcnt lgkmcnt(7)
MA 76,32,120
MA 80,32,136
MA 84,32,152
TR 32,11,0
TR 34,11,4096
s_waitcnt lgkmcnt(8)
MA 76,16,124
s_add_u32 m0, s61, 53248
s_add_u32 s66, s98, 28672
s_and_b32 s66, s66, 0x1ffff
s_waitcnt vmcnt(2)
s_add_u32 s66, s66, 2097152
buffer_load_dwordx4 v2, s[52:55], s66 offen nt lds
MA 80,16,140
MA 84,16,156
TR 16,12,0
TR 18,12,4096
s_waitcnt vmcnt(4)
s_barrier
MA 40,36,88
MA 44,36,92
v_exp_f32 v76, v76
MA 48,36,96
v_exp_f32 v77, v77
s_waitcnt lgkmcnt(8)
MA 160,20,88
v_cvt_pk_bf16_f32 v66, v76, v77
v_exp_f32 v78, v78
MA 164,20,92
v_exp_f32 v79, v79
MA 168,20,96
TR 20,13,0
v_cvt_pk_bf16_f32 v67, v78, v79
TR 22,13,4096
s_waitcnt lgkmcnt(8)
MA 172,24,88
v_exp_f32 v68, v68
MA 176,24,92
v_exp_f32 v69, v69
MA 180,24,96
TR 24,14,0
v_cvt_pk_bf16_f32 v68, v68, v69
TR 26,14,4096
v_exp_f32 v70, v70
s_waitcnt lgkmcnt(8)
MA 184,28,88
v_exp_f32 v71, v71
MA 188,28,92
v_cvt_pk_bf16_f32 v69, v70, v71
MA 192,28,96
s_add_u32 m0, s61, 16384
s_add_u32 s66, s98, 40960
s_and_b32 s66, s66, 0x1ffff
s_waitcnt vmcnt(2)
s_add_u32 s66, s66, 2097152
buffer_load_dwordx4 v3, s[48:51], s66 offen nt lds
TR 28,15,0
v_exp_f32 v80, v80
TR 30,15,4096
s_waitcnt lgkmcnt(8)
MA 196,32,88
v_exp_f32 v81, v81
MA 200,32,92
v_cvt_pk_bf16_f32 v70, v80, v81
v_exp_f32 v82, v82
MA 204,32,96
ds_read_b128 v[32:35], v4 offset:0
v_exp_f32 v83, v83
s_waitcnt lgkmcnt(7)
MA 208,16,88
v_cvt_pk_bf16_f32 v71, v82, v83
MA 212,16,92
v_exp_f32 v72, v72
MA 216,16,96
ds_read_b128 v[16:19], v5 offset:0
v_exp_f32 v73, v73
s_waitcnt lgkmcnt(6)
MA 220,20,88
v_cvt_pk_bf16_f32 v72, v72, v73
v_exp_f32 v74, v74
MA 224,20,92
v_exp_f32 v75, v75
MA 228,20,96
ds_read_b128 v[20:23], v6 offset:0
v_cvt_pk_bf16_f32 v73, v74, v75
s_waitcnt lgkmcnt(5)
MA 232,24,88
v_exp_f32 v84, v84
MA 236,24,92
v_exp_f32 v85, v85
MA 240,24,96
s_add_u32 m0, s61, 20480
s_add_u32 s66, s98, 45056
s_and_b32 s66, s66, 0x1ffff
s_waitcnt vmcnt(2)
s_add_u32 s66, s66, 2097152
buffer_load_dwordx4 v3, s[48:51], s66 offen nt lds
ds_read_b128 v[24:27], v7 offset:0
v_cvt_pk_bf16_f32 v74, v84, v85
v_exp_f32 v86, v86
s_waitcnt lgkmcnt(4)
MA 244,28,88
v_exp_f32 v87, v87
MA 248,28,92
v_cvt_pk_bf16_f32 v75, v86, v87
MA 252,28,96
ds_read_b128 v[28:31], v4 offset:4096
s_waitcnt lgkmcnt(4)
MC 88,32,112,52
MC 92,32,128,56
MC 96,32,144,60
ds_read_b128 v[32:35], v5 offset:4096
s_waitcnt lgkmcnt(4)
MA 88,16,116
MA 92,16,132
MA 96,16,148
ds_read_b128 v[16:19], v6 offset:4096
s_waitcnt lgkmcnt(4)
MA 88,20,120
MA 92,20,136
MA 96,20,152
s_add_u32 m0, s61, 73728
s_add_u32 s66, s98, 32768
s_and_b32 s66, s66, 0x1ffff
s_waitcnt vmcnt(1)
s_add_u32 s66, s66, 2097152
buffer_load_dwordx4 v2, s[52:55], s66 offen nt lds
ds_read_b128 v[20:23], v7 offset:4096
s_waitcnt lgkmcnt(4)
MA 88,24,124
MA 92,24,140
MA 96,24,156
TR 24,8,16384
TR 26,8,20480
s_waitcnt lgkmcnt(5)
MC 100,28,112,52
MC 104,28,128,56
MC 108,28,144,60
TR 28,9,16384
v_exp_f32 v88, v88
TR 30,9,20480
s_waitcnt lgkmcnt(6)
MA 100,32,116
v_exp_f32 v89, v89
MA 104,32,132
v_cvt_pk_bf16_f32 v88, v88, v89
v_exp_f32 v90, v90
MA 108,32,148
TR 32,10,16384
v_exp_f32 v91, v91
TR 34,10,20480
s_waitcnt lgkmcnt(7)
MA 100,16,120
v_cvt_pk_bf16_f32 v89, v90, v91
MA 104,16,136
MA 108,16,152
s_add_u32 m0, s61, 77824
s_add_u32 s66, s98, 36864
s_and_b32 s66, s66, 0x1ffff
s_waitcnt vmcnt(2)
s_add_u32 s66, s66, 2097152
buffer_load_dwordx4 v2, s[52:55], s66 offen nt lds
TR 16,11,16384
TR 18,11,20480
s_waitcnt lgkmcnt(8)
MA 100,20,124
MA 104,20,140
MA 108,20,156
TR 20,12,16384
TR 22,12,20480
s_waitcnt vmcnt(4)
s_barrier
MA 40,36,64
MA 44,36,68
MA 48,36,72
v_exp_f32 v100, v100
s_waitcnt lgkmcnt(8)
MA 160,24,64
v_exp_f32 v101, v101
MA 164,24,68
v_cvt_pk_bf16_f32 v90, v100, v101
v_exp_f32 v102, v102
MA 168,24,72
TR 24,13,16384
v_exp_f32 v103, v103
TR 26,13,20480
s_waitcnt lgkmcnt(8)
MA 172,28,64
v_cvt_pk_bf16_f32 v91, v102, v103
MA 176,28,68
v_exp_f32 v92, v92
MA 180,28,72
TR 28,14,16384
v_exp_f32 v93, v93
TR 30,14,20480
s_waitcnt lgkmcnt(8)
MA 184,32,64
v_cvt_pk_bf16_f32 v92, v92, v93
v_exp_f32 v94, v94
MA 188,32,68
v_exp_f32 v95, v95
MA 192,32,72
s_add_u32 m0, s61, 24576
s_add_u32 s66, s98, 49152
s_and_b32 s66, s66, 0x1ffff
s_waitcnt vmcnt(2)
s_add_u32 s66, s66, 2097152
buffer_load_dwordx4 v3, s[48:51], s66 offen nt lds
TR 32,15,16384
v_cvt_pk_bf16_f32 v93, v94, v95
TR 34,15,20480
s_waitcnt lgkmcnt(8)
MA 196,16,64
v_exp_f32 v104, v104
MA 200,16,68
v_exp_f32 v105, v105
MA 204,16,72
ds_read_b128 v[16:19], v4 offset:8192
v_cvt_pk_bf16_f32 v94, v104, v105
v_exp_f32 v106, v106
s_waitcnt lgkmcnt(7)
MA 208,20,64
v_exp_f32 v107, v107
MA 212,20,68
v_cvt_pk_bf16_f32 v95, v106, v107
MA 216,20,72
ds_read_b128 v[20:23], v5 offset:8192
v_exp_f32 v96, v96
s_waitcnt lgkmcnt(6)
MA 220,24,64
v_exp_f32 v97, v97
MA 224,24,68
v_cvt_pk_bf16_f32 v96, v96, v97
v_exp_f32 v98, v98
MA 228,24,72
ds_read_b128 v[24:27], v6 offset:8192
v_exp_f32 v99, v99
s_waitcnt lgkmcnt(5)
MA 232,28,64
v_cvt_pk_bf16_f32 v97, v98, v99
MA 236,28,68
v_exp_f32 v108, v108
MA 240,28,72
s_add_u32 m0, s61, 28672
s_add_u32 s66, s98, 53248
s_and_b32 s66, s66, 0x1ffff
s_waitcnt vmcnt(2)
s_add_u32 s66, s66, 2097152
buffer_load_dwordx4 v3, s[48:51], s66 offen nt lds
ds_read_b128 v[28:31], v7 offset:8192
v_exp_f32 v109, v109
s_waitcnt lgkmcnt(4)
MA 244,32,64
v_cvt_pk_bf16_f32 v98, v108, v109
v_exp_f32 v110, v110
MA 248,32,68
v_exp_f32 v111, v111
MA 252,32,72
ds_read_b128 v[32:35], v4 offset:12288
v_cvt_pk_bf16_f32 v99, v110, v111
s_waitcnt lgkmcnt(4)
MC 64,16,112,52
MC 68,16,128,56
MC 72,16,144,60
ds_read_b128 v[16:19], v5 offset:12288
s_waitcnt lgkmcnt(4)
MA 64,20,116
MA 68,20,132
MA 72,20,148
ds_read_b128 v[20:23], v6 offset:12288
s_waitcnt lgkmcnt(4)
MA 64,24,120
MA 68,24,136
MA 72,24,152
s_add_u32 m0, s61, 65536
s_add_u32 s66, s98, 40960
s_and_b32 s66, s66, 0x1ffff
s_waitcnt vmcnt(2)
s_add_u32 s66, s66, 2097152
buffer_load_dwordx4 v2, s[52:55], s66 offen nt lds
ds_read_b128 v[24:27], v7 offset:12288
s_waitcnt lgkmcnt(4)
MA 64,28,124
MA 68,28,140
MA 72,28,156
TR 28,8,8192
TR 30,8,12288
s_waitcnt lgkmcnt(5)
MC 76,32,112,52
MC 80,32,128,56
MC 84,32,144,60
TR 32,9,8192
v_exp_f32 v64, v64
TR 34,9,12288
s_waitcnt lgkmcnt(6)
MA 76,16,116
v_exp_f32 v65, v65
MA 80,16,132
v_cvt_pk_bf16_f32 v64, v64, v65
v_exp_f32 v66, v66
MA 84,16,148
TR 16,10,8192
v_exp_f32 v67, v67
TR 18,10,12288
s_waitcnt lgkmcnt(7)
MA 76,20,120
v_cvt_pk_bf16_f32 v65, v66, v67
MA 80,20,136
MA 84,20,152
s_add_u32 m0, s61, 69632
s_add_u32 s66, s98, 45056
s_and_b32 s66, s66, 0x1ffff
s_waitcnt vmcnt(2)
s_add_u32 s66, s66, 2097152
buffer_load_dwordx4 v2, s[52:55], s66 offen nt lds
TR 20,11,8192
TR 22,11,12288
s_waitcnt lgkmcnt(8)
MA 76,24,124
MA 80,24,140
MA 84,24,156
TR 24,12,8192
TR 26,12,12288
s_waitcnt vmcnt(4)
s_barrier
s_lshl_b32 s74, s86, 2
s_add_u32 s74, s74, 128
s_cmp_lg_u32 s62, 0
s_cbranch_scc1 L1a
v_mbcnt_lo_u32_b32 v1, -1, 0
v_lshl_add_u32 v1, v1, 2, s74
s_mov_b64 exec, 1
global_load_dword v0, v1, s[84:85] sc0 sc1
s_mov_b64 exec, -1
L1a:
MA 40,36,88
v_exp_f32 v76, v76
MA 44,36,92
v_exp_f32 v77, v77
MA 48,36,96
v_cvt_pk_bf16_f32 v66, v76, v77
v_exp_f32 v78, v78
s_waitcnt lgkmcnt(8)
MA 160,28,88
v_exp_f32 v79, v79
MA 164,28,92
v_cvt_pk_bf16_f32 v67, v78, v79
MA 168,28,96
TR 28,13,8192
v_exp_f32 v68, v68
TR 30,13,12288
s_waitcnt lgkmcnt(8)
MA 172,32,88
v_exp_f32 v69, v69
MA 176,32,92
v_cvt_pk_bf16_f32 v68, v68, v69
v_exp_f32 v70, v70
MA 180,32,96
TR 32,14,8192
v_exp_f32 v71, v71
TR 34,14,12288
s_waitcnt lgkmcnt(8)
MA 184,16,88
v_cvt_pk_bf16_f32 v69, v70, v71
MA 188,16,92
v_exp_f32 v80, v80
MA 192,16,96
s_add_u32 m0, s61, 32768
s_add_u32 s66, s98, 57344
s_and_b32 s66, s66, 0x1ffff
s_waitcnt vmcnt(2)
s_add_u32 s66, s66, 2097152
buffer_load_dwordx4 v3, s[48:51], s66 offen nt lds
TR 16,15,8192
v_exp_f32 v81, v81
TR 18,15,12288
s_waitcnt lgkmcnt(8)
MA 196,20,88
v_cvt_pk_bf16_f32 v70, v80, v81
v_exp_f32 v82, v82
MA 200,20,92
v_exp_f32 v83, v83
MA 204,20,96
ds_read_b128 v[20:23], v4 offset:16384
v_cvt_pk_bf16_f32 v71, v82, v83
s_waitcnt lgkmcnt(7)
MA 208,24,88
v_exp_f32 v72, v72
MA 212,24,92
v_exp_f32 v73, v73
MA 216,24,96
ds_read_b128 v[24:27], v5 offset:16384
v_cvt_pk_bf16_f32 v72, v72, v73
v_exp_f32 v74, v74
s_waitcnt lgkmcnt(6)
MA 220,28,88
v_exp_f32 v75, v75
MA 224,28,92
v_cvt_pk_bf16_f32 v73, v74, v75
MA 228,28,96
ds_read_b128 v[28:31], v6 offset:16384
v_exp_f32 v84, v84
s_waitcnt lgkmcnt(5)
MA 232,32,88
v_exp_f32 v85, v85
MA 236,32,92
v_cvt_pk_bf16_f32 v74, v84, v85
v_exp_f32 v86, v86
MA 240,32,96
s_add_u32 m0, s61, 36864
s_add_u32 s66, s98, 61440
s_and_b32 s66, s66, 0x1ffff
s_waitcnt vmcnt(2)
s_add_u32 s66, s66, 2097152
buffer_load_dwordx4 v3, s[48:51], s66 offen nt lds
ds_read_b128 v[32:35], v7 offset:16384
v_exp_f32 v87, v87
s_waitcnt lgkmcnt(4)
MA 244,16,88
v_cvt_pk_bf16_f32 v75, v86, v87
MA 248,16,92
MA 252,16,96
ds_read_b128 v[16:19], v4 offset:20480
s_waitcnt lgkmcnt(4)
MC 88,20,112,52
MC 92,20,128,56
MC 96,20,144,60
ds_read_b128 v[20:23], v5 offset:20480
s_waitcnt lgkmcnt(4)
MA 88,24,116
MA 92,24,132
MA 96,24,148
ds_read_b128 v[24:27], v6 offset:20480
s_waitcnt lgkmcnt(4)
MA 88,28,120
MA 92,28,136
MA 96,28,152
s_add_u32 m0, s61, 40960
s_add_u32 s66, s98, 49152
s_and_b32 s66, s66, 0x1ffff
s_waitcnt vmcnt(1)
s_add_u32 s66, s66, 2097152
buffer_load_dwordx4 v2, s[52:55], s66 offen nt lds
ds_read_b128 v[28:31], v7 offset:20480
s_waitcnt lgkmcnt(4)
MA 88,32,124
MA 92,32,140
MA 96,32,156
TR 32,8,32768
TR 34,8,36864
s_waitcnt lgkmcnt(5)
MC 100,16,112,52
MC 104,16,128,56
MC 108,16,144,60
TR 16,9,32768
v_exp_f32 v88, v88
TR 18,9,36864
s_waitcnt lgkmcnt(6)
MA 100,20,116
v_exp_f32 v89, v89
MA 104,20,132
v_cvt_pk_bf16_f32 v88, v88, v89
v_exp_f32 v90, v90
MA 108,20,148
TR 20,10,32768
v_exp_f32 v91, v91
TR 22,10,36864
s_waitcnt lgkmcnt(7)
MA 100,24,120
v_cvt_pk_bf16_f32 v89, v90, v91
MA 104,24,136
MA 108,24,152
s_add_u32 m0, s61, 45056
s_add_u32 s66, s98, 53248
s_and_b32 s66, s66, 0x1ffff
s_waitcnt vmcnt(2)
s_add_u32 s66, s66, 2097152
buffer_load_dwordx4 v2, s[52:55], s66 offen nt lds
TR 24,11,32768
TR 26,11,36864
s_waitcnt lgkmcnt(8)
MA 100,28,124
MA 104,28,140
MA 108,28,156
TR 28,12,32768
TR 30,12,36864
s_waitcnt vmcnt(4)
s_barrier
MA 40,36,64
MA 44,36,68
MA 48,36,72
v_exp_f32 v100, v100
s_waitcnt lgkmcnt(8)
MA 160,32,64
v_exp_f32 v101, v101
MA 164,32,68
v_cvt_pk_bf16_f32 v90, v100, v101
v_exp_f32 v102, v102
MA 168,32,72
TR 32,13,32768
v_exp_f32 v103, v103
TR 34,13,36864
s_waitcnt lgkmcnt(8)
MA 172,16,64
v_cvt_pk_bf16_f32 v91, v102, v103
MA 176,16,68
v_exp_f32 v92, v92
MA 180,16,72
TR 16,14,32768
v_exp_f32 v93, v93
TR 18,14,36864
s_waitcnt lgkmcnt(8)
MA 184,20,64
v_cvt_pk_bf16_f32 v92, v92, v93
v_exp_f32 v94, v94
MA 188,20,68
v_exp_f32 v95, v95
MA 192,20,72
s_add_u32 m0, s61, 0
s_add_u32 s66, s98, 65536
s_and_b32 s66, s66, 0x1ffff
s_waitcnt vmcnt(2)
s_add_u32 s66, s66, 2097152
buffer_load_dwordx4 v3, s[48:51], s66 offen nt lds
TR 20,15,32768
v_cvt_pk_bf16_f32 v93, v94, v95
TR 22,15,36864
s_waitcnt lgkmcnt(8)
MA 196,24,64
v_exp_f32 v104, v104
MA 200,24,68
v_exp_f32 v105, v105
MA 204,24,72
ds_read_b128 v[24:27], v4 offset:24576
v_cvt_pk_bf16_f32 v94, v104, v105
v_exp_f32 v106, v106
s_waitcnt lgkmcnt(7)
MA 208,28,64
v_exp_f32 v107, v107
MA 212,28,68
v_cvt_pk_bf16_f32 v95, v106, v107
MA 216,28,72
ds_read_b128 v[28:31], v5 offset:24576
v_exp_f32 v96, v96
s_waitcnt lgkmcnt(6)
MA 220,32,64
v_exp_f32 v97, v97
MA 224,32,68
v_cvt_pk_bf16_f32 v96, v96, v97
v_exp_f32 v98, v98
MA 228,32,72
ds_read_b128 v[32:35], v6 offset:24576
v_exp_f32 v99, v99
s_waitcnt lgkmcnt(5)
MA 232,16,64
v_cvt_pk_bf16_f32 v97, v98, v99
MA 236,16,68
v_exp_f32 v108, v108
MA 240,16,72
s_add_u32 m0, s61, 4096
s_add_u32 s66, s98, 69632
s_and_b32 s66, s66, 0x1ffff
s_waitcnt vmcnt(2)
s_add_u32 s66, s66, 2097152
buffer_load_dwordx4 v3, s[48:51], s66 offen nt lds
ds_read_b128 v[16:19], v7 offset:24576
v_exp_f32 v109, v109
s_waitcnt lgkmcnt(4)
MA 244,20,64
v_cvt_pk_bf16_f32 v98, v108, v109
v_exp_f32 v110, v110
MA 248,20,68
v_exp_f32 v111, v111
MA 252,20,72
ds_read_b128 v[20:23], v4 offset:28672
v_cvt_pk_bf16_f32 v99, v110, v111
s_waitcnt lgkmcnt(4)
MC 64,24,112,52
MC 68,24,128,56
MC 72,24,144,60
ds_read_b128 v[24:27], v5 offset:28672
s_waitcnt lgkmcnt(4)
MA 64,28,116
MA 68,28,132
MA 72,28,148
ds_read_b128 v[28:31], v6 offset:28672
s_waitcnt lgkmcnt(4)
MA 64,32,120
MA 68,32,136
MA 72,32,152
s_add_u32 m0, s61, 57344
s_add_u32 s66, s98, 57344
s_and_b32 s66, s66, 0x1ffff
s_waitcnt vmcnt(2)
s_add_u32 s66, s66, 2097152
buffer_load_dwordx4 v2, s[52:55], s66 offen nt lds
ds_read_b128 v[32:35], v7 offset:28672
s_waitcnt lgkmcnt(4)
MA 64,16,124
MA 68,16,140
MA 72,16,156
TR 16,8,24576
TR 18,8,28672
s_waitcnt lgkmcnt(5)
MC 76,20,112,52
MC 80,20,128,56
MC 84,20,144,60
TR 20,9,24576
v_exp_f32 v64, v64
TR 22,9,28672
s_waitcnt lgkmcnt(6)
MA 76,24,116
v_exp_f32 v65, v65
MA 80,24,132
v_cvt_pk_bf16_f32 v64, v64, v65
v_exp_f32 v66, v66
MA 84,24,148
TR 24,10,24576
v_exp_f32 v67, v67
TR 26,10,28672
s_waitcnt lgkmcnt(7)
MA 76,28,120
v_cvt_pk_bf16_f32 v65, v66, v67
MA 80,28,136
MA 84,28,152
s_add_u32 m0, s61, 61440
s_add_u32 s66, s98, 61440
s_and_b32 s66, s66, 0x1ffff
s_waitcnt vmcnt(2)
s_add_u32 s66, s66, 2097152
buffer_load_dwordx4 v2, s[52:55], s66 offen nt lds
TR 28,11,24576
TR 30,11,28672
s_waitcnt lgkmcnt(8)
MA 76,32,124
MA 80,32,140
MA 84,32,156
TR 32,12,24576
TR 34,12,28672
s_waitcnt vmcnt(4)
s_barrier
MA 40,36,88
MA 44,36,92
MA 48,36,96
v_exp_f32 v76, v76
s_waitcnt lgkmcnt(8)
MA 160,16,88
v_exp_f32 v77, v77
MA 164,16,92
v_cvt_pk_bf16_f32 v66, v76, v77
v_exp_f32 v78, v78
MA 168,16,96
TR 16,13,24576
v_exp_f32 v79, v79
TR 18,13,28672
s_waitcnt lgkmcnt(8)
MA 172,20,88
v_cvt_pk_bf16_f32 v67, v78, v79
MA 176,20,92
v_exp_f32 v68, v68
MA 180,20,96
TR 20,14,24576
v_exp_f32 v69, v69
TR 22,14,28672
s_waitcnt lgkmcnt(8)
MA 184,24,88
v_cvt_pk_bf16_f32 v68, v68, v69
v_exp_f32 v70, v70
MA 188,24,92
v_exp_f32 v71, v71
MA 192,24,96
s_add_u32 m0, s61, 8192
s_add_u32 s66, s98, 73728
s_and_b32 s66, s66, 0x1ffff
s_waitcnt vmcnt(2)
s_add_u32 s66, s66, 2097152
buffer_load_dwordx4 v3, s[48:51], s66 offen nt lds
TR 24,15,24576
v_cvt_pk_bf16_f32 v69, v70, v71
TR 26,15,28672
s_waitcnt lgkmcnt(8)
MA 196,28,88
v_exp_f32 v80, v80
MA 200,28,92
v_exp_f32 v81, v81
MA 204,28,96
ds_read_b128 v[28:31], v4 offset:32768
v_cvt_pk_bf16_f32 v70, v80, v81
v_exp_f32 v82, v82
s_waitcnt lgkmcnt(7)
MA 208,32,88
v_exp_f32 v83, v83
MA 212,32,92
v_cvt_pk_bf16_f32 v71, v82, v83
MA 216,32,96
ds_read_b128 v[32:35], v5 offset:32768
v_exp_f32 v72, v72
s_waitcnt lgkmcnt(6)
MA 220,16,88
v_exp_f32 v73, v73
MA 224,16,92
v_cvt_pk_bf16_f32 v72, v72, v73
v_exp_f32 v74, v74
MA 228,16,96
ds_read_b128 v[16:19], v6 offset:32768
v_exp_f32 v75, v75
s_waitcnt lgkmcnt(5)
MA 232,20,88
v_cvt_pk_bf16_f32 v73, v74, v75
MA 236,20,92
v_exp_f32 v84, v84
MA 240,20,96
s_add_u32 m0, s61, 12288
s_add_u32 s66, s98, 77824
s_and_b32 s66, s66, 0x1ffff
s_waitcnt vmcnt(2)
s_add_u32 s66, s66, 2097152
buffer_load_dwordx4 v3, s[48:51], s66 offen nt lds
ds_read_b128 v[20:23], v7 offset:32768
v_exp_f32 v85, v85
s_waitcnt lgkmcnt(4)
MA 244,24,88
v_cvt_pk_bf16_f32 v74, v84, v85
v_exp_f32 v86, v86
MA 248,24,92
v_exp_f32 v87, v87
MA 252,24,96
ds_read_b128 v[24:27], v4 offset:36864
v_cvt_pk_bf16_f32 v75, v86, v87
s_waitcnt lgkmcnt(4)
MC 88,28,112,52
MC 92,28,128,56
MC 96,28,144,60
ds_read_b128 v[28:31], v5 offset:36864
s_waitcnt lgkmcnt(4)
MA 88,32,116
MA 92,32,132
MA 96,32,148
ds_read_b128 v[32:35], v6 offset:36864
s_waitcnt lgkmcnt(4)
MA 88,16,120
MA 92,16,136
MA 96,16,152
s_add_u32 m0, s61, 49152
s_add_u32 s66, s98, 65536
s_and_b32 s66, s66, 0x1ffff
s_waitcnt vmcnt(1)
s_add_u32 s66, s66, 2097152
buffer_load_dwordx4 v2, s[52:55], s66 offen nt lds
ds_read_b128 v[16:19], v7 offset:36864
s_waitcnt lgkmcnt(4)
MA 88,20,124
MA 92,20,140
MA 96,20,156
TR 20,8,0
TR 22,8,4096
s_waitcnt lgkmcnt(5)
MC 100,24,112,52
MC 104,24,128,56
MC 108,24,144,60
TR 24,9,0
v_exp_f32 v88, v88
TR 26,9,4096
s_waitcnt lgkmcnt(6)
MA 100,28,116
v_exp_f32 v89, v89
MA 104,28,132
v_cvt_pk_bf16_f32 v88, v88, v89
v_exp_f32 v90, v90
MA 108,28,148
TR 28,10,0
v_exp_f32 v91, v91
TR 30,10,4096
s_waitcnt lgkmcnt(7)
MA 100,32,120
v_cvt_pk_bf16_f32 v89, v90, v91
MA 104,32,136
MA 108,32,152
s_add_u32 m0, s61, 53248
s_add_u32 s66, s98, 69632
s_and_b32 s66, s66, 0x1ffff
s_waitcnt vmcnt(2)
s_add_u32 s66, s66, 2097152
buffer_load_dwordx4 v2, s[52:55], s66 offen nt lds
TR 32,11,0
TR 34,11,4096
s_waitcnt lgkmcnt(8)
MA 100,16,124
MA 104,16,140
MA 108,16,156
TR 16,12,0
TR 18,12,4096
s_waitcnt vmcnt(4)
s_barrier
MA 40,36,64
MA 44,36,68
MA 48,36,72
v_exp_f32 v100, v100
s_waitcnt lgkmcnt(8)
MA 160,20,64
v_exp_f32 v101, v101
MA 164,20,68
v_cvt_pk_bf16_f32 v90, v100, v101
v_exp_f32 v102, v102
MA 168,20,72
TR 20,13,0
v_exp_f32 v103, v103
TR 22,13,4096
s_waitcnt lgkmcnt(8)
MA 172,24,64
v_cvt_pk_bf16_f32 v91, v102, v103
MA 176,24,68
v_exp_f32 v92, v92
MA 180,24,72
TR 24,14,0
v_exp_f32 v93, v93
TR 26,14,4096
s_waitcnt lgkmcnt(8)
MA 184,28,64
v_cvt_pk_bf16_f32 v92, v92, v93
v_exp_f32 v94, v94
MA 188,28,68
v_exp_f32 v95, v95
MA 192,28,72
s_add_u32 m0, s61, 16384
s_add_u32 s66, s98, 81920
s_and_b32 s66, s66, 0x1ffff
s_waitcnt vmcnt(2)
s_add_u32 s66, s66, 2097152
buffer_load_dwordx4 v3, s[48:51], s66 offen nt lds
TR 28,15,0
v_cvt_pk_bf16_f32 v93, v94, v95
TR 30,15,4096
s_waitcnt lgkmcnt(8)
MA 196,32,64
v_exp_f32 v104, v104
MA 200,32,68
v_exp_f32 v105, v105
MA 204,32,72
ds_read_b128 v[32:35], v4 offset:0
v_cvt_pk_bf16_f32 v94, v104, v105
v_exp_f32 v106, v106
s_waitcnt lgkmcnt(7)
MA 208,16,64
v_exp_f32 v107, v107
MA 212,16,68
v_cvt_pk_bf16_f32 v95, v106, v107
MA 216,16,72
ds_read_b128 v[16:19], v5 offset:0
v_exp_f32 v96, v96
s_waitcnt lgkmcnt(6)
MA 220,20,64
v_exp_f32 v97, v97
MA 224,20,68
v_cvt_pk_bf16_f32 v96, v96, v97
v_exp_f32 v98, v98
MA 228,20,72
ds_read_b128 v[20:23], v6 offset:0
v_exp_f32 v99, v99
s_waitcnt lgkmcnt(5)
MA 232,24,64
v_cvt_pk_bf16_f32 v97, v98, v99
MA 236,24,68
v_exp_f32 v108, v108
MA 240,24,72
s_add_u32 m0, s61, 20480
s_add_u32 s66, s98, 86016
s_and_b32 s66, s66, 0x1ffff
s_waitcnt vmcnt(2)
s_add_u32 s66, s66, 2097152
buffer_load_dwordx4 v3, s[48:51], s66 offen nt lds
ds_read_b128 v[24:27], v7 offset:0
v_exp_f32 v109, v109
s_waitcnt lgkmcnt(4)
MA 244,28,64
v_cvt_pk_bf16_f32 v98, v108, v109
v_exp_f32 v110, v110
MA 248,28,68
v_exp_f32 v111, v111
MA 252,28,72
ds_read_b128 v[28:31], v4 offset:4096
v_cvt_pk_bf16_f32 v99, v110, v111
s_waitcnt lgkmcnt(4)
MC 64,32,112,52
MC 68,32,128,56
MC 72,32,144,60
ds_read_b128 v[32:35], v5 offset:4096
s_waitcnt lgkmcnt(4)
MA 64,16,116
MA 68,16,132
MA 72,16,148
ds_read_b128 v[16:19], v6 offset:4096
s_waitcnt lgkmcnt(4)
MA 64,20,120
MA 68,20,136
MA 72,20,152
s_add_u32 m0, s61, 73728
s_add_u32 s66, s98, 73728
s_and_b32 s66, s66, 0x1ffff
s_waitcnt vmcnt(2)
s_add_u32 s66, s66, 2097152
buffer_load_dwordx4 v2, s[52:55], s66 offen nt lds
ds_read_b128 v[20:23], v7 offset:4096
s_waitcnt lgkmcnt(4)
MA 64,24,124
MA 68,24,140
MA 72,24,156
TR 24,8,16384
TR 26,8,20480
s_waitcnt lgkmcnt(5)
MC 76,28,112,52
MC 80,28,128,56
MC 84,28,144,60
TR 28,9,16384
v_exp_f32 v64, v64
TR 30,9,20480
s_waitcnt lgkmcnt(6)
MA 76,32,116
v_exp_f32 v65, v65
MA 80,32,132
v_cvt_pk_bf16_f32 v64, v64, v65
v_exp_f32 v66, v66
MA 84,32,148
TR 32,10,16384
v_exp_f32 v67, v67
TR 34,10,20480
s_waitcnt lgkmcnt(7)
MA 76,16,120
v_cvt_pk_bf16_f32 v65, v66, v67
MA 80,16,136
MA 84,16,152
s_add_u32 m0, s61, 77824
s_add_u32 s66, s98, 77824
s_and_b32 s66, s66, 0x1ffff
s_waitcnt vmcnt(2)
s_add_u32 s66, s66, 2097152
buffer_load_dwordx4 v2, s[52:55], s66 offen nt lds
TR 16,11,16384
TR 18,11,20480
s_waitcnt lgkmcnt(8)
MA 76,20,124
MA 80,20,140
MA 84,20,156
TR 20,12,16384
TR 22,12,20480
s_waitcnt vmcnt(4)
s_barrier
s_lshl_b32 s74, s86, 2
s_add_u32 s74, s74, 128
s_cmp_lg_u32 s62, 0
s_cbranch_scc1 L1b
s_mov_b64 exec, 1
v_cmp_gt_u32 vcc, 8, v0
s_mov_b64 exec, -1
s_nop 3
s_cmp_eq_u64 vcc, 0
s_cbranch_scc1 L1b
s_mov_b32 s93, 0
v_mbcnt_lo_u32_b32 v1, -1, 0
v_lshl_add_u32 v1, v1, 2, s74
s_mov_b64 exec, 1
L1bp_l:
global_load_dword v0, v1, s[84:85] sc0 sc1
s_waitcnt vmcnt(0)
v_cmp_gt_u32 vcc, 8, v0
s_add_u32 s93, s93, 1
s_nop 4
s_cmp_eq_u64 vcc, 0
s_cbranch_scc1 L1bp_d
s_sleep 64
s_cmp_lt_u32 s93, 100000
s_cbranch_scc1 L1bp_l
L1bp_d:
s_mov_b64 exec, -1
L1b:
s_lshr_b32 s74, s71, 2
s_lshl_b32 s74, s74, 4
s_cmp_lg_u32 s62, 0
s_cbranch_scc1 L1c
v_mbcnt_lo_u32_b32 v1, -1, 0
v_lshl_add_u32 v1, v1, 2, s74
s_mov_b64 exec, 15
global_load_dword v0, v1, s[96:97] sc0 sc1
s_mov_b64 exec, -1
L1c:
MA 40,36,88
v_exp_f32 v76, v76
MA 44,36,92
v_exp_f32 v77, v77
MA 48,36,96
v_cvt_pk_bf16_f32 v66, v76, v77
v_exp_f32 v78, v78
s_waitcnt lgkmcnt(8)
MA 160,24,88
v_exp_f32 v79, v79
MA 164,24,92
v_cvt_pk_bf16_f32 v67, v78, v79
MA 168,24,96
TR 24,13,16384
v_exp_f32 v68, v68
TR 26,13,20480
s_waitcnt lgkmcnt(8)
MA 172,28,88
v_exp_f32 v69, v69
MA 176,28,92
v_cvt_pk_bf16_f32 v68, v68, v69
v_exp_f32 v70, v70
MA 180,28,96
TR 28,14,16384
v_exp_f32 v71, v71
TR 30,14,20480
s_waitcnt lgkmcnt(8)
MA 184,32,88
v_cvt_pk_bf16_f32 v69, v70, v71
MA 188,32,92
v_exp_f32 v80, v80
MA 192,32,96
s_add_u32 m0, s61, 24576
s_add_u32 s66, s98, 90112
s_and_b32 s66, s66, 0x1ffff
s_waitcnt vmcnt(2)
s_add_u32 s66, s66, 2097152
buffer_load_dwordx4 v3, s[48:51], s66 offen nt lds
TR 32,15,16384
v_exp_f32 v81, v81
TR 34,15,20480
s_waitcnt lgkmcnt(8)
MA 196,16,88
v_cvt_pk_bf16_f32 v70, v80, v81
v_exp_f32 v82, v82
MA 200,16,92
v_exp_f32 v83, v83
MA 204,16,96
ds_read_b128 v[16:19], v4 offset:8192
v_cvt_pk_bf16_f32 v71, v82, v83
s_waitcnt lgkmcnt(7)
MA 208,20,88
v_exp_f32 v72, v72
MA 212,20,92
v_exp_f32 v73, v73
MA 216,20,96
ds_read_b128 v[20:23], v5 offset:8192
v_cvt_pk_bf16_f32 v72, v72, v73
v_exp_f32 v74, v74
s_waitcnt lgkmcnt(6)
MA 220,24,88
v_exp_f32 v75, v75
MA 224,24,92
v_cvt_pk_bf16_f32 v73, v74, v75
MA 228,24,96
ds_read_b128 v[24:27], v6 offset:8192
v_exp_f32 v84, v84
s_waitcnt lgkmcnt(5)
MA 232,28,88
v_exp_f32 v85, v85
MA 236,28,92
v_cvt_pk_bf16_f32 v74, v84, v85
v_exp_f32 v86, v86
MA 240,28,96
s_add_u32 m0, s61, 28672
s_add_u32 s66, s98, 94208
s_and_b32 s66, s66, 0x1ffff
s_waitcnt vmcnt(2)
s_add_u32 s66, s66, 2097152
buffer_load_dwordx4 v3, s[48:51], s66 offen nt lds
ds_read_b128 v[28:31], v7 offset:8192
v_exp_f32 v87, v87
s_waitcnt lgkmcnt(4)
MA 244,32,88
v_cvt_pk_bf16_f32 v75, v86, v87
MA 248,32,92
MA 252,32,96
ds_read_b128 v[32:35], v4 offset:12288
s_waitcnt lgkmcnt(4)
MC 88,16,112,52
MC 92,16,128,56
MC 96,16,144,60
ds_read_b128 v[16:19], v5 offset:12288
s_waitcnt lgkmcnt(4)
MA 88,20,116
MA 92,20,132
MA 96,20,148
ds_read_b128 v[20:23], v6 offset:12288
s_waitcnt lgkmcnt(4)
MA 88,24,120
MA 92,24,136
MA 96,24,152
s_add_u32 m0, s61, 65536
s_add_u32 s66, s98, 81920
s_and_b32 s66, s66, 0x1ffff
s_waitcnt vmcnt(1)
s_add_u32 s66, s66, 2097152
buffer_load_dwordx4 v2, s[52:55], s66 offen nt lds
ds_read_b128 v[24:27], v7 offset:12288
s_waitcnt lgkmcnt(4)
MA 88,28,124
MA 92,28,140
MA 96,28,156
TR 28,8,8192
TR 30,8,12288
s_waitcnt lgkmcnt(5)
MC 100,32,112,52
MC 104,32,128,56
MC 108,32,144,60
TR 32,9,8192
v_exp_f32 v88, v88
TR 34,9,12288
s_waitcnt lgkmcnt(6)
MA 100,16,116
v_exp_f32 v89, v89
MA 104,16,132
v_cvt_pk_bf16_f32 v88, v88, v89
v_exp_f32 v90, v90
MA 108,16,148
TR 16,10,8192
v_exp_f32 v91, v91
TR 18,10,12288
s_waitcnt lgkmcnt(7)
MA 100,20,120
v_cvt_pk_bf16_f32 v89, v90, v91
MA 104,20,136
MA 108,20,152
s_add_u32 m0, s61, 69632
s_add_u32 s66, s98, 86016
s_and_b32 s66, s66, 0x1ffff
s_waitcnt vmcnt(2)
s_add_u32 s66, s66, 2097152
buffer_load_dwordx4 v2, s[52:55], s66 offen nt lds
TR 20,11,8192
TR 22,11,12288
s_waitcnt lgkmcnt(8)
MA 100,24,124
MA 104,24,140
MA 108,24,156
TR 24,12,8192
TR 26,12,12288
s_waitcnt vmcnt(4)
s_barrier
MA 40,36,64
MA 44,36,68
MA 48,36,72
v_exp_f32 v100, v100
s_waitcnt lgkmcnt(8)
MA 160,28,64
v_exp_f32 v101, v101
MA 164,28,68
v_cvt_pk_bf16_f32 v90, v100, v101
v_exp_f32 v102, v102
MA 168,28,72
TR 28,13,8192
v_exp_f32 v103, v103
TR 30,13,12288
s_waitcnt lgkmcnt(8)
MA 172,32,64
v_cvt_pk_bf16_f32 v91, v102, v103
MA 176,32,68
v_exp_f32 v92, v92
MA 180,32,72
TR 32,14,8192
v_exp_f32 v93, v93
TR 34,14,12288
s_waitcnt lgkmcnt(8)
MA 184,16,64
v_cvt_pk_bf16_f32 v92, v92, v93
v_exp_f32 v94, v94
MA 188,16,68
v_exp_f32 v95, v95
MA 192,16,72
s_add_u32 m0, s61, 32768
s_add_u32 s66, s98, 98304
s_and_b32 s66, s66, 0x1ffff
s_waitcnt vmcnt(2)
s_add_u32 s66, s66, 2097152
buffer_load_dwordx4 v3, s[48:51], s66 offen nt lds
TR 16,15,8192
v_cvt_pk_bf16_f32 v93, v94, v95
TR 18,15,12288
s_waitcnt lgkmcnt(8)
MA 196,20,64
v_exp_f32 v104, v104
MA 200,20,68
v_exp_f32 v105, v105
MA 204,20,72
ds_read_b128 v[20:23], v4 offset:16384
v_cvt_pk_bf16_f32 v94, v104, v105
v_exp_f32 v106, v106
s_waitcnt lgkmcnt(7)
MA 208,24,64
v_exp_f32 v107, v107
MA 212,24,68
v_cvt_pk_bf16_f32 v95, v106, v107
MA 216,24,72
ds_read_b128 v[24:27], v5 offset:16384
v_exp_f32 v96, v96
s_waitcnt lgkmcnt(6)
MA 220,28,64
v_exp_f32 v97, v97
MA 224,28,68
v_cvt_pk_bf16_f32 v96, v96, v97
v_exp_f32 v98, v98
MA 228,28,72
ds_read_b128 v[28:31], v6 offset:16384
v_exp_f32 v99, v99
s_waitcnt lgkmcnt(5)
MA 232,32,64
v_cvt_pk_bf16_f32 v97, v98, v99
MA 236,32,68
v_exp_f32 v108, v108
MA 240,32,72
s_add_u32 m0, s61, 36864
s_add_u32 s66, s98, 102400
s_and_b32 s66, s66, 0x1ffff
s_waitcnt vmcnt(2)
s_add_u32 s66, s66, 2097152
buffer_load_dwordx4 v3, s[48:51], s66 offen nt lds
ds_read_b128 v[32:35], v7 offset:16384
v_exp_f32 v109, v109
s_waitcnt lgkmcnt(4)
MA 244,16,64
v_cvt_pk_bf16_f32 v98, v108, v109
v_exp_f32 v110, v110
MA 248,16,68
v_exp_f32 v111, v111
MA 252,16,72
ds_read_b128 v[16:19], v4 offset:20480
v_cvt_pk_bf16_f32 v99, v110, v111
s_waitcnt lgkmcnt(4)
MC 64,20,112,52
MC 68,20,128,56
MC 72,20,144,60
ds_read_b128 v[20:23], v5 offset:20480
s_waitcnt lgkmcnt(4)
MA 64,24,116
MA 68,24,132
MA 72,24,148
ds_read_b128 v[24:27], v6 offset:20480
s_waitcnt lgkmcnt(4)
MA 64,28,120
MA 68,28,136
MA 72,28,152
s_add_u32 m0, s61, 40960
s_add_u32 s66, s98, 90112
s_and_b32 s66, s66, 0x1ffff
s_waitcnt vmcnt(2)
s_add_u32 s66, s66, 2097152
buffer_load_dwordx4 v2, s[52:55], s66 offen nt lds
ds_read_b128 v[28:31], v7 offset:20480
s_waitcnt lgkmcnt(4)
MA 64,32,124
MA 68,32,140
MA 72,32,156
TR 32,8,32768
TR 34,8,36864
s_waitcnt lgkmcnt(5)
MC 76,16,112,52
MC 80,16,128,56
MC 84,16,144,60
TR 16,9,32768
v_exp_f32 v64, v64
TR 18,9,36864
s_waitcnt lgkmcnt(6)
MA 76,20,116
v_exp_f32 v65, v65
MA 80,20,132
v_cvt_pk_bf16_f32 v64, v64, v65
v_exp_f32 v66, v66
MA 84,20,148
TR 20,10,32768
v_exp_f32 v67, v67
TR 22,10,36864
s_waitcnt lgkmcnt(7)
MA 76,24,120
v_cvt_pk_bf16_f32 v65, v66, v67
MA 80,24,136
MA 84,24,152
s_add_u32 m0, s61, 45056
s_add_u32 s66, s98, 94208
s_and_b32 s66, s66, 0x1ffff
s_waitcnt vmcnt(2)
s_add_u32 s66, s66, 2097152
buffer_load_dwordx4 v2, s[52:55], s66 offen nt lds
TR 24,11,32768
TR 26,11,36864
s_waitcnt lgkmcnt(8)
MA 76,28,124
MA 80,28,140
MA 84,28,156
TR 28,12,32768
TR 30,12,36864
s_waitcnt vmcnt(4)
s_barrier
MA 40,36,88
MA 44,36,92
MA 48,36,96
v_exp_f32 v76, v76
s_waitcnt lgkmcnt(8)
MA 160,32,88
v_exp_f32 v77, v77
MA 164,32,92
v_cvt_pk_bf16_f32 v66, v76, v77
v_exp_f32 v78, v78
MA 168,32,96
TR 32,13,32768
v_exp_f32 v79, v79
TR 34,13,36864
s_waitcnt lgkmcnt(8)
MA 172,16,88
v_cvt_pk_bf16_f32 v67, v78, v79
MA 176,16,92
v_exp_f32 v68, v68
MA 180,16,96
TR 16,14,32768
v_exp_f32 v69, v69
TR 18,14,36864
s_waitcnt lgkmcnt(8)
MA 184,20,88
v_cvt_pk_bf16_f32 v68, v68, v69
v_exp_f32 v70, v70
MA 188,20,92
v_exp_f32 v71, v71
MA 192,20,96
s_add_u32 m0, s61, 0
s_add_u32 s66, s98, 106496
s_and_b32 s66, s66, 0x1ffff
s_waitcnt vmcnt(2)
s_add_u32 s66, s66, 2097152
buffer_load_dwordx4 v3, s[48:51], s66 offen nt lds
TR 20,15,32768
v_cvt_pk_bf16_f32 v69, v70, v71
TR 22,15,36864
s_waitcnt lgkmcnt(8)
MA 196,24,88
v_exp_f32 v80, v80
MA 200,24,92
v_exp_f32 v81, v81
MA 204,24,96
ds_read_b128 v[24:27], v4 offset:24576
v_cvt_pk_bf16_f32 v70, v80, v81
v_exp_f32 v82, v82
s_waitcnt lgkmcnt(7)
MA 208,28,88
v_exp_f32 v83, v83
MA 212,28,92
v_cvt_pk_bf16_f32 v71, v82, v83
MA 216,28,96
ds_read_b128 v[28:31], v5 offset:24576
v_exp_f32 v72, v72
s_waitcnt lgkmcnt(6)
MA 220,32,88
v_exp_f32 v73, v73
MA 224,32,92
v_cvt_pk_bf16_f32 v72, v72, v73
v_exp_f32 v74, v74
MA 228,32,96
ds_read_b128 v[32:35], v6 offset:24576
v_exp_f32 v75, v75
s_waitcnt lgkmcnt(5)
MA 232,16,88
v_cvt_pk_bf16_f32 v73, v74, v75
MA 236,16,92
v_exp_f32 v84, v84
MA 240,16,96
s_add_u32 m0, s61, 4096
s_add_u32 s66, s98, 110592
s_and_b32 s66, s66, 0x1ffff
s_waitcnt vmcnt(2)
s_add_u32 s66, s66, 2097152
buffer_load_dwordx4 v3, s[48:51], s66 offen nt lds
ds_read_b128 v[16:19], v7 offset:24576
v_exp_f32 v85, v85
s_waitcnt lgkmcnt(4)
MA 244,20,88
v_cvt_pk_bf16_f32 v74, v84, v85
v_exp_f32 v86, v86
MA 248,20,92
v_exp_f32 v87, v87
MA 252,20,96
ds_read_b128 v[20:23], v4 offset:28672
v_cvt_pk_bf16_f32 v75, v86, v87
s_waitcnt lgkmcnt(4)
MC 88,24,112,52
MC 92,24,128,56
MC 96,24,144,60
ds_read_b128 v[24:27], v5 offset:28672
s_waitcnt lgkmcnt(4)
MA 88,28,116
MA 92,28,132
MA 96,28,148
ds_read_b128 v[28:31], v6 offset:28672
s_waitcnt lgkmcnt(4)
MA 88,32,120
MA 92,32,136
MA 96,32,152
s_add_u32 m0, s61, 57344
s_add_u32 s66, s98, 98304
s_and_b32 s66, s66, 0x1ffff
s_waitcnt vmcnt(1)
s_add_u32 s66, s66, 2097152
buffer_load_dwordx4 v2, s[52:55], s66 offen nt lds
ds_read_b128 v[32:35], v7 offset:28672
s_waitcnt lgkmcnt(4)
MA 88,16,124
MA 92,16,140
MA 96,16,156
TR 16,8,24576
TR 18,8,28672
s_waitcnt lgkmcnt(5)
MC 100,20,112,52
MC 104,20,128,56
MC 108,20,144,60
TR 20,9,24576
v_exp_f32 v88, v88
TR 22,9,28672
s_waitcnt lgkmcnt(6)
MA 100,24,116
v_exp_f32 v89, v89
MA 104,24,132
v_cvt_pk_bf16_f32 v88, v88, v89
v_exp_f32 v90, v90
MA 108,24,148
TR 24,10,24576
v_exp_f32 v91, v91
TR 26,10,28672
s_waitcnt lgkmcnt(7)
MA 100,28,120
v_cvt_pk_bf16_f32 v89, v90, v91
MA 104,28,136
MA 108,28,152
s_add_u32 m0, s61, 61440
s_add_u32 s66, s98, 102400
s_and_b32 s66, s66, 0x1ffff
s_waitcnt vmcnt(2)
s_add_u32 s66, s66, 2097152
buffer_load_dwordx4 v2, s[52:55], s66 offen nt lds
TR 28,11,24576
TR 30,11,28672
s_waitcnt lgkmcnt(8)
MA 100,32,124
MA 104,32,140
MA 108,32,156
TR 32,12,24576
TR 34,12,28672
s_waitcnt vmcnt(4)
s_barrier
MA 40,36,64
MA 44,36,68
MA 48,36,72
v_exp_f32 v100, v100
s_waitcnt lgkmcnt(8)
MA 160,16,64
v_exp_f32 v101, v101
MA 164,16,68
v_cvt_pk_bf16_f32 v90, v100, v101
v_exp_f32 v102, v102
MA 168,16,72
TR 16,13,24576
v_exp_f32 v103, v103
TR 18,13,28672
s_waitcnt lgkmcnt(8)
MA 172,20,64
v_cvt_pk_bf16_f32 v91, v102, v103
MA 176,20,68
v_exp_f32 v92, v92
MA 180,20,72
TR 20,14,24576
v_exp_f32 v93, v93
TR 22,14,28672
s_waitcnt lgkmcnt(8)
MA 184,24,64
v_cvt_pk_bf16_f32 v92, v92, v93
v_exp_f32 v94, v94
MA 188,24,68
v_exp_f32 v95, v95
MA 192,24,72
s_add_u32 m0, s61, 8192
s_add_u32 s66, s98, 114688
s_and_b32 s66, s66, 0x1ffff
s_waitcnt vmcnt(2)
s_add_u32 s66, s66, 2097152
buffer_load_dwordx4 v3, s[48:51], s66 offen nt lds
TR 24,15,24576
v_cvt_pk_bf16_f32 v93, v94, v95
TR 26,15,28672
s_waitcnt lgkmcnt(8)
MA 196,28,64
v_exp_f32 v104, v104
MA 200,28,68
v_exp_f32 v105, v105
MA 204,28,72
ds_read_b128 v[28:31], v4 offset:32768
v_cvt_pk_bf16_f32 v94, v104, v105
v_exp_f32 v106, v106
s_waitcnt lgkmcnt(7)
MA 208,32,64
v_exp_f32 v107, v107
MA 212,32,68
v_cvt_pk_bf16_f32 v95, v106, v107
MA 216,32,72
ds_read_b128 v[32:35], v5 offset:32768
v_exp_f32 v96, v96
s_waitcnt lgkmcnt(6)
MA 220,16,64
v_exp_f32 v97, v97
MA 224,16,68
v_cvt_pk_bf16_f32 v96, v96, v97
v_exp_f32 v98, v98
MA 228,16,72
ds_read_b128 v[16:19], v6 offset:32768
v_exp_f32 v99, v99
s_waitcnt lgkmcnt(5)
MA 232,20,64
v_cvt_pk_bf16_f32 v97, v98, v99
MA 236,20,68
v_exp_f32 v108, v108
MA 240,20,72
s_add_u32 m0, s61, 12288
s_add_u32 s66, s98, 118784
s_and_b32 s66, s66, 0x1ffff
s_waitcnt vmcnt(2)
s_add_u32 s66, s66, 2097152
buffer_load_dwordx4 v3, s[48:51], s66 offen nt lds
ds_read_b128 v[20:23], v7 offset:32768
v_exp_f32 v109, v109
s_waitcnt lgkmcnt(4)
MA 244,24,64
v_cvt_pk_bf16_f32 v98, v108, v109
v_exp_f32 v110, v110
MA 248,24,68
v_exp_f32 v111, v111
MA 252,24,72
ds_read_b128 v[24:27], v4 offset:36864
v_cvt_pk_bf16_f32 v99, v110, v111
s_waitcnt lgkmcnt(4)
MC 64,28,112,52
MC 68,28,128,56
MC 72,28,144,60
ds_read_b128 v[28:31], v5 offset:36864
s_waitcnt lgkmcnt(4)
MA 64,32,116
MA 68,32,132
MA 72,32,148
ds_read_b128 v[32:35], v6 offset:36864
s_waitcnt lgkmcnt(4)
MA 64,16,120
MA 68,16,136
MA 72,16,152
s_add_u32 m0, s61, 49152
s_add_u32 s66, s98, 106496
s_and_b32 s66, s66, 0x1ffff
s_waitcnt vmcnt(2)
s_add_u32 s66, s66, 2097152
buffer_load_dwordx4 v2, s[52:55], s66 offen nt lds
ds_read_b128 v[16:19], v7 offset:36864
s_waitcnt lgkmcnt(4)
MA 64,20,124
MA 68,20,140
MA 72,20,156
TR 20,8,0
TR 22,8,4096
s_waitcnt lgkmcnt(5)
MC 76,24,112,52
MC 80,24,128,56
MC 84,24,144,60
TR 24,9,0
v_exp_f32 v64, v64
TR 26,9,4096
s_waitcnt lgkmcnt(6)
MA 76,28,116
v_exp_f32 v65, v65
MA 80,28,132
v_cvt_pk_bf16_f32 v64, v64, v65
v_exp_f32 v66, v66
MA 84,28,148
TR 28,10,0
v_exp_f32 v67, v67
TR 30,10,4096
s_waitcnt lgkmcnt(7)
MA 76,32,120
v_cvt_pk_bf16_f32 v65, v66, v67
MA 80,32,136
MA 84,32,152
s_add_u32 m0, s61, 53248
s_add_u32 s66, s98, 110592
s_and_b32 s66, s66, 0x1ffff
s_waitcnt vmcnt(2)
s_add_u32 s66, s66, 2097152
buffer_load_dwordx4 v2, s[52:55], s66 offen nt lds
TR 32,11,0
TR 34,11,4096
s_waitcnt lgkmcnt(8)
MA 76,16,124
MA 80,16,140
MA 84,16,156
TR 16,12,0
TR 18,12,4096
s_waitcnt vmcnt(4)
s_barrier
s_lshr_b32 s74, s71, 2
s_lshl_b32 s74, s74, 4
s_cmp_lg_u32 s62, 0
s_cbranch_scc1 L1d
s_mov_b64 exec, 15
v_cmp_gt_u32 vcc, 1, v0
s_mov_b64 exec, -1
s_nop 3
s_cmp_eq_u64 vcc, 0
s_cbranch_scc1 L1d
s_mov_b32 s93, 0
v_mbcnt_lo_u32_b32 v1, -1, 0
v_lshl_add_u32 v1, v1, 2, s74
s_mov_b64 exec, 15
L1dp_l:
global_load_dword v0, v1, s[96:97] sc0 sc1
s_waitcnt vmcnt(0)
v_cmp_gt_u32 vcc, 1, v0
s_add_u32 s93, s93, 1
s_nop 4
s_cmp_eq_u64 vcc, 0
s_cbranch_scc1 L1dp_d
s_sleep 8
s_cmp_lt_u32 s93, 100000
s_cbranch_scc1 L1dp_l
L1dp_d:
s_mov_b64 exec, -1
L1d:
MA 40,36,88
v_exp_f32 v76, v76
MA 44,36,92
v_exp_f32 v77, v77
MA 48,36,96
v_cvt_pk_bf16_f32 v66, v76, v77
v_exp_f32 v78, v78
s_waitcnt lgkmcnt(8)
MA 160,20,88
v_exp_f32 v79, v79
MA 164,20,92
v_cvt_pk_bf16_f32 v67, v78, v79
MA 168,20,96
TR 20,13,0
v_exp_f32 v68, v68
TR 22,13,4096
s_waitcnt lgkmcnt(8)
MA 172,24,88
v_exp_f32 v69, v69
MA 176,24,92
v_cvt_pk_bf16_f32 v68, v68, v69
v_exp_f32 v70, v70
MA 180,24,96
TR 24,14,0
v_exp_f32 v71, v71
TR 26,14,4096
s_waitcnt lgkmcnt(8)
MA 184,28,88
v_cvt_pk_bf16_f32 v69, v70, v71
MA 188,28,92
v_exp_f32 v80, v80
MA 192,28,96
s_add_u32 m0, s61, 16384
s_add_u32 s66, s98, 122880
s_and_b32 s66, s66, 0x1ffff
s_waitcnt vmcnt(2)
s_add_u32 s66, s66, 2097152
buffer_load_dwordx4 v3, s[48:51], s66 offen nt lds
TR 28,15,0
v_exp_f32 v81, v81
TR 30,15,4096
s_waitcnt lgkmcnt(8)
MA 196,32,88
v_cvt_pk_bf16_f32 v70, v80, v81
v_exp_f32 v82, v82
MA 200,32,92
v_exp_f32 v83, v83
MA 204,32,96
ds_read_b128 v[32:35], v4 offset:0
v_cvt_pk_bf16_f32 v71, v82, v83
s_waitcnt lgkmcnt(7)
MA 208,16,88
v_exp_f32 v72, v72
MA 212,16,92
v_exp_f32 v73, v73
MA 216,16,96
ds_read_b128 v[16:19], v5 offset:0
v_cvt_pk_bf16_f32 v72, v72, v73
v_exp_f32 v74, v74
s_waitcnt lgkmcnt(6)
MA 220,20,88
v_exp_f32 v75, v75
MA 224,20,92
v_cvt_pk_bf16_f32 v73, v74, v75
MA 228,20,96
ds_read_b128 v[20:23], v6 offset:0
v_exp_f32 v84, v84
s_waitcnt lgkmcnt(5)
MA 232,24,88
v_exp_f32 v85, v85
MA 236,24,92
v_cvt_pk_bf16_f32 v74, v84, v85
v_exp_f32 v86, v86
MA 240,24,96
s_add_u32 m0, s61, 20480
s_add_u32 s66, s98, 126976
s_and_b32 s66, s66, 0x1ffff
s_waitcnt vmcnt(2)
s_add_u32 s66, s66, 2097152
buffer_load_dwordx4 v3, s[48:51], s66 offen nt lds
ds_read_b128 v[24:27], v7 offset:0
v_exp_f32 v87, v87
s_waitcnt lgkmcnt(4)
MA 244,28,88
v_cvt_pk_bf16_f32 v75, v86, v87
MA 248,28,92
MA 252,28,96
ds_read_b128 v[28:31], v4 offset:4096
s_waitcnt lgkmcnt(4)
MC 88,32,112,52
MC 92,32,128,56
MC 96,32,144,60
ds_read_b128 v[32:35], v5 offset:4096
s_waitcnt lgkmcnt(4)
MA 88,16,116
MA 92,16,132
MA 96,16,148
ds_read_b128 v[16:19], v6 offset:4096
s_waitcnt lgkmcnt(4)
MA 88,20,120
MA 92,20,136
MA 96,20,152
s_add_u32 m0, s61, 73728
s_add_u32 s66, s98, 114688
s_and_b32 s66, s66, 0x1ffff
s_waitcnt vmcnt(1)
s_add_u32 s66, s66, 2097152
buffer_load_dwordx4 v2, s[52:55], s66 offen nt lds
ds_read_b128 v[20:23], v7 offset:4096
s_waitcnt lgkmcnt(4)
MA 88,24,124
MA 92,24,140
MA 96,24,156
TR 24,8,16384
TR 26,8,20480
s_waitcnt lgkmcnt(5)
MC 100,28,112,52
MC 104,28,128,56
MC 108,28,144,60
TR 28,9,16384
v_exp_f32 v88, v88
TR 30,9,20480
s_waitcnt lgkmcnt(6)
MA 100,32,116
v_exp_f32 v89, v89
MA 104,32,132
v_cvt_pk_bf16_f32 v88, v88, v89
v_exp_f32 v90, v90
MA 108,32,148
TR 32,10,16384
v_exp_f32 v91, v91
TR 34,10,20480
s_waitcnt lgkmcnt(7)
MA 100,16,120
v_cvt_pk_bf16_f32 v89, v90, v91
MA 104,16,136
MA 108,16,152
s_add_u32 m0, s61, 77824
s_add_u32 s66, s98, 118784
s_and_b32 s66, s66, 0x1ffff
s_waitcnt vmcnt(2)
s_add_u32 s66, s66, 2097152
buffer_load_dwordx4 v2, s[52:55], s66 offen nt lds
TR 16,11,16384
TR 18,11,20480
s_waitcnt lgkmcnt(8)
MA 100,20,124
MA 104,20,140
MA 108,20,156
TR 20,12,16384
TR 22,12,20480
s_waitcnt vmcnt(4)
s_barrier
MA 40,36,64
MA 44,36,68
MA 48,36,72
v_exp_f32 v100, v100
s_waitcnt lgkmcnt(8)
MA 160,24,64
v_exp_f32 v101, v101
MA 164,24,68
v_cvt_pk_bf16_f32 v90, v100, v101
v_exp_f32 v102, v102
MA 168,24,72
TR 24,13,16384
v_exp_f32 v103, v103
TR 26,13,20480
s_waitcnt lgkmcnt(8)
MA 172,28,64
v_cvt_pk_bf16_f32 v91, v102, v103
MA 176,28,68
v_exp_f32 v92, v92
MA 180,28,72
TR 28,14,16384
v_exp_f32 v93, v93
TR 30,14,20480
s_waitcnt lgkmcnt(8)
MA 184,32,64
v_cvt_pk_bf16_f32 v92, v92, v93
v_exp_f32 v94, v94
MA 188,32,68
v_exp_f32 v95, v95
MA 192,32,72
s_add_u32 m0, s61, 65536
s_add_u32 s66, s98, 122880
s_and_b32 s66, s66, 0x1ffff
s_waitcnt vmcnt(2)
s_add_u32 s66, s66, 2097152
buffer_load_dwordx4 v2, s[52:55], s66 offen nt lds
TR 32,15,16384
v_cvt_pk_bf16_f32 v93, v94, v95
TR 34,15,20480
s_waitcnt lgkmcnt(8)
MA 196,16,64
v_exp_f32 v104, v104
MA 200,16,68
v_exp_f32 v105, v105
MA 204,16,72
ds_read_b128 v[16:19], v4 offset:8192
v_cvt_pk_bf16_f32 v94, v104, v105
v_exp_f32 v106, v106
s_waitcnt lgkmcnt(7)
MA 208,20,64
v_exp_f32 v107, v107
MA 212,20,68
v_cvt_pk_bf16_f32 v95, v106, v107
MA 216,20,72
ds_read_b128 v[20:23], v5 offset:8192
v_exp_f32 v96, v96
s_waitcnt lgkmcnt(6)
MA 220,24,64
v_exp_f32 v97, v97
MA 224,24,68
v_cvt_pk_bf16_f32 v96, v96, v97
v_exp_f32 v98, v98
MA 228,24,72
ds_read_b128 v[24:27], v6 offset:8192
v_exp_f32 v99, v99
s_waitcnt lgkmcnt(5)
MA 232,28,64
v_cvt_pk_bf16_f32 v97, v98, v99
MA 236,28,68
v_exp_f32 v108, v108
MA 240,28,72
s_add_u32 m0, s61, 69632
s_add_u32 s66, s98, 126976
s_and_b32 s66, s66, 0x1ffff
s_waitcnt vmcnt(2)
s_add_u32 s66, s66, 2097152
buffer_load_dwordx4 v2, s[52:55], s66 offen nt lds
ds_read_b128 v[28:31], v7 offset:8192
v_exp_f32 v109, v109
s_waitcnt lgkmcnt(4)
MA 244,32,64
v_cvt_pk_bf16_f32 v98, v108, v109
v_exp_f32 v110, v110
MA 248,32,68
v_exp_f32 v111, v111
MA 252,32,72
ds_read_b128 v[32:35], v4 offset:12288
v_cvt_pk_bf16_f32 v99, v110, v111
s_waitcnt lgkmcnt(4)
MC 64,16,112,52
MC 68,16,128,56
MC 72,16,144,60
ds_read_b128 v[16:19], v5 offset:12288
s_waitcnt lgkmcnt(4)
MA 64,20,116
MA 68,20,132
MA 72,20,148
ds_read_b128 v[20:23], v6 offset:12288
s_waitcnt lgkmcnt(4)
MA 64,24,120
MA 68,24,136
MA 72,24,152
ds_read_b128 v[24:27], v7 offset:12288
s_waitcnt lgkmcnt(4)
MA 64,28,124
MA 68,28,140
MA 72,28,156
TR 28,8,8192
TR 30,8,12288
s_waitcnt lgkmcnt(5)
MC 76,32,112,52
MC 80,32,128,56
MC 84,32,144,60
TR 32,9,8192
v_exp_f32 v64, v64
TR 34,9,12288
s_waitcnt lgkmcnt(6)
MA 76,16,116
v_exp_f32 v65, v65
MA 80,16,132
v_cvt_pk_bf16_f32 v64, v64, v65
v_exp_f32 v66, v66
MA 84,16,148
TR 16,10,8192
v_exp_f32 v67, v67
TR 18,10,12288
s_waitcnt lgkmcnt(7)
MA 76,20,120
v_cvt_pk_bf16_f32 v65, v66, v67
MA 80,20,136
MA 84,20,152
TR 20,11,8192
TR 22,11,12288
s_waitcnt lgkmcnt(8)
MA 76,24,124
MA 80,24,140
MA 84,24,156
TR 24,12,8192
TR 26,12,12288
s_waitcnt vmcnt(2)
s_barrier
MA 40,36,88
MA 44,36,92
MA 48,36,96
v_exp_f32 v76, v76
s_waitcnt lgkmcnt(8)
MA 160,28,88
v_exp_f32 v77, v77
MA 164,28,92
v_cvt_pk_bf16_f32 v66, v76, v77
v_exp_f32 v78, v78
MA 168,28,96
TR 28,13,8192
v_exp_f32 v79, v79
TR 30,13,12288
s_waitcnt lgkmcnt(8)
MA 172,32,88
v_cvt_pk_bf16_f32 v67, v78, v79
MA 176,32,92
v_exp_f32 v68, v68
MA 180,32,96
TR 32,14,8192
v_exp_f32 v69, v69
TR 34,14,12288
s_waitcnt lgkmcnt(8)
MA 184,16,88
v_cvt_pk_bf16_f32 v68, v68, v69
v_exp_f32 v70, v70
MA 188,16,92
v_exp_f32 v71, v71
MA 192,16,96
TR 16,15,8192
v_cvt_pk_bf16_f32 v69, v70, v71
TR 18,15,12288
s_waitcnt lgkmcnt(8)
MA 196,20,88
v_exp_f32 v80, v80
MA 200,20,92
v_exp_f32 v81, v81
MA 204,20,96
ds_read_b128 v[20:23], v4 offset:16384
v_cvt_pk_bf16_f32 v70, v80, v81
v_exp_f32 v82, v82
s_waitcnt lgkmcnt(7)
MA 208,24,88
v_exp_f32 v83, v83
MA 212,24,92
v_cvt_pk_bf16_f32 v71, v82, v83
MA 216,24,96
ds_read_b128 v[24:27], v5 offset:16384
v_exp_f32 v72, v72
s_waitcnt lgkmcnt(6)
MA 220,28,88
v_exp_f32 v73, v73
MA 224,28,92
v_cvt_pk_bf16_f32 v72, v72, v73
v_exp_f32 v74, v74
MA 228,28,96
ds_read_b128 v[28:31], v6 offset:16384
v_exp_f32 v75, v75
s_waitcnt lgkmcnt(5)
MA 232,32,88
v_cvt_pk_bf16_f32 v73, v74, v75
MA 236,32,92
v_exp_f32 v84, v84
MA 240,32,96
ds_read_b128 v[32:35], v7 offset:16384
v_exp_f32 v85, v85
s_waitcnt lgkmcnt(4)
MA 244,16,88
v_cvt_pk_bf16_f32 v74, v84, v85
v_exp_f32 v86, v86
MA 248,16,92
v_exp_f32 v87, v87
MA 252,16,96
ds_read_b128 v[16:19], v4 offset:20480
v_cvt_pk_bf16_f32 v75, v86, v87
s_waitcnt lgkmcnt(4)
MC 88,20,112,52
MC 92,20,128,56
MC 96,20,144,60
ds_read_b128 v[20:23], v5 offset:20480
s_waitcnt lgkmcnt(4)
MA 88,24,116
MA 92,24,132
MA 96,24,148
ds_read_b128 v[24:27], v6 offset:20480
s_waitcnt lgkmcnt(4)
MA 88,28,120
MA 92,28,136
MA 96,28,152
ds_read_b128 v[28:31], v7 offset:20480
s_waitcnt lgkmcnt(4)
MA 88,32,124
MA 92,32,140
MA 96,32,156
TR 32,8,32768
TR 34,8,36864
s_waitcnt lgkmcnt(5)
MC 100,16,112,52
MC 104,16,128,56
MC 108,16,144,60
TR 16,9,32768
v_exp_f32 v88, v88
TR 18,9,36864
s_waitcnt lgkmcnt(6)
MA 100,20,116
v_exp_f32 v89, v89
MA 104,20,132
v_cvt_pk_bf16_f32 v88, v88, v89
v_exp_f32 v90, v90
MA 108,20,148
TR 20,10,32768
v_exp_f32 v91, v91
TR 22,10,36864
s_waitcnt lgkmcnt(7)
MA 100,24,120
v_cvt_pk_bf16_f32 v89, v90, v91
MA 104,24,136
MA 108,24,152
TR 24,11,32768
TR 26,11,36864
s_waitcnt lgkmcnt(8)
MA 100,28,124
MA 104,28,140
MA 108,28,156
TR 28,12,32768
TR 30,12,36864
s_waitcnt vmcnt(0)
s_barrier
v_mbcnt_lo_u32_b32 v59, -1, 0
v_mbcnt_hi_u32_b32 v59, -1, v59
s_movk_i32 s75, 3641
s_mul_i32 s73, s60, 144
v_add_u32 v60, s73, v59
v_mul_u32_u24 v61, s75, v60
v_lshrrev_b32 v61, 16, v61
v_mul_u32_u24 v62, 18, v61
v_sub_u32 v62, v60, v62
v_mul_u32_u24 v61, 1152, v61
v_lshl_add_u32 v52, v62, 4, v61
v_add_u32 v60, s73, v59
v_add_u32 v60, 64, v60
v_mul_u32_u24 v61, s75, v60
v_lshrrev_b32 v61, 16, v61
v_mul_u32_u24 v62, 18, v61
v_sub_u32 v62, v60, v62
v_mul_u32_u24 v61, 1152, v61
v_lshl_add_u32 v53, v62, 4, v61
v_add_u32 v60, s73, v59
v_add_u32 v60, 128, v60
v_mul_u32_u24 v61, s75, v60
v_lshrrev_b32 v61, 16, v61
v_mul_u32_u24 v62, 18, v61
v_sub_u32 v62, v60, v62
v_mul_u32_u24 v61, 1152, v61
v_lshl_add_u32 v54, v62, 4, v61
v_lshrrev_b32 v60, 2, v59
v_mul_u32_u24 v60, 288, v60
v_and_b32 v61, 3, v59
v_lshl_add_u32 v60, v61, 3, v60
v_add_u32 v57, s63, v60
v_lshl_add_u32 v55, v59, 4, s94
v_add_u32 v58, 0, v55
buffer_load_dwordx4 v[112:115], v58, s[56:59], 0 offen offset:0 sc1
buffer_load_dwordx4 v[116:119], v58, s[56:59], s64 offen offset:0 sc1
buffer_load_dwordx4 v[120:123], v58, s[56:59], s65 offen offset:0 sc1
buffer_load_dwordx4 v[124:127], v58, s[56:59], 0 offen offset:1024 sc1
buffer_load_dwordx4 v[128:131], v58, s[56:59], s64 offen offset:1024 sc1
buffer_load_dwordx4 v[132:135], v58, s[56:59], s65 offen offset:1024 sc1
buffer_load_dwordx4 v[136:139], v58, s[56:59], 0 offen offset:2048 sc1
buffer_load_dwordx4 v[140:143], v58, s[56:59], s64 offen offset:2048 sc1
buffer_load_dwordx4 v[144:147], v58, s[56:59], s65 offen offset:2048 sc1
MA 40,36,64
v_exp_f32 v100, v100
MA 44,36,68
s_add_u32 m0, s88, 27648
s_add_u32 s66, s8, 2359296
buffer_load_dwordx4 v52, s[16:19], s66 offen lds
v_exp_f32 v101, v101
MA 48,36,72
v_cvt_pk_bf16_f32 v90, v100, v101
v_exp_f32 v102, v102
s_waitcnt lgkmcnt(8)
MA 160,32,64
s_add_u32 m0, s88, 28672
s_add_u32 s66, s8, 2359296
buffer_load_dwordx4 v53, s[16:19], s66 offen lds
v_exp_f32 v103, v103
MA 164,32,68
v_cvt_pk_bf16_f32 v91, v102, v103
MA 168,32,72
s_add_u32 m0, s88, 29696
s_add_u32 s66, s8, 2359296
s_mov_b64 exec, 0xffff
buffer_load_dwordx4 v54, s[16:19], s66 offen lds
s_mov_b64 exec, -1
TR 32,13,32768
v_exp_f32 v92, v92
TR 34,13,36864
s_waitcnt lgkmcnt(8)
MA 172,16,64
v_exp_f32 v93, v93
MA 176,16,68
s_add_u32 m0, s88, 0
s_add_u32 s66, s8, 2396160
buffer_load_dwordx4 v52, s[16:19], s66 offen lds
v_cvt_pk_bf16_f32 v92, v92, v93
v_exp_f32 v94, v94
MA 180,16,72
TR 16,14,32768
v_exp_f32 v95, v95
TR 18,14,36864
s_waitcnt lgkmcnt(8)
MA 184,20,64
s_add_u32 m0, s88, 1024
s_add_u32 s66, s8, 2396160
buffer_load_dwordx4 v53, s[16:19], s66 offen lds
v_cvt_pk_bf16_f32 v93, v94, v95
MA 188,20,68
v_exp_f32 v104, v104
MA 192,20,72
s_add_u32 m0, s88, 2048
s_add_u32 s66, s8, 2396160
s_mov_b64 exec, 0xffff
buffer_load_dwordx4 v54, s[16:19], s66 offen lds
s_mov_b64 exec, -1
TR 20,15,32768
v_exp_f32 v105, v105
TR 22,15,36864
s_waitcnt lgkmcnt(8)
MA 196,24,64
v_cvt_pk_bf16_f32 v94, v104, v105
v_exp_f32 v106, v106
MA 200,24,68
s_add_u32 m0, s88, 9216
s_add_u32 s66, s8, 2433024
buffer_load_dwordx4 v52, s[16:19], s66 offen lds
v_exp_f32 v107, v107
MA 204,24,72
TR 24,8,24576
v_cvt_pk_bf16_f32 v95, v106, v107
TR 26,8,28672
s_waitcnt lgkmcnt(8)
MA 208,28,64
s_add_u32 m0, s88, 10240
s_add_u32 s66, s8, 2433024
buffer_load_dwordx4 v53, s[16:19], s66 offen lds
v_exp_f32 v96, v96
MA 212,28,68
v_exp_f32 v97, v97
MA 216,28,72
s_add_u32 m0, s88, 11264
s_add_u32 s66, s8, 2433024
s_mov_b64 exec, 0xffff
buffer_load_dwordx4 v54, s[16:19], s66 offen lds
s_mov_b64 exec, -1
TR 28,9,24576
v_cvt_pk_bf16_f32 v96, v96, v97
TR 30,9,28672
v_exp_f32 v98, v98
s_waitcnt lgkmcnt(8)
MA 220,32,64
v_exp_f32 v99, v99
MA 224,32,68
v_cvt_pk_bf16_f32 v97, v98, v99
MA 228,32,72
TR 32,10,24576
v_exp_f32 v108, v108
TR 34,10,28672
s_waitcnt lgkmcnt(8)
MA 232,16,64
v_exp_f32 v109, v109
MA 236,16,68
v_cvt_pk_bf16_f32 v98, v108, v109
v_exp_f32 v110, v110
MA 240,16,72
v_exp_f32 v111, v111
s_waitcnt lgkmcnt(6)
MA 244,20,64
v_cvt_pk_bf16_f32 v99, v110, v111
MA 248,20,68
s_add_u32 m0, s88, 18432
s_add_u32 s66, s8, 2469888
buffer_load_dwordx4 v52, s[16:19], s66 offen lds
MA 252,20,72
MA 40,36,88
MA 44,36,92
MA 48,36,96
s_waitcnt lgkmcnt(4)
MA 160,24,88
MA 164,24,92
MA 168,24,96
s_waitcnt lgkmcnt(2)
MA 172,28,88
s_add_u32 m0, s88, 19456
s_add_u32 s66, s8, 2469888
buffer_load_dwordx4 v53, s[16:19], s66 offen lds
MA 176,28,92
MA 180,28,96
v_rcp_f32 v42, v40
s_waitcnt lgkmcnt(0)
MA 184,32,88
v_mov_b32 v43, v42
v_rcp_f32 v46, v44
MA 188,32,92
v_mov_b32 v47, v46
v_rcp_f32 v50, v48
MA 192,32,96
v_mov_b32 v51, v50
v_pk_mul_f32 v[160:161], v[160:161], v[42:43]
v_pk_mul_f32 v[162:163], v[162:163], v[42:43]
v_cmp_nge_f32 vcc, s67, v40
v_cmp_nge_f32 s[72:73], s67, v44
v_cmp_nge_f32 s[74:75], s67, v48
s_nop 4
s_or_b64 s[72:73], s[72:73], s[74:75]
s_or_b64 s[72:73], s[72:73], vcc
s_cmp_lg_u64 s[72:73], 0
s_cselect_b32 s72, 1, 0
s_lshl_b32 s73, s62, 2
v_mov_b32 v60, s73
v_mov_b32 v61, s72
ds_write_b32 v60, v61 offset:36864
TR 16,11,24576
TR 18,11,28672
s_waitcnt lgkmcnt(0)
MA 196,16,88
TR 20,12,24576
v_pk_mul_f32 v[172:173], v[172:173], v[42:43]
TR 22,12,28672
v_pk_mul_f32 v[174:175], v[174:175], v[42:43]
v_cvt_pk_bf16_f32 v64, v160, v161
MA 200,16,92
TR 24,13,24576
v_cvt_pk_bf16_f32 v65, v162, v163
TR 26,13,28672
v_cvt_pk_bf16_f32 v66, v172, v173
v_cvt_pk_bf16_f32 v67, v174, v175
MA 204,16,96
s_add_u32 m0, s88, 20480
s_add_u32 s66, s8, 2469888
s_mov_b64 exec, 0xffff
buffer_load_dwordx4 v54, s[16:19], s66 offen lds
s_mov_b64 exec, -1
TR 28,14,24576
v_pk_mul_f32 v[164:165], v[164:165], v[46:47]
TR 30,14,28672
v_pk_mul_f32 v[166:167], v[166:167], v[46:47]
v_pk_mul_f32 v[176:177], v[176:177], v[46:47]
s_waitcnt lgkmcnt(4)
MA 208,20,88
TR 32,15,24576
v_pk_mul_f32 v[178:179], v[178:179], v[46:47]
TR 34,15,28672
v_cvt_pk_bf16_f32 v68, v164, v165
v_cvt_pk_bf16_f32 v69, v166, v167
MA 212,20,92
v_cvt_pk_bf16_f32 v70, v176, v177
v_cvt_pk_bf16_f32 v71, v178, v179
v_pk_mul_f32 v[168:169], v[168:169], v[50:51]
MA 216,20,96
v_pk_mul_f32 v[170:171], v[170:171], v[50:51]
v_pk_mul_f32 v[180:181], v[180:181], v[50:51]
v_pk_mul_f32 v[182:183], v[182:183], v[50:51]
s_waitcnt lgkmcnt(4)
MA 220,24,88
v_cvt_pk_bf16_f32 v72, v168, v169
v_cvt_pk_bf16_f32 v73, v170, v171
v_cvt_pk_bf16_f32 v74, v180, v181
MA 224,24,92
v_cvt_pk_bf16_f32 v75, v182, v183
v_pk_mul_f32 v[184:185], v[184:185], v[42:43]
v_pk_mul_f32 v[186:187], v[186:187], v[42:43]
MA 228,24,96
v_pk_mul_f32 v[196:197], v[196:197], v[42:43]
v_pk_mul_f32 v[198:199], v[198:199], v[42:43]
v_cvt_pk_bf16_f32 v76, v184, v185
s_waitcnt lgkmcnt(2)
MA 232,28,88
v_cvt_pk_bf16_f32 v77, v186, v187
v_cvt_pk_bf16_f32 v78, v196, v197
v_cvt_pk_bf16_f32 v79, v198, v199
MA 236,28,92
s_add_u32 m0, s88, 46080
s_mov_b32 s66, 0
buffer_load_dwordx4 v52, s[16:19], s66 offen lds
v_pk_mul_f32 v[188:189], v[188:189], v[46:47]
v_pk_mul_f32 v[190:191], v[190:191], v[46:47]
v_pk_mul_f32 v[200:201], v[200:201], v[46:47]
MA 240,28,96
v_pk_mul_f32 v[202:203], v[202:203], v[46:47]
v_cvt_pk_bf16_f32 v80, v188, v189
v_cvt_pk_bf16_f32 v81, v190, v191
s_waitcnt lgkmcnt(0)
MA 244,32,88
v_cvt_pk_bf16_f32 v82, v200, v201
v_cvt_pk_bf16_f32 v83, v202, v203
v_pk_mul_f32 v[192:193], v[192:193], v[50:51]
MA 248,32,92
v_pk_mul_f32 v[194:195], v[194:195], v[50:51]
v_pk_mul_f32 v[204:205], v[204:205], v[50:51]
v_pk_mul_f32 v[206:207], v[206:207], v[50:51]
MA 252,32,96
v_cvt_pk_bf16_f32 v84, v192, v193
v_cvt_pk_bf16_f32 v85, v194, v195
v_cvt_pk_bf16_f32 v86, v204, v205
v_cvt_pk_bf16_f32 v87, v206, v207
v_pk_mul_f32 v[208:209], v[208:209], v[42:43]
v_pk_mul_f32 v[210:211], v[210:211], v[42:43]
v_pk_mul_f32 v[220:221], v[220:221], v[42:43]
v_pk_mul_f32 v[222:223], v[222:223], v[42:43]
v_cvt_pk_bf16_f32 v100, v208, v209
v_cvt_pk_bf16_f32 v101, v210, v211
v_cvt_pk_bf16_f32 v102, v220, v221
v_cvt_pk_bf16_f32 v103, v222, v223
v_pk_mul_f32 v[212:213], v[212:213], v[46:47]
v_pk_mul_f32 v[214:215], v[214:215], v[46:47]
v_pk_mul_f32 v[224:225], v[224:225], v[46:47]
v_pk_mul_f32 v[226:227], v[226:227], v[46:47]
v_cvt_pk_bf16_f32 v104, v212, v213
v_cvt_pk_bf16_f32 v105, v214, v215
v_cvt_pk_bf16_f32 v106, v224, v225
v_cvt_pk_bf16_f32 v107, v226, v227
v_pk_mul_f32 v[216:217], v[216:217], v[50:51]
v_pk_mul_f32 v[218:219], v[218:219], v[50:51]
v_pk_mul_f32 v[228:229], v[228:229], v[50:51]
v_pk_mul_f32 v[230:231], v[230:231], v[50:51]
v_cvt_pk_bf16_f32 v108, v216, v217
v_cvt_pk_bf16_f32 v109, v218, v219
v_cvt_pk_bf16_f32 v110, v228, v229
v_cvt_pk_bf16_f32 v111, v230, v231
v_pk_mul_f32 v[232:233], v[232:233], v[42:43]
v_pk_mul_f32 v[234:235], v[234:235], v[42:43]
v_pk_mul_f32 v[244:245], v[244:245], v[42:43]
v_pk_mul_f32 v[246:247], v[246:247], v[42:43]
v_cvt_pk_bf16_f32 v88, v232, v233
v_cvt_pk_bf16_f32 v89, v234, v235
v_cvt_pk_bf16_f32 v90, v244, v245
v_cvt_pk_bf16_f32 v91, v246, v247
v_pk_mul_f32 v[236:237], v[236:237], v[46:47]
v_pk_mul_f32 v[238:239], v[238:239], v[46:47]
v_pk_mul_f32 v[248:249], v[248:249], v[46:47]
v_pk_mul_f32 v[250:251], v[250:251], v[46:47]
v_cvt_pk_bf16_f32 v92, v236, v237
v_cvt_pk_bf16_f32 v93, v238, v239
v_cvt_pk_bf16_f32 v94, v248, v249
v_cvt_pk_bf16_f32 v95, v250, v251
v_pk_mul_f32 v[240:241], v[240:241], v[50:51]
v_pk_mul_f32 v[242:243], v[242:243], v[50:51]
v_pk_mul_f32 v[252:253], v[252:253], v[50:51]
v_pk_mul_f32 v[254:255], v[254:255], v[50:51]
v_cvt_pk_bf16_f32 v96, v240, v241
v_cvt_pk_bf16_f32 v97, v242, v243
v_cvt_pk_bf16_f32 v98, v252, v253
v_cvt_pk_bf16_f32 v99, v254, v255
s_add_u32 m0, s88, 47104
s_mov_b32 s66, 0
buffer_load_dwordx4 v53, s[16:19], s66 offen lds
s_add_u32 m0, s88, 48128
s_mov_b32 s66, 0
s_mov_b64 exec, 0xffff
buffer_load_dwordx4 v54, s[16:19], s66 offen lds
s_mov_b64 exec, -1
s_add_u32 m0, s88, 55296
s_mov_b32 s66, 36864
buffer_load_dwordx4 v52, s[16:19], s66 offen lds
s_add_u32 m0, s88, 56320
s_mov_b32 s66, 36864
buffer_load_dwordx4 v53, s[16:19], s66 offen lds
s_add_u32 m0, s88, 57344
s_mov_b32 s66, 36864
s_mov_b64 exec, 0xffff
buffer_load_dwordx4 v54, s[16:19], s66 offen lds
s_mov_b64 exec, -1
L_after1:
s_waitcnt lgkmcnt(0)
v_mbcnt_lo_u32_b32 v44, -1, 0
v_mbcnt_hi_u32_b32 v44, -1, v44
s_add_u32 s72, s89, 65536
v_lshl_add_u32 v44, v44, 4, s72
s_waitcnt vmcnt(9)
s_barrier
v_mbcnt_lo_u32_b32 v45, -1, 0
v_mbcnt_hi_u32_b32 v45, -1, v45
v_and_b32 v45, 7, v45
v_lshlrev_b32 v45, 2, v45
ds_read_b32 v45, v45 offset:36864
TR 16,57,27648
TR 18,57,32256
s_waitcnt lgkmcnt(0)
MZ 148,16,64
TR 20,57,27680
TR 22,57,32288
MZ 152,16,68
TR 24,57,27712
TR 26,57,32320
MZ 156,16,72
buffer_load_dwordx4 v[4:7], v58, s[56:59], 0 offen offset:3072 sc1
s_waitcnt lgkmcnt(2)
MZ 160,20,64
MZ 164,20,68
MZ 168,20,72
buffer_load_dwordx4 v[8:11], v58, s[56:59], s64 offen offset:3072 sc1
s_waitcnt lgkmcnt(0)
MZ 172,24,64
MZ 176,24,68
MZ 180,24,72
buffer_load_dwordx4 v[12:15], v58, s[56:59], s65 offen offset:3072 sc1
v_cmp_ne_u32 vcc, 0, v45
s_mov_b32 s78, 36864
s_mov_b32 s99, 1
s_nop 3
s_cmp_lg_u64 vcc, 0
s_cbranch_scc1 L_fallback
TR 28,57,27744
TR 30,57,32352
s_waitcnt lgkmcnt(0)
MZ 184,28,64
TR 32,57,27776
v_lshl_add_u32 v46, v59, 4, s36
TR 34,57,32384
v_lshl_add_u32 v47, v59, 4, s37
MZ 188,28,68
TR 16,57,27808
v_lshlrev_b32 v49, 4, v59
TR 18,57,32416
MZ 192,28,72
TR 20,57,27840
v_and_b32 v48, 15, v59
TR 22,57,32448
s_waitcnt lgkmcnt(4)
MZ 196,32,64
TR 24,57,27872
v_mul_u32_u24 v48, 2304, v48
TR 26,57,32480
MZ 200,32,68
TR 28,57,27904
v_lshrrev_b32 v50, 4, v59
TR 30,57,32512
v_lshl_add_u32 v48, v50, 3, v48
buffer_store_dwordx4 v[64:67], v44, s[56:59], 0 offen offset:0 sc1
MZ 204,32,72
TR 32,57,0
TR 34,57,4608
s_waitcnt lgkmcnt(8)
MZ 208,16,64
MZ 212,16,68
MZ 216,16,72
TR 16,57,32
TR 18,57,4640
s_waitcnt lgkmcnt(8)
MZ 220,20,64
MZ 224,20,68
MZ 228,20,72
TR 20,57,64
TR 22,57,4672
s_waitcnt lgkmcnt(8)
MZ 232,24,64
MZ 236,24,68
MZ 240,24,72
TR 24,57,96
TR 26,57,4704
buffer_store_dwordx4 v[68:71], v44, s[56:59], s64 offen offset:0 sc1
s_waitcnt lgkmcnt(8)
MZ 244,28,64
MZ 248,28,68
MZ 252,28,72
TR 28,57,128
TR 30,57,4736
s_waitcnt lgkmcnt(8)
MA 148,32,76
MA 152,32,80
MA 156,32,84
TR 32,57,160
TR 34,57,4768
s_waitcnt lgkmcnt(8)
MA 160,16,76
MA 164,16,80
MA 168,16,84
TR 16,57,192
TR 18,57,4800
s_waitcnt lgkmcnt(8)
MA 172,20,76
buffer_store_dwordx4 v[72:75], v44, s[56:59], s65 offen offset:0 sc1
MA 176,20,80
MA 180,20,84
TR 20,57,224
TR 22,57,4832
s_waitcnt lgkmcnt(8)
MA 184,24,76
MA 188,24,80
MA 192,24,84
TR 24,57,256
TR 26,57,4864
s_waitcnt lgkmcnt(8)
MA 196,28,76
MA 200,28,80
MA 204,28,84
TR 28,57,9216
TR 30,57,13824
s_waitcnt lgkmcnt(8)
MA 208,32,76
MA 212,32,80
MA 216,32,84
TR 32,57,9248
TR 34,57,13856
s_waitcnt lgkmcnt(8)
MA 220,16,76
MA 224,16,80
MA 228,16,84
TR 16,57,9280
TR 18,57,13888
s_waitcnt lgkmcnt(8)
MA 232,20,76
MA 236,20,80
MA 240,20,84
TR 20,57,9312
TR 22,57,13920
s_waitcnt lgkmcnt(8)
MA 244,24,76
MA 248,24,80
MA 252,24,84
TR 24,57,9344
TR 26,57,13952
s_waitcnt vmcnt(9)
s_barrier
s_waitcnt lgkmcnt(8)
MA 148,28,100
s_add_u32 m0, s88, 0
s_mov_b32 s66, 73728
buffer_load_dwordx4 v52, s[16:19], s66 offen lds
MA 152,28,104
MA 156,28,108
s_add_u32 m0, s88, 1024
s_mov_b32 s66, 73728
buffer_load_dwordx4 v53, s[16:19], s66 offen lds
TR 28,57,9376
TR 30,57,13984
s_waitcnt lgkmcnt(8)
MA 160,32,100
MA 164,32,104
s_add_u32 m0, s88, 2048
s_mov_b32 s66, 73728
s_mov_b64 exec, 0xffff
buffer_load_dwordx4 v54, s[16:19], s66 offen lds
s_mov_b64 exec, -1
MA 168,32,108
TR 32,57,9408
TR 34,57,14016
s_waitcnt lgkmcnt(8)
MA 172,16,100
MA 176,16,104
MA 180,16,108
TR 16,57,9440
TR 18,57,14048
s_waitcnt lgkmcnt(8)
MA 184,20,100
MA 188,20,104
MA 192,20,108
TR 20,57,9472
TR 22,57,14080
s_waitcnt lgkmcnt(8)
MA 196,24,100
s_add_u32 m0, s88, 27648
s_mov_b32 s66, 110592
buffer_load_dwordx4 v52, s[16:19], s66 offen lds
MA 200,24,104
buffer_store_dwordx4 v[76:79], v44, s[56:59], 0 offen offset:1024 sc1
MA 204,24,108
TR 24,57,18432
TR 26,57,23040
s_waitcnt lgkmcnt(8)
MA 208,28,100
MA 212,28,104
MA 216,28,108
TR 28,57,18464
TR 30,57,23072
s_waitcnt lgkmcnt(8)
MA 220,32,100
MA 224,32,104
MA 228,32,108
s_add_u32 m0, s88, 28672
s_mov_b32 s66, 110592
buffer_load_dwordx4 v53, s[16:19], s66 offen lds
TR 32,57,18496
TR 34,57,23104
s_waitcnt lgkmcnt(8)
MA 232,16,100
MA 236,16,104
MA 240,16,108
TR 16,57,18528
TR 18,57,23136
buffer_store_dwordx4 v[80:83], v44, s[56:59], s64 offen offset:1024 sc1
s_waitcnt lgkmcnt(8)
MA 244,20,100
MA 248,20,104
MA 252,20,108
TR 20,57,18560
TR 22,57,23168
s_waitcnt lgkmcnt(8)
MA 148,24,88
MA 152,24,92
s_add_u32 m0, s88, 29696
s_mov_b32 s66, 110592
s_mov_b64 exec, 0xffff
buffer_load_dwordx4 v54, s[16:19], s66 offen lds
s_mov_b64 exec, -1
MA 156,24,96
TR 24,57,18592
TR 26,57,23200
s_waitcnt lgkmcnt(8)
MA 160,28,88
MA 164,28,92
MA 168,28,96
TR 28,57,18624
TR 30,57,23232
s_waitcnt lgkmcnt(8)
MA 172,32,88
buffer_store_dwordx4 v[84:87], v44, s[56:59], s65 offen offset:1024 sc1
MA 176,32,92
MA 180,32,96
TR 32,57,18656
TR 34,57,23264
s_waitcnt lgkmcnt(8)
MA 184,16,88
s_add_u32 m0, s88, 36864
s_mov_b32 s66, 294912
buffer_load_dwordx4 v52, s[16:19], s66 offen lds
MA 188,16,92
MA 192,16,96
TR 16,57,18688
TR 18,57,23296
s_waitcnt lgkmcnt(8)
MA 196,20,88
MA 200,20,92
MA 204,20,96
TR 20,57,46080
TR 22,57,50688
s_waitcnt lgkmcnt(8)
MA 208,24,88
MA 212,24,92
MA 216,24,96
s_add_u32 m0, s88, 37888
s_mov_b32 s66, 294912
buffer_load_dwordx4 v53, s[16:19], s66 offen lds
TR 24,57,46112
TR 26,57,50720
s_waitcnt lgkmcnt(8)
MA 220,28,88
MA 224,28,92
MA 228,28,96
TR 28,57,46144
TR 30,57,50752
s_waitcnt lgkmcnt(8)
MA 232,32,88
MA 236,32,92
MA 240,32,96
TR 32,57,46176
TR 34,57,50784
s_waitcnt lgkmcnt(8)
MA 244,16,88
MA 248,16,92
s_add_u32 m0, s88, 38912
s_mov_b32 s66, 294912
s_mov_b64 exec, 0xffff
buffer_load_dwordx4 v54, s[16:19], s66 offen lds
s_mov_b64 exec, -1
MA 252,16,96
TR 16,57,46208
TR 18,57,50816
s_waitcnt vmcnt(9)
s_barrier
s_waitcnt lgkmcnt(8)
MA 148,20,112
MA 152,20,116
MA 156,20,120
TR 20,57,46240
TR 22,57,50848
s_waitcnt lgkmcnt(8)
MA 160,24,112
MA 164,24,116
MA 168,24,120
TR 24,57,46272
TR 26,57,50880
s_waitcnt lgkmcnt(8)
MA 172,28,112
MA 176,28,116
s_add_u32 m0, s88, 9216
s_mov_b32 s66, 331776
buffer_load_dwordx4 v52, s[16:19], s66 offen lds
MA 180,28,120
TR 28,57,46304
TR 30,57,50912
s_waitcnt lgkmcnt(8)
MA 184,32,112
MA 188,32,116
MA 192,32,120
TR 32,57,46336
TR 34,57,50944
s_waitcnt lgkmcnt(8)
MA 196,16,112
MA 200,16,116
buffer_store_dwordx4 v[100:103], v44, s[56:59], 0 offen offset:2048 sc1
MA 204,16,120
TR 16,57,55296
TR 18,57,59904
s_waitcnt lgkmcnt(8)
MA 208,20,112
s_add_u32 m0, s88, 10240
s_mov_b32 s66, 331776
buffer_load_dwordx4 v53, s[16:19], s66 offen lds
MA 212,20,116
MA 216,20,120
TR 20,57,55328
TR 22,57,59936
s_waitcnt lgkmcnt(8)
MA 220,24,112
MA 224,24,116
MA 228,24,120
TR 24,57,55360
TR 26,57,59968
s_waitcnt lgkmcnt(8)
MA 232,28,112
MA 236,28,116
MA 240,28,120
s_add_u32 m0, s88, 11264
s_mov_b32 s66, 331776
s_mov_b64 exec, 0xffff
buffer_load_dwordx4 v54, s[16:19], s66 offen lds
s_mov_b64 exec, -1
TR 28,57,55392
TR 30,57,60000
buffer_store_dwordx4 v[104:107], v44, s[56:59], s64 offen offset:2048 sc1
s_waitcnt lgkmcnt(8)
MA 244,32,112
MA 248,32,116
MA 252,32,120
TR 32,57,55424
TR 34,57,60032
s_waitcnt lgkmcnt(8)
MA 148,16,124
MA 152,16,128
MA 156,16,132
TR 16,57,55456
TR 18,57,60064
v_add_u32 v58, 8192, v55
s_waitcnt lgkmcnt(8)
MA 160,20,124
MA 164,20,128
s_add_u32 m0, s88, 18432
s_mov_b32 s66, 368640
buffer_load_dwordx4 v52, s[16:19], s66 offen lds
MA 168,20,132
TR 20,57,55488
TR 22,57,60096
buffer_load_dwordx4 v[112:115], v58, s[56:59], 0 offen offset:0 sc1
s_waitcnt lgkmcnt(8)
MA 172,24,124
buffer_store_dwordx4 v[108:111], v44, s[56:59], s65 offen offset:2048 sc1
MA 176,24,128
MA 180,24,132
TR 24,57,55520
TR 26,57,60128
buffer_load_dwordx4 v[116:119], v58, s[56:59], s64 offen offset:0 sc1
s_waitcnt lgkmcnt(8)
MA 184,28,124
MA 188,28,128
MA 192,28,132
TR 28,57,55552
TR 30,57,60160
buffer_load_dwordx4 v[120:123], v58, s[56:59], s65 offen offset:0 sc1
s_waitcnt lgkmcnt(8)
MA 196,32,124
s_add_u32 m0, s88, 19456
s_mov_b32 s66, 368640
buffer_load_dwordx4 v53, s[16:19], s66 offen lds
MA 200,32,128
MA 204,32,132
TR 32,57,0
TR 34,57,4608
s_waitcnt lgkmcnt(8)
MA 208,16,124
MA 212,16,128
MA 216,16,132
TR 16,57,32
TR 18,57,4640
s_waitcnt lgkmcnt(8)
MA 220,20,124
MA 224,20,128
MA 228,20,132
s_add_u32 m0, s88, 20480
s_mov_b32 s66, 368640
s_mov_b64 exec, 0xffff
buffer_load_dwordx4 v54, s[16:19], s66 offen lds
s_mov_b64 exec, -1
TR 20,57,64
TR 22,57,4672
s_waitcnt lgkmcnt(8)
MA 232,24,124
MA 236,24,128
MA 240,24,132
TR 24,57,96
TR 26,57,4704
s_waitcnt lgkmcnt(8)
MA 244,28,124
MA 248,28,128
MA 252,28,132
TR 28,57,128
TR 30,57,4736
s_waitcnt vmcnt(12)
s_barrier
s_waitcnt lgkmcnt(8)
MA 148,32,136
MA 152,32,140
MA 156,32,144
TR 32,57,160
TR 34,57,4768
buffer_load_dwordx4 v[124:127], v58, s[56:59], 0 offen offset:1024 sc1
s_waitcnt lgkmcnt(8)
MA 160,16,136
MA 164,16,140
MA 168,16,144
TR 16,57,192
TR 18,57,4800
buffer_load_dwordx4 v[128:131], v58, s[56:59], s64 offen offset:1024 sc1
s_waitcnt lgkmcnt(8)
MA 172,20,136
MA 176,20,140
s_add_u32 m0, s88, 46080
s_mov_b32 s66, 405504
buffer_load_dwordx4 v52, s[16:19], s66 offen lds
MA 180,20,144
TR 20,57,224
TR 22,57,4832
buffer_load_dwordx4 v[132:135], v58, s[56:59], s65 offen offset:1024 sc1
s_waitcnt lgkmcnt(8)
MA 184,24,136
MA 188,24,140
MA 192,24,144
TR 24,57,256
TR 26,57,4864
s_waitcnt lgkmcnt(8)
MA 196,28,136
MA 200,28,140
buffer_store_dwordx4 v[88:91], v44, s[56:59], 0 offen offset:3072 sc1
MA 204,28,144
TR 28,57,27648
TR 30,57,32256
s_waitcnt lgkmcnt(8)
MA 208,32,136
s_add_u32 m0, s88, 47104
s_mov_b32 s66, 405504
buffer_load_dwordx4 v53, s[16:19], s66 offen lds
MA 212,32,140
MA 216,32,144
TR 32,57,27680
TR 34,57,32288
s_waitcnt lgkmcnt(8)
MA 220,16,136
MA 224,16,140
MA 228,16,144
TR 16,57,27712
TR 18,57,32320
s_waitcnt lgkmcnt(8)
MA 232,20,136
MA 236,20,140
MA 240,20,144
s_add_u32 m0, s88, 48128
s_mov_b32 s66, 405504
s_mov_b64 exec, 0xffff
buffer_load_dwordx4 v54, s[16:19], s66 offen lds
s_mov_b64 exec, -1
TR 20,57,27744
TR 22,57,32352
buffer_store_dwordx4 v[92:95], v44, s[56:59], s64 offen offset:3072 sc1
s_waitcnt lgkmcnt(8)
MA 244,24,136
MA 248,24,140
MA 252,24,144
TR 24,57,27776
TR 26,57,32384
s_waitcnt lgkmcnt(8)
MA 148,28,4
MA 152,28,8
MA 156,28,12
TR 28,57,27808
TR 30,57,32416
buffer_load_dwordx4 v[136:139], v58, s[56:59], 0 offen offset:2048 sc1
s_waitcnt lgkmcnt(8)
MA 160,32,4
MA 164,32,8
s_add_u32 m0, s88, 55296
s_mov_b32 s66, 589824
buffer_load_dwordx4 v52, s[16:19], s66 offen lds
MA 168,32,12
TR 32,57,27840
TR 34,57,32448
buffer_load_dwordx4 v[140:143], v58, s[56:59], s64 offen offset:2048 sc1
s_waitcnt lgkmcnt(8)
MA 172,16,4
buffer_store_dwordx4 v[96:99], v44, s[56:59], s65 offen offset:3072 sc1
MA 176,16,8
MA 180,16,12
TR 16,57,27872
TR 18,57,32480
buffer_load_dwordx4 v[144:147], v58, s[56:59], s65 offen offset:2048 sc1
s_waitcnt lgkmcnt(8)
MA 184,20,4
MA 188,20,8
MA 192,20,12
TR 20,57,27904
TR 22,57,32512
s_waitcnt lgkmcnt(8)
MA 196,24,4
s_add_u32 m0, s88, 56320
s_mov_b32 s66, 589824
buffer_load_dwordx4 v53, s[16:19], s66 offen lds
MA 200,24,8
MA 204,24,12
TR 24,57,36864
TR 26,57,41472
s_waitcnt lgkmcnt(8)
MA 208,28,4
MA 212,28,8
MA 216,28,12
TR 28,57,36896
TR 30,57,41504
s_waitcnt lgkmcnt(8)
MA 220,32,4
MA 224,32,8
MA 228,32,12
s_add_u32 m0, s88, 57344
s_mov_b32 s66, 589824
s_mov_b64 exec, 0xffff
buffer_load_dwordx4 v54, s[16:19], s66 offen lds
s_mov_b64 exec, -1
TR 32,57,36928
TR 34,57,41536
s_waitcnt lgkmcnt(8)
MA 232,16,4
MA 236,16,8
MA 240,16,12
TR 16,57,36960
TR 18,57,41568
s_waitcnt lgkmcnt(8)
MA 244,20,4
MA 248,20,8
MA 252,20,12
TR 20,57,36992
TR 22,57,41600
s_waitcnt vmcnt(15)
s_barrier
s_waitcnt lgkmcnt(8)
MA 148,24,112
MA 152,24,116
MA 156,24,120
TR 24,57,37024
TR 26,57,41632
buffer_load_dwordx4 v[4:7], v58, s[56:59], 0 offen offset:3072 sc1
s_waitcnt lgkmcnt(8)
MA 160,28,112
MA 164,28,116
MA 168,28,120
TR 28,57,37056
TR 30,57,41664
buffer_load_dwordx4 v[8:11], v58, s[56:59], s64 offen offset:3072 sc1
s_waitcnt lgkmcnt(8)
MA 172,32,112
MA 176,32,116
s_add_u32 m0, s88, 0
s_mov_b32 s66, 626688
buffer_load_dwordx4 v52, s[16:19], s66 offen lds
MA 180,32,120
TR 32,57,37088
TR 34,57,41696
buffer_load_dwordx4 v[12:15], v58, s[56:59], s65 offen offset:3072 sc1
s_waitcnt lgkmcnt(8)
MA 184,16,112
MA 188,16,116
MA 192,16,120
TR 16,57,37120
TR 18,57,41728
v_add_u32 v58, 16384, v55
s_waitcnt lgkmcnt(8)
MA 196,20,112
MA 200,20,116
MA 204,20,120
TR 20,57,9216
TR 22,57,13824
buffer_load_dwordx4 v[64:67], v58, s[56:59], 0 offen offset:0 sc1
s_waitcnt lgkmcnt(8)
MA 208,24,112
s_add_u32 m0, s88, 1024
s_mov_b32 s66, 626688
buffer_load_dwordx4 v53, s[16:19], s66 offen lds
MA 212,24,116
MA 216,24,120
TR 24,57,9248
TR 26,57,13856
buffer_load_dwordx4 v[68:71], v58, s[56:59], s64 offen offset:0 sc1
s_waitcnt lgkmcnt(8)
MA 220,28,112
MA 224,28,116
MA 228,28,120
TR 28,57,9280
TR 30,57,13888
buffer_load_dwordx4 v[72:75], v58, s[56:59], s65 offen offset:0 sc1
s_waitcnt lgkmcnt(8)
MA 232,32,112
MA 236,32,116
MA 240,32,120
s_add_u32 m0, s88, 2048
s_mov_b32 s66, 626688
s_mov_b64 exec, 0xffff
buffer_load_dwordx4 v54, s[16:19], s66 offen lds
s_mov_b64 exec, -1
TR 32,57,9312
TR 34,57,13920
s_waitcnt lgkmcnt(8)
MA 244,16,112
MA 248,16,116
MA 252,16,120
TR 16,57,9344
TR 18,57,13952
s_waitcnt vmcnt(23) lgkmcnt(8)
MA 148,20,124
s_waitcnt vmcnt(22)
MA 152,20,128
s_waitcnt vmcnt(20)
MA 156,20,132
TR 20,57,9376
TR 22,57,13984
buffer_load_dwordx4 v[76:79], v58, s[56:59], 0 offen offset:1024 sc1
s_waitcnt lgkmcnt(8)
MA 160,24,124
MA 164,24,128
s_add_u32 m0, s88, 27648
s_mov_b32 s66, 663552
buffer_load_dwordx4 v52, s[16:19], s66 offen lds
MA 168,24,132
TR 24,57,9408
TR 26,57,14016
buffer_load_dwordx4 v[80:83], v58, s[56:59], s64 offen offset:1024 sc1
s_waitcnt lgkmcnt(8)
MA 172,28,124
MA 176,28,128
MA 180,28,132
TR 28,57,9440
TR 30,57,14048
buffer_load_dwordx4 v[84:87], v58, s[56:59], s65 offen offset:1024 sc1
s_waitcnt lgkmcnt(8)
MA 184,32,124
MA 188,32,128
MA 192,32,132
TR 32,57,9472
TR 34,57,14080
s_waitcnt lgkmcnt(8)
MA 196,16,124
s_add_u32 m0, s88, 28672
s_mov_b32 s66, 663552
buffer_load_dwordx4 v53, s[16:19], s66 offen lds
MA 200,16,128
MA 204,16,132
TR 16,57,18432
TR 18,57,23040
s_waitcnt lgkmcnt(8)
MA 208,20,124
MA 212,20,128
MA 216,20,132
TR 20,57,18464
TR 22,57,23072
s_waitcnt lgkmcnt(8)
MA 220,24,124
MA 224,24,128
MA 228,24,132
s_add_u32 m0, s88, 29696
s_mov_b32 s66, 663552
s_mov_b64 exec, 0xffff
buffer_load_dwordx4 v54, s[16:19], s66 offen lds
s_mov_b64 exec, -1
TR 24,57,18496
TR 26,57,23104
s_waitcnt lgkmcnt(8)
MA 232,28,124
MA 236,28,128
MA 240,28,132
TR 28,57,18528
TR 30,57,23136
s_waitcnt lgkmcnt(8)
MA 244,32,124
MA 248,32,128
MA 252,32,132
TR 32,57,18560
TR 34,57,23168
s_waitcnt vmcnt(15)
s_barrier
s_cmp_lg_u32 s62, 0
s_cbranch_scc1 Los
s_lshl_b32 s73, s71, 2
v_mov_b32 v40, s73
v_mov_b32 v41, 2
s_mov_b64 exec, 1
global_store_dword v40, v41, s[96:97] sc0 sc1
s_mov_b64 exec, -1
Los:
s_waitcnt lgkmcnt(8)
MA 148,16,136
MA 152,16,140
MA 156,16,144
TR 16,57,18592
TR 18,57,23200
buffer_load_dwordx4 v[88:91], v58, s[56:59], 0 offen offset:2048 sc1
s_waitcnt lgkmcnt(8)
MA 160,20,136
MA 164,20,140
MA 168,20,144
TR 20,57,18624
TR 22,57,23232
buffer_load_dwordx4 v[92:95], v58, s[56:59], s64 offen offset:2048 sc1
s_waitcnt lgkmcnt(8)
MA 172,24,136
MA 176,24,140
s_add_u32 m0, s88, 9216
s_mov_b32 s66, 700416
buffer_load_dwordx4 v52, s[16:19], s66 offen lds
MA 180,24,144
TR 24,57,18656
TR 26,57,23264
buffer_load_dwordx4 v[96:99], v58, s[56:59], s65 offen offset:2048 sc1
s_waitcnt lgkmcnt(8)
MA 184,28,136
MA 188,28,140
MA 192,28,144
TR 28,57,18688
TR 30,57,23296
s_waitcnt lgkmcnt(8)
MA 196,32,136
MA 200,32,140
MA 204,32,144
TR 32,57,46080
TR 34,57,50688
s_waitcnt lgkmcnt(8)
MA 208,16,136
s_add_u32 m0, s88, 10240
s_mov_b32 s66, 700416
buffer_load_dwordx4 v53, s[16:19], s66 offen lds
MA 212,16,140
MA 216,16,144
TR 16,57,46112
TR 18,57,50720
s_waitcnt lgkmcnt(8)
MA 220,20,136
MA 224,20,140
MA 228,20,144
TR 20,57,46144
TR 22,57,50752
s_waitcnt lgkmcnt(8)
MA 232,24,136
MA 236,24,140
MA 240,24,144
s_add_u32 m0, s88, 11264
s_mov_b32 s66, 700416
s_mov_b64 exec, 0xffff
buffer_load_dwordx4 v54, s[16:19], s66 offen lds
s_mov_b64 exec, -1
TR 24,57,46176
TR 26,57,50784
s_waitcnt lgkmcnt(8)
MA 244,28,136
MA 248,28,140
MA 252,28,144
TR 28,57,46208
TR 30,57,50816
s_waitcnt vmcnt(20) lgkmcnt(8)
MA 148,32,4
s_waitcnt vmcnt(19)
MA 152,32,8
s_waitcnt vmcnt(17)
MA 156,32,12
TR 32,57,46240
TR 34,57,50848
buffer_load_dwordx4 v[100:103], v58, s[56:59], 0 offen offset:3072 sc1
s_waitcnt lgkmcnt(8)
MA 160,16,4
MA 164,16,8
s_add_u32 m0, s88, 36864
s_mov_b32 s66, 884736
buffer_load_dwordx4 v52, s[16:19], s66 offen lds
MA 168,16,12
TR 16,57,46272
TR 18,57,50880
buffer_load_dwordx4 v[104:107], v58, s[56:59], s64 offen offset:3072 sc1
s_waitcnt lgkmcnt(8)
MA 172,20,4
MA 176,20,8
MA 180,20,12
TR 20,57,46304
TR 22,57,50912
buffer_load_dwordx4 v[108:111], v58, s[56:59], s65 offen offset:3072 sc1
s_waitcnt lgkmcnt(8)
MA 184,24,4
MA 188,24,8
MA 192,24,12
TR 24,57,46336
TR 26,57,50944
s_waitcnt lgkmcnt(8)
MA 196,28,4
s_add_u32 m0, s88, 37888
s_mov_b32 s66, 884736
buffer_load_dwordx4 v53, s[16:19], s66 offen lds
MA 200,28,8
MA 204,28,12
TR 28,57,55296
TR 30,57,59904
s_waitcnt lgkmcnt(8)
MA 208,32,4
MA 212,32,8
MA 216,32,12
TR 32,57,55328
TR 34,57,59936
s_waitcnt lgkmcnt(8)
MA 220,16,4
MA 224,16,8
MA 228,16,12
s_add_u32 m0, s88, 38912
s_mov_b32 s66, 884736
s_mov_b64 exec, 0xffff
buffer_load_dwordx4 v54, s[16:19], s66 offen lds
s_mov_b64 exec, -1
TR 16,57,55360
TR 18,57,59968
s_waitcnt lgkmcnt(8)
MA 232,20,4
MA 236,20,8
MA 240,20,12
TR 20,57,55392
TR 22,57,60000
s_waitcnt lgkmcnt(8)
MA 244,24,4
MA 248,24,8
MA 252,24,12
TR 24,57,55424
TR 26,57,60032
s_waitcnt vmcnt(12)
s_barrier
s_waitcnt lgkmcnt(8)
MA 148,28,64
MA 152,28,68
MA 156,28,72
TR 28,57,55456
TR 30,57,60064
v_add_u32 v58, 24576, v55
s_waitcnt lgkmcnt(8)
MA 160,32,64
MA 164,32,68
MA 168,32,72
TR 32,57,55488
TR 34,57,60096
buffer_load_dwordx4 v[112:115], v58, s[56:59], 0 offen offset:0 sc1
s_waitcnt lgkmcnt(8)
MA 172,16,64
MA 176,16,68
s_add_u32 m0, s88, 18432
s_mov_b32 s66, 921600
buffer_load_dwordx4 v52, s[16:19], s66 offen lds
MA 180,16,72
TR 16,57,55520
TR 18,57,60128
buffer_load_dwordx4 v[116:119], v58, s[56:59], s64 offen offset:0 sc1
s_waitcnt lgkmcnt(8)
MA 184,20,64
MA 188,20,68
MA 192,20,72
TR 20,57,55552
TR 22,57,60160
buffer_load_dwordx4 v[120:123], v58, s[56:59], s65 offen offset:0 sc1
s_waitcnt lgkmcnt(8)
MA 196,24,64
MA 200,24,68
MA 204,24,72
TR 24,57,0
TR 26,57,4608
s_waitcnt lgkmcnt(8)
MA 208,28,64
s_add_u32 m0, s88, 19456
s_mov_b32 s66, 921600
buffer_load_dwordx4 v53, s[16:19], s66 offen lds
MA 212,28,68
MA 216,28,72
TR 28,57,32
TR 30,57,4640
s_waitcnt lgkmcnt(8)
MA 220,32,64
MA 224,32,68
MA 228,32,72
TR 32,57,64
TR 34,57,4672
s_waitcnt lgkmcnt(8)
MA 232,16,64
MA 236,16,68
MA 240,16,72
s_add_u32 m0, s88, 20480
s_mov_b32 s66, 921600
s_mov_b64 exec, 0xffff
buffer_load_dwordx4 v54, s[16:19], s66 offen lds
s_mov_b64 exec, -1
TR 16,57,96
TR 18,57,4704
s_waitcnt lgkmcnt(8)
MA 244,20,64
MA 248,20,68
MA 252,20,72
TR 20,57,128
TR 22,57,4736
s_waitcnt lgkmcnt(8)
MA 148,24,76
MA 152,24,80
MA 156,24,84
TR 24,57,160
TR 26,57,4768
buffer_load_dwordx4 v[124:127], v58, s[56:59], 0 offen offset:1024 sc1
s_waitcnt lgkmcnt(8)
MA 160,28,76
MA 164,28,80
s_add_u32 m0, s88, 46080
s_mov_b32 s66, 958464
buffer_load_dwordx4 v52, s[16:19], s66 offen lds
MA 168,28,84
TR 28,57,192
TR 30,57,4800
buffer_load_dwordx4 v[128:131], v58, s[56:59], s64 offen offset:1024 sc1
s_waitcnt lgkmcnt(8)
MA 172,32,76
MA 176,32,80
MA 180,32,84
TR 32,57,224
TR 34,57,4832
buffer_load_dwordx4 v[132:135], v58, s[56:59], s65 offen offset:1024 sc1
s_waitcnt lgkmcnt(8)
MA 184,16,76
MA 188,16,80
MA 192,16,84
TR 16,57,256
TR 18,57,4864
s_waitcnt lgkmcnt(8)
MA 196,20,76
s_add_u32 m0, s88, 47104
s_mov_b32 s66, 958464
buffer_load_dwordx4 v53, s[16:19], s66 offen lds
MA 200,20,80
MA 204,20,84
TR 20,57,27648
TR 22,57,32256
s_waitcnt lgkmcnt(8)
MA 208,24,76
MA 212,24,80
MA 216,24,84
TR 24,57,27680
TR 26,57,32288
s_waitcnt lgkmcnt(8)
MA 220,28,76
MA 224,28,80
MA 228,28,84
s_add_u32 m0, s88, 48128
s_mov_b32 s66, 958464
s_mov_b64 exec, 0xffff
buffer_load_dwordx4 v54, s[16:19], s66 offen lds
s_mov_b64 exec, -1
TR 28,57,27712
TR 30,57,32320
s_waitcnt lgkmcnt(8)
MA 232,32,76
MA 236,32,80
MA 240,32,84
TR 32,57,27744
TR 34,57,32352
s_waitcnt lgkmcnt(8)
MA 244,16,76
MA 248,16,80
MA 252,16,84
TR 16,57,27776
TR 18,57,32384
s_waitcnt vmcnt(12)
s_barrier
s_lshr_b32 s74, s71, 2
s_lshl_b32 s74, s74, 4
v_lshl_add_u32 v43, v59, 2, s74
s_mov_b64 exec, 15
global_load_dword v42, v43, s[96:97] sc0 sc1
s_mov_b64 exec, -1
s_waitcnt lgkmcnt(8)
MA 148,20,88
MA 152,20,92
MA 156,20,96
TR 20,57,27808
TR 22,57,32416
buffer_load_dwordx4 v[136:139], v58, s[56:59], 0 offen offset:2048 sc1
s_waitcnt lgkmcnt(8)
MA 160,24,88
MA 164,24,92
MA 168,24,96
TR 24,57,27840
TR 26,57,32448
buffer_load_dwordx4 v[140:143], v58, s[56:59], s64 offen offset:2048 sc1
s_waitcnt lgkmcnt(8)
MA 172,28,88
MA 176,28,92
s_add_u32 m0, s88, 0
s_mov_b32 s66, 995328
buffer_load_dwordx4 v52, s[16:19], s66 offen lds
MA 180,28,96
TR 28,57,27872
TR 30,57,32480
buffer_load_dwordx4 v[144:147], v58, s[56:59], s65 offen offset:2048 sc1
s_waitcnt lgkmcnt(8)
MA 184,32,88
MA 188,32,92
MA 192,32,96
TR 32,57,27904
TR 34,57,32512
s_waitcnt lgkmcnt(8)
MA 196,16,88
MA 200,16,92
MA 204,16,96
TR 16,57,9216
TR 18,57,13824
s_waitcnt lgkmcnt(8)
MA 208,20,88
s_add_u32 m0, s88, 1024
s_mov_b32 s66, 995328
buffer_load_dwordx4 v53, s[16:19], s66 offen lds
MA 212,20,92
MA 216,20,96
TR 20,57,9248
TR 22,57,13856
s_waitcnt lgkmcnt(8)
MA 220,24,88
MA 224,24,92
MA 228,24,96
TR 24,57,9280
TR 26,57,13888
s_waitcnt lgkmcnt(8)
MA 232,28,88
MA 236,28,92
MA 240,28,96
s_add_u32 m0, s88, 2048
s_mov_b32 s66, 995328
s_mov_b64 exec, 0xffff
buffer_load_dwordx4 v54, s[16:19], s66 offen lds
s_mov_b64 exec, -1
TR 28,57,9312
TR 30,57,13920
s_waitcnt lgkmcnt(8)
MA 244,32,88
MA 248,32,92
MA 252,32,96
TR 32,57,9344
TR 34,57,13952
s_waitcnt lgkmcnt(8)
MA 148,16,100
MA 152,16,104
MA 156,16,108
TR 16,57,9376
TR 18,57,13984
buffer_load_dwordx4 v[4:7], v58, s[56:59], 0 offen offset:3072 sc1
s_waitcnt lgkmcnt(8)
MA 160,20,100
MA 164,20,104
s_add_u32 m0, s88, 55296
s_add_u32 s66, s9, 2359296
buffer_load_dwordx4 v52, s[16:19], s66 offen lds
MA 168,20,108
TR 20,57,9408
TR 22,57,14016
buffer_load_dwordx4 v[8:11], v58, s[56:59], s64 offen offset:3072 sc1
s_waitcnt lgkmcnt(8)
MA 172,24,100
MA 176,24,104
MA 180,24,108
TR 24,57,9440
TR 26,57,14048
buffer_load_dwordx4 v[12:15], v58, s[56:59], s65 offen offset:3072 sc1
s_waitcnt lgkmcnt(8)
MA 184,28,100
MA 188,28,104
MA 192,28,108
TR 28,57,9472
TR 30,57,14080
s_waitcnt lgkmcnt(8)
MA 196,32,100
s_add_u32 m0, s88, 56320
s_add_u32 s66, s9, 2359296
buffer_load_dwordx4 v53, s[16:19], s66 offen lds
MA 200,32,104
MA 204,32,108
TR 32,57,36864
TR 34,57,41472
s_waitcnt lgkmcnt(8)
MA 208,16,100
MA 212,16,104
MA 216,16,108
TR 16,57,36896
TR 18,57,41504
s_waitcnt lgkmcnt(8)
MA 220,20,100
MA 224,20,104
MA 228,20,108
s_add_u32 m0, s88, 57344
s_add_u32 s66, s9, 2359296
s_mov_b64 exec, 0xffff
buffer_load_dwordx4 v54, s[16:19], s66 offen lds
s_mov_b64 exec, -1
TR 20,57,36928
TR 22,57,41536
s_waitcnt lgkmcnt(8)
MA 232,24,100
MA 236,24,104
MA 240,24,108
TR 24,57,36960
TR 26,57,41568
s_waitcnt lgkmcnt(8)
MA 244,28,100
MA 248,28,104
MA 252,28,108
TR 28,57,36992
TR 30,57,41600
s_waitcnt vmcnt(13)
s_barrier
s_waitcnt vmcnt(12)
v_cmp_gt_u32 vcc, 2, v42
s_nop 4
s_and_b32 s72, vcc_lo, 15
s_cmp_eq_u32 s72, 0
s_cbranch_scc1 Loc
s_lshr_b32 s74, s71, 2
s_lshl_b32 s74, s74, 4
s_mov_b32 s93, 0
v_mbcnt_lo_u32_b32 v43, -1, 0
v_lshl_add_u32 v43, v43, 2, s74
s_mov_b64 exec, 15
Lod_l:
global_load_dword v42, v43, s[96:97] sc0 sc1
s_waitcnt vmcnt(0)
v_cmp_gt_u32 vcc, 2, v42
s_add_u32 s93, s93, 1
s_nop 4
s_cmp_eq_u64 vcc, 0
s_cbranch_scc1 Lod_d
s_sleep 8
s_cmp_lt_u32 s93, 100000
s_cbranch_scc1 Lod_l
Lod_d:
s_mov_b64 exec, -1
Loc:
s_waitcnt lgkmcnt(8)
MA 148,32,112
MA 152,32,116
MA 156,32,120
TR 32,57,37024
TR 34,57,41632
v_add_u32 v58, s13, v55
s_waitcnt lgkmcnt(8)
MA 160,16,112
MA 164,16,116
MA 168,16,120
TR 16,57,37056
TR 18,57,41664
buffer_load_dwordx4 v[64:67], v58, s[56:59], 0 offen offset:0 sc1
s_waitcnt lgkmcnt(8)
MA 172,20,112
MA 176,20,116
s_add_u32 m0, s88, 9216
s_add_u32 s66, s9, 2396160
buffer_load_dwordx4 v52, s[16:19], s66 offen lds
MA 180,20,120
TR 20,57,37088
TR 22,57,41696
buffer_load_dwordx4 v[68:71], v58, s[56:59], s64 offen offset:0 sc1
s_waitcnt lgkmcnt(8)
MA 184,24,112
MA 188,24,116
MA 192,24,120
TR 24,57,37120
TR 26,57,41728
buffer_load_dwordx4 v[72:75], v58, s[56:59], s65 offen offset:0 sc1
s_waitcnt lgkmcnt(8)
MA 196,28,112
MA 200,28,116
MA 204,28,120
TR 28,57,18432
TR 30,57,23040
s_waitcnt lgkmcnt(8)
MA 208,32,112
s_add_u32 m0, s88, 10240
s_add_u32 s66, s9, 2396160
buffer_load_dwordx4 v53, s[16:19], s66 offen lds
MA 212,32,116
MA 216,32,120
TR 32,57,18464
TR 34,57,23072
s_waitcnt lgkmcnt(8)
MA 220,16,112
MA 224,16,116
MA 228,16,120
TR 16,57,18496
TR 18,57,23104
s_waitcnt lgkmcnt(8)
MA 232,20,112
MA 236,20,116
MA 240,20,120
s_add_u32 m0, s88, 11264
s_add_u32 s66, s9, 2396160
s_mov_b64 exec, 0xffff
buffer_load_dwordx4 v54, s[16:19], s66 offen lds
s_mov_b64 exec, -1
TR 20,57,18528
TR 22,57,23136
s_waitcnt lgkmcnt(8)
MA 244,24,112
MA 248,24,116
MA 252,24,120
TR 24,57,18560
TR 26,57,23168
s_waitcnt lgkmcnt(8)
MA 148,28,124
MA 152,28,128
MA 156,28,132
TR 28,57,18592
TR 30,57,23200
buffer_load_dwordx4 v[76:79], v58, s[56:59], 0 offen offset:1024 sc1
s_waitcnt lgkmcnt(8)
MA 160,32,124
MA 164,32,128
s_add_u32 m0, s88, 27648
s_add_u32 s66, s9, 2433024
buffer_load_dwordx4 v52, s[16:19], s66 offen lds
MA 168,32,132
TR 32,57,18624
TR 34,57,23232
buffer_load_dwordx4 v[80:83], v58, s[56:59], s64 offen offset:1024 sc1
s_waitcnt lgkmcnt(8)
MA 172,16,124
MA 176,16,128
MA 180,16,132
TR 16,57,18656
TR 18,57,23264
buffer_load_dwordx4 v[84:87], v58, s[56:59], s65 offen offset:1024 sc1
s_waitcnt lgkmcnt(8)
MA 184,20,124
MA 188,20,128
MA 192,20,132
TR 20,57,18688
TR 22,57,23296
s_waitcnt lgkmcnt(8)
MA 196,24,124
s_add_u32 m0, s88, 28672
s_add_u32 s66, s9, 2433024
buffer_load_dwordx4 v53, s[16:19], s66 offen lds
MA 200,24,128
MA 204,24,132
TR 24,57,46080
TR 26,57,50688
s_waitcnt lgkmcnt(8)
MA 208,28,124
MA 212,28,128
MA 216,28,132
TR 28,57,46112
TR 30,57,50720
s_waitcnt lgkmcnt(8)
MA 220,32,124
MA 224,32,128
MA 228,32,132
s_add_u32 m0, s88, 29696
s_add_u32 s66, s9, 2433024
s_mov_b64 exec, 0xffff
buffer_load_dwordx4 v54, s[16:19], s66 offen lds
s_mov_b64 exec, -1
TR 32,57,46144
TR 34,57,50752
s_waitcnt lgkmcnt(8)
MA 232,16,124
MA 236,16,128
MA 240,16,132
TR 16,57,46176
TR 18,57,50784
s_waitcnt lgkmcnt(8)
MA 244,20,124
MA 248,20,128
MA 252,20,132
TR 20,57,46208
TR 22,57,50816
s_waitcnt vmcnt(12)
s_barrier
s_waitcnt lgkmcnt(8)
MA 148,24,136
MA 152,24,140
MA 156,24,144
TR 24,57,46240
TR 26,57,50848
buffer_load_dwordx4 v[88:91], v58, s[56:59], 0 offen offset:2048 sc1
s_waitcnt lgkmcnt(8)
MA 160,28,136
MA 164,28,140
MA 168,28,144
TR 28,57,46272
TR 30,57,50880
buffer_load_dwordx4 v[92:95], v58, s[56:59], s64 offen offset:2048 sc1
s_waitcnt lgkmcnt(8)
MA 172,32,136
MA 176,32,140
s_add_u32 m0, s88, 18432
s_add_u32 s66, s9, 2469888
buffer_load_dwordx4 v52, s[16:19], s66 offen lds
MA 180,32,144
TR 32,57,46304
TR 34,57,50912
buffer_load_dwordx4 v[96:99], v58, s[56:59], s65 offen offset:2048 sc1
s_waitcnt lgkmcnt(8)
MA 184,16,136
MA 188,16,140
MA 192,16,144
TR 16,57,46336
TR 18,57,50944
s_waitcnt lgkmcnt(8)
MA 196,20,136
MA 200,20,140
MA 204,20,144
TR 20,57,0
TR 22,57,4608
s_waitcnt lgkmcnt(8)
MA 208,24,136
s_add_u32 m0, s88, 19456
s_add_u32 s66, s9, 2469888
buffer_load_dwordx4 v53, s[16:19], s66 offen lds
MA 212,24,140
MA 216,24,144
TR 24,57,32
TR 26,57,4640
s_waitcnt lgkmcnt(8)
MA 220,28,136
MA 224,28,140
MA 228,28,144
TR 28,57,64
TR 30,57,4672
s_waitcnt lgkmcnt(8)
MA 232,32,136
MA 236,32,140
MA 240,32,144
s_add_u32 m0, s88, 20480
s_add_u32 s66, s9, 2469888
s_mov_b64 exec, 0xffff
buffer_load_dwordx4 v54, s[16:19], s66 offen lds
s_mov_b64 exec, -1
TR 32,57,96
TR 34,57,4704
s_waitcnt lgkmcnt(8)
MA 244,16,136
MA 248,16,140
MA 252,16,144
TR 16,57,128
TR 18,57,4736
s_waitcnt lgkmcnt(8)
MA 148,20,4
MA 152,20,8
MA 156,20,12
TR 20,57,160
TR 22,57,4768
buffer_load_dwordx4 v[100:103], v58, s[56:59], 0 offen offset:3072 sc1
s_waitcnt lgkmcnt(8)
MA 160,24,4
MA 164,24,8
s_add_u32 m0, s88, 36864
s_add_u32 s66, s10, 2359296
buffer_load_dwordx4 v52, s[16:19], s66 offen lds
MA 168,24,12
TR 24,57,192
TR 26,57,4800
buffer_load_dwordx4 v[104:107], v58, s[56:59], s64 offen offset:3072 sc1
s_waitcnt lgkmcnt(8)
MA 172,28,4
MA 176,28,8
MA 180,28,12
TR 28,57,224
TR 30,57,4832
buffer_load_dwordx4 v[108:111], v58, s[56:59], s65 offen offset:3072 sc1
s_waitcnt lgkmcnt(8)
MA 184,32,4
MA 188,32,8
MA 192,32,12
TR 32,57,256
TR 34,57,4864
s_waitcnt lgkmcnt(8)
MA 196,16,4
s_add_u32 m0, s88, 37888
s_add_u32 s66, s10, 2359296
buffer_load_dwordx4 v53, s[16:19], s66 offen lds
MA 200,16,8
MA 204,16,12
TR 16,57,55296
TR 18,57,59904
s_waitcnt lgkmcnt(8)
MA 208,20,4
MA 212,20,8
MA 216,20,12
TR 20,57,55328
TR 22,57,59936
s_waitcnt lgkmcnt(8)
MA 220,24,4
MA 224,24,8
MA 228,24,12
s_add_u32 m0, s88, 38912
s_add_u32 s66, s10, 2359296
s_mov_b64 exec, 0xffff
buffer_load_dwordx4 v54, s[16:19], s66 offen lds
s_mov_b64 exec, -1
TR 24,57,55360
TR 26,57,59968
s_waitcnt lgkmcnt(8)
MA 232,28,4
MA 236,28,8
MA 240,28,12
TR 28,57,55392
TR 30,57,60000
s_waitcnt lgkmcnt(8)
MA 244,32,4
MA 248,32,8
MA 252,32,12
TR 32,57,55424
TR 34,57,60032
s_waitcnt vmcnt(12)
s_barrier
s_waitcnt lgkmcnt(8)
MA 148,16,64
MA 152,16,68
MA 156,16,72
TR 16,57,55456
TR 18,57,60064
v_add_u32 v58, s14, v55
s_waitcnt lgkmcnt(8)
MA 160,20,64
MA 164,20,68
MA 168,20,72
TR 20,57,55488
TR 22,57,60096
buffer_load_dwordx4 v[112:115], v58, s[56:59], 0 offen offset:0 sc1
s_waitcnt lgkmcnt(8)
MA 172,24,64
MA 176,24,68
s_add_u32 m0, s88, 0
s_add_u32 s66, s10, 2396160
buffer_load_dwordx4 v52, s[16:19], s66 offen lds
MA 180,24,72
TR 24,57,55520
TR 26,57,60128
buffer_load_dwordx4 v[116:119], v58, s[56:59], s64 offen offset:0 sc1
s_waitcnt lgkmcnt(8)
MA 184,28,64
MA 188,28,68
MA 192,28,72
TR 28,57,55552
TR 30,57,60160
buffer_load_dwordx4 v[120:123], v58, s[56:59], s65 offen offset:0 sc1
s_waitcnt lgkmcnt(8)
MA 196,32,64
MA 200,32,68
MA 204,32,72
TR 32,57,9216
TR 34,57,13824
s_waitcnt lgkmcnt(8)
MA 208,16,64
s_add_u32 m0, s88, 1024
s_add_u32 s66, s10, 2396160
buffer_load_dwordx4 v53, s[16:19], s66 offen lds
MA 212,16,68
MA 216,16,72
TR 16,57,9248
TR 18,57,13856
s_waitcnt lgkmcnt(8)
MA 220,20,64
MA 224,20,68
MA 228,20,72
TR 20,57,9280
TR 22,57,13888
s_waitcnt lgkmcnt(8)
MA 232,24,64
MA 236,24,68
MA 240,24,72
s_add_u32 m0, s88, 2048
s_add_u32 s66, s10, 2396160
s_mov_b64 exec, 0xffff
buffer_load_dwordx4 v54, s[16:19], s66 offen lds
s_mov_b64 exec, -1
TR 24,57,9312
TR 26,57,13920
s_waitcnt lgkmcnt(8)
MA 244,28,64
MA 248,28,68
MA 252,28,72
TR 28,57,9344
TR 30,57,13952
s_waitcnt lgkmcnt(8)
MA 148,32,76
MA 152,32,80
MA 156,32,84
TR 32,57,9376
TR 34,57,13984
buffer_load_dwordx4 v[124:127], v58, s[56:59], 0 offen offset:1024 sc1
s_waitcnt lgkmcnt(8)
MA 160,16,76
MA 164,16,80
s_add_u32 m0, s88, 46080
s_add_u32 s66, s10, 2433024
buffer_load_dwordx4 v52, s[16:19], s66 offen lds
MA 168,16,84
TR 16,57,9408
TR 18,57,14016
buffer_load_dwordx4 v[128:131], v58, s[56:59], s64 offen offset:1024 sc1
s_waitcnt lgkmcnt(8)
MA 172,20,76
MA 176,20,80
MA 180,20,84
TR 20,57,9440
TR 22,57,14048
buffer_load_dwordx4 v[132:135], v58, s[56:59], s65 offen offset:1024 sc1
s_waitcnt lgkmcnt(8)
MA 184,24,76
MA 188,24,80
MA 192,24,84
TR 24,57,9472
TR 26,57,14080
s_waitcnt lgkmcnt(8)
MA 196,28,76
s_add_u32 m0, s88, 47104
s_add_u32 s66, s10, 2433024
buffer_load_dwordx4 v53, s[16:19], s66 offen lds
MA 200,28,80
MA 204,28,84
TR 28,57,27648
TR 30,57,32256
s_waitcnt lgkmcnt(8)
MA 208,32,76
MA 212,32,80
MA 216,32,84
TR 32,57,27680
TR 34,57,32288
s_waitcnt lgkmcnt(8)
MA 220,16,76
MA 224,16,80
MA 228,16,84
s_add_u32 m0, s88, 48128
s_add_u32 s66, s10, 2433024
s_mov_b64 exec, 0xffff
buffer_load_dwordx4 v54, s[16:19], s66 offen lds
s_mov_b64 exec, -1
TR 16,57,27712
TR 18,57,32320
s_waitcnt lgkmcnt(8)
MA 232,20,76
MA 236,20,80
MA 240,20,84
TR 20,57,27744
TR 22,57,32352
s_waitcnt lgkmcnt(8)
MA 244,24,76
MA 248,24,80
MA 252,24,84
TR 24,57,27776
TR 26,57,32384
s_waitcnt vmcnt(12)
s_barrier
s_waitcnt lgkmcnt(8)
MA 148,28,88
MA 152,28,92
MA 156,28,96
TR 28,57,27808
TR 30,57,32416
buffer_load_dwordx4 v[136:139], v58, s[56:59], 0 offen offset:2048 sc1
s_waitcnt lgkmcnt(8)
MA 160,32,88
MA 164,32,92
MA 168,32,96
TR 32,57,27840
TR 34,57,32448
buffer_load_dwordx4 v[140:143], v58, s[56:59], s64 offen offset:2048 sc1
s_waitcnt lgkmcnt(8)
MA 172,16,88
MA 176,16,92
s_add_u32 m0, s88, 9216
s_add_u32 s66, s10, 2469888
buffer_load_dwordx4 v52, s[16:19], s66 offen lds
MA 180,16,96
TR 16,57,27872
TR 18,57,32480
buffer_load_dwordx4 v[144:147], v58, s[56:59], s65 offen offset:2048 sc1
s_waitcnt lgkmcnt(8)
MA 184,20,88
MA 188,20,92
MA 192,20,96
TR 20,57,27904
TR 22,57,32512
s_waitcnt lgkmcnt(8)
MA 196,24,88
MA 200,24,92
MA 204,24,96
TR 24,57,18432
TR 26,57,23040
s_waitcnt lgkmcnt(8)
MA 208,28,88
s_add_u32 m0, s88, 10240
s_add_u32 s66, s10, 2469888
buffer_load_dwordx4 v53, s[16:19], s66 offen lds
MA 212,28,92
MA 216,28,96
TR 28,57,18464
TR 30,57,23072
s_waitcnt lgkmcnt(8)
MA 220,32,88
MA 224,32,92
MA 228,32,96
TR 32,57,18496
TR 34,57,23104
s_waitcnt lgkmcnt(8)
MA 232,16,88
MA 236,16,92
MA 240,16,96
s_add_u32 m0, s88, 11264
s_add_u32 s66, s10, 2469888
s_mov_b64 exec, 0xffff
buffer_load_dwordx4 v54, s[16:19], s66 offen lds
s_mov_b64 exec, -1
TR 16,57,18528
TR 18,57,23136
s_waitcnt lgkmcnt(8)
MA 244,20,88
MA 248,20,92
MA 252,20,96
TR 20,57,18560
TR 22,57,23168
s_waitcnt lgkmcnt(8)
MA 148,24,100
MA 152,24,104
MA 156,24,108
TR 24,57,18592
TR 26,57,23200
buffer_load_dwordx4 v[4:7], v58, s[56:59], 0 offen offset:3072 sc1
s_waitcnt lgkmcnt(8)
MA 160,28,100
MA 164,28,104
s_add_u32 m0, s88, 55296
s_add_u32 s66, s11, 2359296
buffer_load_dwordx4 v52, s[16:19], s66 offen lds
MA 168,28,108
TR 28,57,18624
TR 30,57,23232
buffer_load_dwordx4 v[8:11], v58, s[56:59], s64 offen offset:3072 sc1
s_waitcnt lgkmcnt(8)
MA 172,32,100
MA 176,32,104
MA 180,32,108
TR 32,57,18656
TR 34,57,23264
buffer_load_dwordx4 v[12:15], v58, s[56:59], s65 offen offset:3072 sc1
s_waitcnt lgkmcnt(8)
MA 184,16,100
MA 188,16,104
MA 192,16,108
TR 16,57,18688
TR 18,57,23296
s_waitcnt lgkmcnt(8)
MA 196,20,100
s_add_u32 m0, s88, 56320
s_add_u32 s66, s11, 2359296
buffer_load_dwordx4 v53, s[16:19], s66 offen lds
MA 200,20,104
MA 204,20,108
TR 20,57,36864
TR 22,57,41472
s_waitcnt lgkmcnt(8)
MA 208,24,100
MA 212,24,104
MA 216,24,108
TR 24,57,36896
TR 26,57,41504
s_waitcnt lgkmcnt(8)
MA 220,28,100
MA 224,28,104
MA 228,28,108
s_add_u32 m0, s88, 57344
s_add_u32 s66, s11, 2359296
s_mov_b64 exec, 0xffff
buffer_load_dwordx4 v54, s[16:19], s66 offen lds
s_mov_b64 exec, -1
TR 28,57,36928
TR 30,57,41536
s_waitcnt lgkmcnt(8)
MA 232,32,100
MA 236,32,104
MA 240,32,108
TR 32,57,36960
TR 34,57,41568
s_waitcnt lgkmcnt(8)
MA 244,16,100
MA 248,16,104
MA 252,16,108
TR 16,57,36992
TR 18,57,41600
s_waitcnt vmcnt(12)
s_barrier
s_waitcnt lgkmcnt(8)
MA 148,20,112
MA 152,20,116
MA 156,20,120
TR 20,57,37024
TR 22,57,41632
v_add_u32 v58, s15, v55
s_waitcnt lgkmcnt(8)
MA 160,24,112
MA 164,24,116
MA 168,24,120
TR 24,57,37056
TR 26,57,41664
buffer_load_dwordx4 v[64:67], v58, s[56:59], 0 offen offset:0 sc1
s_waitcnt lgkmcnt(8)
MA 172,28,112
MA 176,28,116
s_add_u32 m0, s88, 18432
s_add_u32 s66, s11, 2396160
buffer_load_dwordx4 v52, s[16:19], s66 offen lds
MA 180,28,120
TR 28,57,37088
TR 30,57,41696
buffer_load_dwordx4 v[68:71], v58, s[56:59], s64 offen offset:0 sc1
s_waitcnt lgkmcnt(8)
MA 184,32,112
MA 188,32,116
MA 192,32,120
TR 32,57,37120
TR 34,57,41728
buffer_load_dwordx4 v[72:75], v58, s[56:59], s65 offen offset:0 sc1
s_waitcnt lgkmcnt(8)
MA 196,16,112
MA 200,16,116
MA 204,16,120
TR 16,57,0
TR 18,57,4608
s_waitcnt lgkmcnt(8)
MA 208,20,112
s_add_u32 m0, s88, 19456
s_add_u32 s66, s11, 2396160
buffer_load_dwordx4 v53, s[16:19], s66 offen lds
MA 212,20,116
MA 216,20,120
TR 20,57,32
TR 22,57,4640
s_waitcnt lgkmcnt(8)
MA 220,24,112
MA 224,24,116
MA 228,24,120
TR 24,57,64
TR 26,57,4672
s_waitcnt lgkmcnt(8)
MA 232,28,112
MA 236,28,116
MA 240,28,120
s_add_u32 m0, s88, 20480
s_add_u32 s66, s11, 2396160
s_mov_b64 exec, 0xffff
buffer_load_dwordx4 v54, s[16:19], s66 offen lds
s_mov_b64 exec, -1
TR 28,57,96
TR 30,57,4704
s_waitcnt lgkmcnt(8)
MA 244,32,112
MA 248,32,116
MA 252,32,120
TR 32,57,128
TR 34,57,4736
s_waitcnt lgkmcnt(8)
MA 148,16,124
MA 152,16,128
MA 156,16,132
TR 16,57,160
TR 18,57,4768
buffer_load_dwordx4 v[76:79], v58, s[56:59], 0 offen offset:1024 sc1
s_waitcnt lgkmcnt(8)
MA 160,20,124
MA 164,20,128
s_add_u32 m0, s88, 27648
s_add_u32 s66, s11, 2433024
buffer_load_dwordx4 v52, s[16:19], s66 offen lds
MA 168,20,132
TR 20,57,192
TR 22,57,4800
buffer_load_dwordx4 v[80:83], v58, s[56:59], s64 offen offset:1024 sc1
s_waitcnt lgkmcnt(8)
MA 172,24,124
MA 176,24,128
MA 180,24,132
TR 24,57,224
TR 26,57,4832
buffer_load_dwordx4 v[84:87], v58, s[56:59], s65 offen offset:1024 sc1
s_waitcnt lgkmcnt(8)
MA 184,28,124
MA 188,28,128
MA 192,28,132
TR 28,57,256
TR 30,57,4864
s_waitcnt lgkmcnt(8)
MA 196,32,124
s_add_u32 m0, s88, 28672
s_add_u32 s66, s11, 2433024
buffer_load_dwordx4 v53, s[16:19], s66 offen lds
MA 200,32,128
MA 204,32,132
TR 32,57,46080
TR 34,57,50688
s_waitcnt lgkmcnt(8)
MA 208,16,124
MA 212,16,128
MA 216,16,132
TR 16,57,46112
TR 18,57,50720
s_waitcnt lgkmcnt(8)
MA 220,20,124
MA 224,20,128
MA 228,20,132
s_add_u32 m0, s88, 29696
s_add_u32 s66, s11, 2433024
s_mov_b64 exec, 0xffff
buffer_load_dwordx4 v54, s[16:19], s66 offen lds
s_mov_b64 exec, -1
TR 20,57,46144
TR 22,57,50752
s_waitcnt lgkmcnt(8)
MA 232,24,124
MA 236,24,128
MA 240,24,132
TR 24,57,46176
TR 26,57,50784
s_waitcnt lgkmcnt(8)
MA 244,28,124
MA 248,28,128
MA 252,28,132
TR 28,57,46208
TR 30,57,50816
s_waitcnt vmcnt(12)
s_barrier
s_waitcnt lgkmcnt(8)
MA 148,32,136
MA 152,32,140
MA 156,32,144
TR 32,57,46240
TR 34,57,50848
buffer_load_dwordx4 v[88:91], v58, s[56:59], 0 offen offset:2048 sc1
s_waitcnt lgkmcnt(8)
MA 160,16,136
MA 164,16,140
MA 168,16,144
TR 16,57,46272
TR 18,57,50880
buffer_load_dwordx4 v[92:95], v58, s[56:59], s64 offen offset:2048 sc1
s_waitcnt lgkmcnt(8)
MA 172,20,136
MA 176,20,140
s_add_u32 m0, s88, 0
s_add_u32 s66, s11, 2469888
buffer_load_dwordx4 v52, s[16:19], s66 offen lds
MA 180,20,144
TR 20,57,46304
TR 22,57,50912
buffer_load_dwordx4 v[96:99], v58, s[56:59], s65 offen offset:2048 sc1
s_waitcnt lgkmcnt(8)
MA 184,24,136
MA 188,24,140
MA 192,24,144
TR 24,57,46336
TR 26,57,50944
s_waitcnt lgkmcnt(8)
MA 196,28,136
MA 200,28,140
MA 204,28,144
TR 28,57,9216
TR 30,57,13824
s_waitcnt lgkmcnt(8)
MA 208,32,136
s_add_u32 m0, s88, 1024
s_add_u32 s66, s11, 2469888
buffer_load_dwordx4 v53, s[16:19], s66 offen lds
MA 212,32,140
MA 216,32,144
TR 32,57,9248
TR 34,57,13856
s_waitcnt lgkmcnt(8)
MA 220,16,136
MA 224,16,140
MA 228,16,144
TR 16,57,9280
TR 18,57,13888
s_waitcnt lgkmcnt(8)
MA 232,20,136
MA 236,20,140
MA 240,20,144
s_add_u32 m0, s88, 2048
s_add_u32 s66, s11, 2469888
s_mov_b64 exec, 0xffff
buffer_load_dwordx4 v54, s[16:19], s66 offen lds
s_mov_b64 exec, -1
TR 20,57,9312
TR 22,57,13920
s_waitcnt lgkmcnt(8)
MA 244,24,136
MA 248,24,140
MA 252,24,144
TR 24,57,9344
TR 26,57,13952
s_waitcnt lgkmcnt(8)
MA 148,28,4
MA 152,28,8
MA 156,28,12
TR 28,57,9376
TR 30,57,13984
buffer_load_dwordx4 v[100:103], v58, s[56:59], 0 offen offset:3072 sc1
s_waitcnt lgkmcnt(8)
MA 160,32,4
MA 164,32,8
MA 168,32,12
TR 32,57,9408
TR 34,57,14016
buffer_load_dwordx4 v[104:107], v58, s[56:59], s64 offen offset:3072 sc1
s_waitcnt lgkmcnt(8)
MA 172,16,4
MA 176,16,8
MA 180,16,12
TR 16,57,9440
TR 18,57,14048
buffer_load_dwordx4 v[108:111], v58, s[56:59], s65 offen offset:3072 sc1
s_waitcnt lgkmcnt(8)
MA 184,20,4
MA 188,20,8
MA 192,20,12
TR 20,57,9472
TR 22,57,14080
s_waitcnt lgkmcnt(8)
MA 196,24,4
MA 200,24,8
MA 204,24,12
TR 24,57,55296
TR 26,57,59904
s_waitcnt lgkmcnt(8)
MA 208,28,4
MA 212,28,8
MA 216,28,12
TR 28,57,55328
TR 30,57,59936
s_waitcnt lgkmcnt(8)
MA 220,32,4
MA 224,32,8
MA 228,32,12
TR 32,57,55360
TR 34,57,59968
s_waitcnt lgkmcnt(8)
MA 232,16,4
MA 236,16,8
MA 240,16,12
TR 16,57,55392
TR 18,57,60000
s_waitcnt lgkmcnt(8)
MA 244,20,4
MA 248,20,8
MA 252,20,12
TR 20,57,55424
TR 22,57,60032
s_waitcnt vmcnt(9)
s_barrier
s_waitcnt lgkmcnt(8)
MA 148,24,64
MA 152,24,68
MA 156,24,72
TR 24,57,55456
TR 26,57,60064
s_waitcnt lgkmcnt(8)
MA 160,28,64
MA 164,28,68
MA 168,28,72
TR 28,57,55488
TR 30,57,60096
s_waitcnt lgkmcnt(8)
MA 172,32,64
MA 176,32,68
MA 180,32,72
TR 32,57,55520
TR 34,57,60128
s_waitcnt lgkmcnt(8)
MA 184,16,64
MA 188,16,68
MA 192,16,72
TR 16,57,55552
TR 18,57,60160
s_waitcnt lgkmcnt(8)
MA 196,20,64
MA 200,20,68
MA 204,20,72
TR 20,57,18432
TR 22,57,23040
s_waitcnt lgkmcnt(8)
MA 208,24,64
MA 212,24,68
MA 216,24,72
TR 24,57,18464
TR 26,57,23072
s_waitcnt lgkmcnt(8)
MA 220,28,64
MA 224,28,68
MA 228,28,72
TR 28,57,18496
TR 30,57,23104
s_waitcnt lgkmcnt(8)
MA 232,32,64
MA 236,32,68
MA 240,32,72
TR 32,57,18528
TR 34,57,23136
s_waitcnt lgkmcnt(8)
MA 244,16,64
MA 248,16,68
MA 252,16,72
TR 16,57,18560
TR 18,57,23168
s_waitcnt lgkmcnt(8)
MA 148,20,76
MA 152,20,80
MA 156,20,84
TR 20,57,18592
TR 22,57,23200
s_waitcnt lgkmcnt(8)
MA 160,24,76
MA 164,24,80
MA 168,24,84
TR 24,57,18624
TR 26,57,23232
s_waitcnt lgkmcnt(8)
MA 172,28,76
MA 176,28,80
MA 180,28,84
TR 28,57,18656
TR 30,57,23264
s_waitcnt lgkmcnt(8)
MA 184,32,76
MA 188,32,80
MA 192,32,84
TR 32,57,18688
TR 34,57,23296
s_waitcnt lgkmcnt(8)
MA 196,16,76
MA 200,16,80
MA 204,16,84
TR 16,57,27648
TR 18,57,32256
s_waitcnt lgkmcnt(8)
MA 208,20,76
MA 212,20,80
MA 216,20,84
TR 20,57,27680
TR 22,57,32288
s_waitcnt lgkmcnt(8)
MA 220,24,76
MA 224,24,80
MA 228,24,84
TR 24,57,27712
TR 26,57,32320
s_waitcnt lgkmcnt(8)
MA 232,28,76
MA 236,28,80
MA 240,28,84
TR 28,57,27744
TR 30,57,32352
s_waitcnt lgkmcnt(8)
MA 244,32,76
MA 248,32,80
MA 252,32,84
TR 32,57,27776
TR 34,57,32384
s_waitcnt vmcnt(3)
s_barrier
s_waitcnt lgkmcnt(8)
MA 148,16,88
MA 152,16,92
MA 156,16,96
TR 16,57,27808
TR 18,57,32416
s_waitcnt lgkmcnt(8)
MA 160,20,88
MA 164,20,92
MA 168,20,96
TR 20,57,27840
TR 22,57,32448
s_waitcnt lgkmcnt(8)
MA 172,24,88
MA 176,24,92
MA 180,24,96
TR 24,57,27872
TR 26,57,32480
s_waitcnt lgkmcnt(8)
MA 184,28,88
MA 188,28,92
MA 192,28,96
TR 28,57,27904
TR 30,57,32512
s_waitcnt lgkmcnt(8)
MA 196,32,88
MA 200,32,92
MA 204,32,96
TR 32,57,0
TR 34,57,4608
s_waitcnt lgkmcnt(8)
MA 208,16,88
MA 212,16,92
MA 216,16,96
TR 16,57,32
TR 18,57,4640
s_waitcnt lgkmcnt(8)
MA 220,20,88
MA 224,20,92
MA 228,20,96
TR 20,57,64
TR 22,57,4672
s_waitcnt lgkmcnt(8)
MA 232,24,88
MA 236,24,92
MA 240,24,96
TR 24,57,96
TR 26,57,4704
s_waitcnt lgkmcnt(8)
MA 244,28,88
MA 248,28,92
MA 252,28,96
TR 28,57,128
TR 30,57,4736
s_waitcnt vmcnt(2) lgkmcnt(8)
MA 148,32,100
s_waitcnt vmcnt(1)
MA 152,32,104
s_waitcnt vmcnt(0)
MA 156,32,108
TR 32,57,160
TR 34,57,4768
s_waitcnt lgkmcnt(8)
MA 160,16,100
MA 164,16,104
MA 168,16,108
TR 16,57,192
TR 18,57,4800
s_waitcnt lgkmcnt(8)
MA 172,20,100
MA 176,20,104
MA 180,20,108
TR 20,57,224
TR 22,57,4832
s_waitcnt lgkmcnt(8)
MA 184,24,100
MA 188,24,104
MA 192,24,108
TR 24,57,256
TR 26,57,4864
s_waitcnt lgkmcnt(8)
MA 196,28,100
MA 200,28,104
MA 204,28,108
s_waitcnt lgkmcnt(6)
MA 208,32,100
MA 212,32,104
MA 216,32,108
s_waitcnt lgkmcnt(4)
MA 220,16,100
MA 224,16,104
MA 228,16,108
s_waitcnt lgkmcnt(2)
MA 232,20,100
MA 236,20,104
MA 240,20,108
s_waitcnt lgkmcnt(0)
MA 244,24,100
MA 248,24,104
MA 252,24,108
s_branch L_fin
L_fin:
s_nop 7
s_cmp_ge_u32 s62, 4
s_cbranch_scc1 L_red1
ds_write_b128 v46, v[204:207] offset:0
ds_write_b128 v46, v[208:211] offset:1024
ds_write_b128 v46, v[212:215] offset:2048
ds_write_b128 v46, v[216:219] offset:3072
ds_write_b128 v46, v[220:223] offset:4096
ds_write_b128 v46, v[224:227] offset:5120
ds_write_b128 v46, v[228:231] offset:6144
ds_write_b128 v46, v[232:235] offset:7168
ds_write_b128 v46, v[236:239] offset:8192
ds_write_b128 v46, v[240:243] offset:9216
ds_write_b128 v46, v[244:247] offset:10240
ds_write_b128 v46, v[248:251] offset:11264
ds_write_b128 v46, v[252:255] offset:12288
s_waitcnt lgkmcnt(0)
s_barrier
ds_read_b128 v[60:63], v47 offset:0
ds_read_b128 v[64:67], v47 offset:1024
ds_read_b128 v[68:71], v47 offset:2048
ds_read_b128 v[72:75], v47 offset:3072
ds_read_b128 v[76:79], v47 offset:4096
ds_read_b128 v[80:83], v47 offset:5120
ds_read_b128 v[84:87], v47 offset:6144
ds_read_b128 v[88:91], v47 offset:7168
ds_read_b128 v[92:95], v47 offset:8192
ds_read_b128 v[96:99], v47 offset:9216
ds_read_b128 v[100:103], v47 offset:10240
ds_read_b128 v[104:107], v47 offset:11264
ds_read_b128 v[108:111], v47 offset:12288
ds_read_b128 v[112:115], v47 offset:13312
s_cmp_eq_u32 s38, 0
s_cbranch_scc1 L_own0
s_waitcnt lgkmcnt(13)
v_pk_add_f32 v[148:149], v[148:149], v[60:61]
v_pk_add_f32 v[150:151], v[150:151], v[62:63]
v_cvt_pk_bf16_f32 v148, v148, v149
v_cvt_pk_bf16_f32 v149, v150, v151
s_waitcnt lgkmcnt(12)
v_pk_add_f32 v[152:153], v[152:153], v[64:65]
v_pk_add_f32 v[154:155], v[154:155], v[66:67]
v_cvt_pk_bf16_f32 v150, v152, v153
v_cvt_pk_bf16_f32 v151, v154, v155
s_movk_i32 s72, 0
buffer_store_dwordx4 v[148:151], v49, s[28:31], s72 offen offset:0 sc1
s_waitcnt lgkmcnt(11)
v_pk_add_f32 v[156:157], v[156:157], v[68:69]
v_pk_add_f32 v[158:159], v[158:159], v[70:71]
v_cvt_pk_bf16_f32 v156, v156, v157
v_cvt_pk_bf16_f32 v157, v158, v159
s_waitcnt lgkmcnt(10)
v_pk_add_f32 v[160:161], v[160:161], v[72:73]
v_pk_add_f32 v[162:163], v[162:163], v[74:75]
v_cvt_pk_bf16_f32 v158, v160, v161
v_cvt_pk_bf16_f32 v159, v162, v163
buffer_store_dwordx4 v[156:159], v49, s[28:31], s72 offen offset:1024 sc1
s_waitcnt lgkmcnt(9)
v_pk_add_f32 v[164:165], v[164:165], v[76:77]
v_pk_add_f32 v[166:167], v[166:167], v[78:79]
v_cvt_pk_bf16_f32 v164, v164, v165
v_cvt_pk_bf16_f32 v165, v166, v167
s_waitcnt lgkmcnt(8)
v_pk_add_f32 v[168:169], v[168:169], v[80:81]
v_pk_add_f32 v[170:171], v[170:171], v[82:83]
v_cvt_pk_bf16_f32 v166, v168, v169
v_cvt_pk_bf16_f32 v167, v170, v171
buffer_store_dwordx4 v[164:167], v49, s[28:31], s72 offen offset:2048 sc1
s_waitcnt lgkmcnt(7)
v_pk_add_f32 v[172:173], v[172:173], v[84:85]
v_pk_add_f32 v[174:175], v[174:175], v[86:87]
v_cvt_pk_bf16_f32 v172, v172, v173
v_cvt_pk_bf16_f32 v173, v174, v175
s_waitcnt lgkmcnt(6)
v_pk_add_f32 v[176:177], v[176:177], v[88:89]
v_pk_add_f32 v[178:179], v[178:179], v[90:91]
v_cvt_pk_bf16_f32 v174, v176, v177
v_cvt_pk_bf16_f32 v175, v178, v179
buffer_store_dwordx4 v[172:175], v49, s[28:31], s72 offen offset:3072 sc1
s_waitcnt lgkmcnt(5)
v_pk_add_f32 v[180:181], v[180:181], v[92:93]
v_pk_add_f32 v[182:183], v[182:183], v[94:95]
v_cvt_pk_bf16_f32 v180, v180, v181
v_cvt_pk_bf16_f32 v181, v182, v183
s_waitcnt lgkmcnt(4)
v_pk_add_f32 v[184:185], v[184:185], v[96:97]
v_pk_add_f32 v[186:187], v[186:187], v[98:99]
v_cvt_pk_bf16_f32 v182, v184, v185
v_cvt_pk_bf16_f32 v183, v186, v187
s_movk_i32 s72, 4096
buffer_store_dwordx4 v[180:183], v49, s[28:31], s72 offen offset:0 sc1
s_waitcnt lgkmcnt(3)
v_pk_add_f32 v[188:189], v[188:189], v[100:101]
v_pk_add_f32 v[190:191], v[190:191], v[102:103]
v_cvt_pk_bf16_f32 v188, v188, v189
v_cvt_pk_bf16_f32 v189, v190, v191
s_waitcnt lgkmcnt(2)
v_pk_add_f32 v[192:193], v[192:193], v[104:105]
v_pk_add_f32 v[194:195], v[194:195], v[106:107]
v_cvt_pk_bf16_f32 v190, v192, v193
v_cvt_pk_bf16_f32 v191, v194, v195
buffer_store_dwordx4 v[188:191], v49, s[28:31], s72 offen offset:1024 sc1
s_waitcnt lgkmcnt(1)
v_pk_add_f32 v[196:197], v[196:197], v[108:109]
v_pk_add_f32 v[198:199], v[198:199], v[110:111]
v_cvt_pk_bf16_f32 v196, v196, v197
v_cvt_pk_bf16_f32 v197, v198, v199
s_waitcnt lgkmcnt(0)
v_pk_add_f32 v[200:201], v[200:201], v[112:113]
v_pk_add_f32 v[202:203], v[202:203], v[114:115]
v_cvt_pk_bf16_f32 v198, v200, v201
v_cvt_pk_bf16_f32 v199, v202, v203
buffer_store_dwordx4 v[196:199], v49, s[28:31], s72 offen offset:2048 sc1
v_mov_b32 v40, s39
v_mov_b32 v41, 1
s_waitcnt vmcnt(0) lgkmcnt(0)
s_mov_b64 exec, 1
global_store_dword v40, v41, s[96:97] sc0 sc1
s_mov_b64 exec, -1
s_endpgm
L_own0:
s_waitcnt lgkmcnt(0)
v_pk_add_f32 v[148:149], v[148:149], v[60:61]
v_pk_add_f32 v[150:151], v[150:151], v[62:63]
v_pk_add_f32 v[152:153], v[152:153], v[64:65]
v_pk_add_f32 v[154:155], v[154:155], v[66:67]
v_pk_add_f32 v[156:157], v[156:157], v[68:69]
v_pk_add_f32 v[158:159], v[158:159], v[70:71]
v_pk_add_f32 v[160:161], v[160:161], v[72:73]
v_pk_add_f32 v[162:163], v[162:163], v[74:75]
v_pk_add_f32 v[164:165], v[164:165], v[76:77]
v_pk_add_f32 v[166:167], v[166:167], v[78:79]
v_pk_add_f32 v[168:169], v[168:169], v[80:81]
v_pk_add_f32 v[170:171], v[170:171], v[82:83]
v_pk_add_f32 v[172:173], v[172:173], v[84:85]
v_pk_add_f32 v[174:175], v[174:175], v[86:87]
v_pk_add_f32 v[176:177], v[176:177], v[88:89]
v_pk_add_f32 v[178:179], v[178:179], v[90:91]
v_pk_add_f32 v[180:181], v[180:181], v[92:93]
v_pk_add_f32 v[182:183], v[182:183], v[94:95]
v_pk_add_f32 v[184:185], v[184:185], v[96:97]
v_pk_add_f32 v[186:187], v[186:187], v[98:99]
v_pk_add_f32 v[188:189], v[188:189], v[100:101]
v_pk_add_f32 v[190:191], v[190:191], v[102:103]
v_pk_add_f32 v[192:193], v[192:193], v[104:105]
v_pk_add_f32 v[194:195], v[194:195], v[106:107]
v_pk_add_f32 v[196:197], v[196:197], v[108:109]
v_pk_add_f32 v[198:199], v[198:199], v[110:111]
v_pk_add_f32 v[200:201], v[200:201], v[112:113]
v_pk_add_f32 v[202:203], v[202:203], v[114:115]
s_mov_b32 s93, 0
v_mbcnt_lo_u32_b32 v43, -1, 0
v_lshl_add_u32 v43, v43, 2, s39
s_mov_b64 exec, 1
L_xp0_l:
global_load_dword v42, v43, s[96:97] sc0 sc1
s_waitcnt vmcnt(0)
v_cmp_gt_u32 vcc, 1, v42
s_add_u32 s93, s93, 1
s_nop 4
s_cmp_eq_u64 vcc, 0
s_cbranch_scc1 L_xp0_d
s_sleep 4
s_cmp_lt_u32 s93, 100000
s_cbranch_scc1 L_xp0_l
L_xp0_d:
s_mov_b64 exec, -1
s_movk_i32 s72, 0
buffer_load_dwordx4 v[60:63], v49, s[28:31], s72 offen offset:0 sc1
buffer_load_dwordx4 v[64:67], v49, s[28:31], s72 offen offset:1024 sc1
buffer_load_dwordx4 v[68:71], v49, s[28:31], s72 offen offset:2048 sc1
buffer_load_dwordx4 v[72:75], v49, s[28:31], s72 offen offset:3072 sc1
s_movk_i32 s72, 4096
buffer_load_dwordx4 v[76:79], v49, s[28:31], s72 offen offset:0 sc1
buffer_load_dwordx4 v[80:83], v49, s[28:31], s72 offen offset:1024 sc1
buffer_load_dwordx4 v[84:87], v49, s[28:31], s72 offen offset:2048 sc1
s_waitcnt vmcnt(6)
v_lshlrev_b32 v120, 16, v60
v_and_b32 v121, 0xffff0000, v60
v_pk_add_f32 v[148:149], v[148:149], v[120:121]
v_lshlrev_b32 v120, 16, v61
v_and_b32 v121, 0xffff0000, v61
v_pk_add_f32 v[150:151], v[150:151], v[120:121]
v_cvt_pk_bf16_f32 v148, v148, v149
v_cvt_pk_bf16_f32 v149, v150, v151
s_mov_b32 s72, 0
buffer_store_dwordx2 v[148:149], v48, s[20:23], s72 offen offset:0
v_lshlrev_b32 v120, 16, v62
v_and_b32 v121, 0xffff0000, v62
v_pk_add_f32 v[152:153], v[152:153], v[120:121]
v_lshlrev_b32 v120, 16, v63
v_and_b32 v121, 0xffff0000, v63
v_pk_add_f32 v[154:155], v[154:155], v[120:121]
v_cvt_pk_bf16_f32 v152, v152, v153
v_cvt_pk_bf16_f32 v153, v154, v155
s_mov_b32 s72, 36864
buffer_store_dwordx2 v[152:153], v48, s[20:23], s72 offen offset:0
s_waitcnt vmcnt(7)
v_lshlrev_b32 v120, 16, v64
v_and_b32 v121, 0xffff0000, v64
v_pk_add_f32 v[156:157], v[156:157], v[120:121]
v_lshlrev_b32 v120, 16, v65
v_and_b32 v121, 0xffff0000, v65
v_pk_add_f32 v[158:159], v[158:159], v[120:121]
v_cvt_pk_bf16_f32 v156, v156, v157
v_cvt_pk_bf16_f32 v157, v158, v159
s_mov_b32 s72, 73728
buffer_store_dwordx2 v[156:157], v48, s[20:23], s72 offen offset:0
v_lshlrev_b32 v120, 16, v66
v_and_b32 v121, 0xffff0000, v66
v_pk_add_f32 v[160:161], v[160:161], v[120:121]
v_lshlrev_b32 v120, 16, v67
v_and_b32 v121, 0xffff0000, v67
v_pk_add_f32 v[162:163], v[162:163], v[120:121]
v_cvt_pk_bf16_f32 v160, v160, v161
v_cvt_pk_bf16_f32 v161, v162, v163
s_mov_b32 s72, 0
buffer_store_dwordx2 v[160:161], v48, s[20:23], s72 offen offset:32
s_waitcnt vmcnt(8)
v_lshlrev_b32 v120, 16, v68
v_and_b32 v121, 0xffff0000, v68
v_pk_add_f32 v[164:165], v[164:165], v[120:121]
v_lshlrev_b32 v120, 16, v69
v_and_b32 v121, 0xffff0000, v69
v_pk_add_f32 v[166:167], v[166:167], v[120:121]
v_cvt_pk_bf16_f32 v164, v164, v165
v_cvt_pk_bf16_f32 v165, v166, v167
s_mov_b32 s72, 36864
buffer_store_dwordx2 v[164:165], v48, s[20:23], s72 offen offset:32
v_lshlrev_b32 v120, 16, v70
v_and_b32 v121, 0xffff0000, v70
v_pk_add_f32 v[168:169], v[168:169], v[120:121]
v_lshlrev_b32 v120, 16, v71
v_and_b32 v121, 0xffff0000, v71
v_pk_add_f32 v[170:171], v[170:171], v[120:121]
v_cvt_pk_bf16_f32 v168, v168, v169
v_cvt_pk_bf16_f32 v169, v170, v171
s_mov_b32 s72, 73728
buffer_store_dwordx2 v[168:169], v48, s[20:23], s72 offen offset:32
s_waitcnt vmcnt(9)
v_lshlrev_b32 v120, 16, v72
v_and_b32 v121, 0xffff0000, v72
v_pk_add_f32 v[172:173], v[172:173], v[120:121]
v_lshlrev_b32 v120, 16, v73
v_and_b32 v121, 0xffff0000, v73
v_pk_add_f32 v[174:175], v[174:175], v[120:121]
v_cvt_pk_bf16_f32 v172, v172, v173
v_cvt_pk_bf16_f32 v173, v174, v175
s_mov_b32 s72, 0
buffer_store_dwordx2 v[172:173], v48, s[20:23], s72 offen offset:64
v_lshlrev_b32 v120, 16, v74
v_and_b32 v121, 0xffff0000, v74
v_pk_add_f32 v[176:177], v[176:177], v[120:121]
v_lshlrev_b32 v120, 16, v75
v_and_b32 v121, 0xffff0000, v75
v_pk_add_f32 v[178:179], v[178:179], v[120:121]
v_cvt_pk_bf16_f32 v176, v176, v177
v_cvt_pk_bf16_f32 v177, v178, v179
s_mov_b32 s72, 36864
buffer_store_dwordx2 v[176:177], v48, s[20:23], s72 offen offset:64
s_waitcnt vmcnt(10)
v_lshlrev_b32 v120, 16, v76
v_and_b32 v121, 0xffff0000, v76
v_pk_add_f32 v[180:181], v[180:181], v[120:121]
v_lshlrev_b32 v120, 16, v77
v_and_b32 v121, 0xffff0000, v77
v_pk_add_f32 v[182:183], v[182:183], v[120:121]
v_cvt_pk_bf16_f32 v180, v180, v181
v_cvt_pk_bf16_f32 v181, v182, v183
s_mov_b32 s72, 73728
buffer_store_dwordx2 v[180:181], v48, s[20:23], s72 offen offset:64
v_lshlrev_b32 v120, 16, v78
v_and_b32 v121, 0xffff0000, v78
v_pk_add_f32 v[184:185], v[184:185], v[120:121]
v_lshlrev_b32 v120, 16, v79
v_and_b32 v121, 0xffff0000, v79
v_pk_add_f32 v[186:187], v[186:187], v[120:121]
v_cvt_pk_bf16_f32 v184, v184, v185
v_cvt_pk_bf16_f32 v185, v186, v187
s_mov_b32 s72, 0
buffer_store_dwordx2 v[184:185], v48, s[20:23], s72 offen offset:96
s_waitcnt vmcnt(11)
v_lshlrev_b32 v120, 16, v80
v_and_b32 v121, 0xffff0000, v80
v_pk_add_f32 v[188:189], v[188:189], v[120:121]
v_lshlrev_b32 v120, 16, v81
v_and_b32 v121, 0xffff0000, v81
v_pk_add_f32 v[190:191], v[190:191], v[120:121]
v_cvt_pk_bf16_f32 v188, v188, v189
v_cvt_pk_bf16_f32 v189, v190, v191
s_mov_b32 s72, 36864
buffer_store_dwordx2 v[188:189], v48, s[20:23], s72 offen offset:96
v_lshlrev_b32 v120, 16, v82
v_and_b32 v121, 0xffff0000, v82
v_pk_add_f32 v[192:193], v[192:193], v[120:121]
v_lshlrev_b32 v120, 16, v83
v_and_b32 v121, 0xffff0000, v83
v_pk_add_f32 v[194:195], v[194:195], v[120:121]
v_cvt_pk_bf16_f32 v192, v192, v193
v_cvt_pk_bf16_f32 v193, v194, v195
s_mov_b32 s72, 73728
buffer_store_dwordx2 v[192:193], v48, s[20:23], s72 offen offset:96
s_waitcnt vmcnt(12)
v_lshlrev_b32 v120, 16, v84
v_and_b32 v121, 0xffff0000, v84
v_pk_add_f32 v[196:197], v[196:197], v[120:121]
v_lshlrev_b32 v120, 16, v85
v_and_b32 v121, 0xffff0000, v85
v_pk_add_f32 v[198:199], v[198:199], v[120:121]
v_cvt_pk_bf16_f32 v196, v196, v197
v_cvt_pk_bf16_f32 v197, v198, v199
s_mov_b32 s72, 0
buffer_store_dwordx2 v[196:197], v48, s[20:23], s72 offen offset:128
v_lshlrev_b32 v120, 16, v86
v_and_b32 v121, 0xffff0000, v86
v_pk_add_f32 v[200:201], v[200:201], v[120:121]
v_lshlrev_b32 v120, 16, v87
v_and_b32 v121, 0xffff0000, v87
v_pk_add_f32 v[202:203], v[202:203], v[120:121]
v_cvt_pk_bf16_f32 v200, v200, v201
v_cvt_pk_bf16_f32 v201, v202, v203
s_mov_b32 s72, 36864
buffer_store_dwordx2 v[200:201], v48, s[20:23], s72 offen offset:128
s_endpgm
s_waitcnt vmcnt(0) lgkmcnt(0)
L_red1:
ds_write_b128 v46, v[148:151] offset:0
ds_write_b128 v46, v[152:155] offset:1024
ds_write_b128 v46, v[156:159] offset:2048
ds_write_b128 v46, v[160:163] offset:3072
ds_write_b128 v46, v[164:167] offset:4096
ds_write_b128 v46, v[168:171] offset:5120
ds_write_b128 v46, v[172:175] offset:6144
ds_write_b128 v46, v[176:179] offset:7168
ds_write_b128 v46, v[180:183] offset:8192
ds_write_b128 v46, v[184:187] offset:9216
ds_write_b128 v46, v[188:191] offset:10240
ds_write_b128 v46, v[192:195] offset:11264
ds_write_b128 v46, v[196:199] offset:12288
ds_write_b128 v46, v[200:203] offset:13312
s_waitcnt lgkmcnt(0)
s_barrier
ds_read_b128 v[60:63], v47 offset:0
ds_read_b128 v[64:67], v47 offset:1024
ds_read_b128 v[68:71], v47 offset:2048
ds_read_b128 v[72:75], v47 offset:3072
ds_read_b128 v[76:79], v47 offset:4096
ds_read_b128 v[80:83], v47 offset:5120
ds_read_b128 v[84:87], v47 offset:6144
ds_read_b128 v[88:91], v47 offset:7168
ds_read_b128 v[92:95], v47 offset:8192
ds_read_b128 v[96:99], v47 offset:9216
ds_read_b128 v[100:103], v47 offset:10240
ds_read_b128 v[104:107], v47 offset:11264
ds_read_b128 v[108:111], v47 offset:12288
s_cmp_eq_u32 s38, 0
s_cbranch_scc1 L_own1
s_waitcnt lgkmcnt(12)
v_pk_add_f32 v[204:205], v[204:205], v[60:61]
v_pk_add_f32 v[206:207], v[206:207], v[62:63]
v_cvt_pk_bf16_f32 v204, v204, v205
v_cvt_pk_bf16_f32 v205, v206, v207
s_waitcnt lgkmcnt(11)
v_pk_add_f32 v[208:209], v[208:209], v[64:65]
v_pk_add_f32 v[210:211], v[210:211], v[66:67]
v_cvt_pk_bf16_f32 v206, v208, v209
v_cvt_pk_bf16_f32 v207, v210, v211
s_movk_i32 s72, 0
buffer_store_dwordx4 v[204:207], v49, s[28:31], s72 offen offset:0 sc1
s_waitcnt lgkmcnt(10)
v_pk_add_f32 v[212:213], v[212:213], v[68:69]
v_pk_add_f32 v[214:215], v[214:215], v[70:71]
v_cvt_pk_bf16_f32 v212, v212, v213
v_cvt_pk_bf16_f32 v213, v214, v215
s_waitcnt lgkmcnt(9)
v_pk_add_f32 v[216:217], v[216:217], v[72:73]
v_pk_add_f32 v[218:219], v[218:219], v[74:75]
v_cvt_pk_bf16_f32 v214, v216, v217
v_cvt_pk_bf16_f32 v215, v218, v219
buffer_store_dwordx4 v[212:215], v49, s[28:31], s72 offen offset:1024 sc1
s_waitcnt lgkmcnt(8)
v_pk_add_f32 v[220:221], v[220:221], v[76:77]
v_pk_add_f32 v[222:223], v[222:223], v[78:79]
v_cvt_pk_bf16_f32 v220, v220, v221
v_cvt_pk_bf16_f32 v221, v222, v223
s_waitcnt lgkmcnt(7)
v_pk_add_f32 v[224:225], v[224:225], v[80:81]
v_pk_add_f32 v[226:227], v[226:227], v[82:83]
v_cvt_pk_bf16_f32 v222, v224, v225
v_cvt_pk_bf16_f32 v223, v226, v227
buffer_store_dwordx4 v[220:223], v49, s[28:31], s72 offen offset:2048 sc1
s_waitcnt lgkmcnt(6)
v_pk_add_f32 v[228:229], v[228:229], v[84:85]
v_pk_add_f32 v[230:231], v[230:231], v[86:87]
v_cvt_pk_bf16_f32 v228, v228, v229
v_cvt_pk_bf16_f32 v229, v230, v231
s_waitcnt lgkmcnt(5)
v_pk_add_f32 v[232:233], v[232:233], v[88:89]
v_pk_add_f32 v[234:235], v[234:235], v[90:91]
v_cvt_pk_bf16_f32 v230, v232, v233
v_cvt_pk_bf16_f32 v231, v234, v235
buffer_store_dwordx4 v[228:231], v49, s[28:31], s72 offen offset:3072 sc1
s_waitcnt lgkmcnt(4)
v_pk_add_f32 v[236:237], v[236:237], v[92:93]
v_pk_add_f32 v[238:239], v[238:239], v[94:95]
v_cvt_pk_bf16_f32 v236, v236, v237
v_cvt_pk_bf16_f32 v237, v238, v239
s_waitcnt lgkmcnt(3)
v_pk_add_f32 v[240:241], v[240:241], v[96:97]
v_pk_add_f32 v[242:243], v[242:243], v[98:99]
v_cvt_pk_bf16_f32 v238, v240, v241
v_cvt_pk_bf16_f32 v239, v242, v243
s_movk_i32 s72, 4096
buffer_store_dwordx4 v[236:239], v49, s[28:31], s72 offen offset:0 sc1
s_waitcnt lgkmcnt(2)
v_pk_add_f32 v[244:245], v[244:245], v[100:101]
v_pk_add_f32 v[246:247], v[246:247], v[102:103]
v_cvt_pk_bf16_f32 v244, v244, v245
v_cvt_pk_bf16_f32 v245, v246, v247
s_waitcnt lgkmcnt(1)
v_pk_add_f32 v[248:249], v[248:249], v[104:105]
v_pk_add_f32 v[250:251], v[250:251], v[106:107]
v_cvt_pk_bf16_f32 v246, v248, v249
v_cvt_pk_bf16_f32 v247, v250, v251
buffer_store_dwordx4 v[244:247], v49, s[28:31], s72 offen offset:1024 sc1
s_waitcnt lgkmcnt(0)
v_pk_add_f32 v[252:253], v[252:253], v[108:109]
v_pk_add_f32 v[254:255], v[254:255], v[110:111]
v_cvt_pk_bf16_f32 v252, v252, v253
v_cvt_pk_bf16_f32 v253, v254, v255
buffer_store_dwordx4 v[252:255], v49, s[28:31], s72 offen offset:2048 sc1
v_mov_b32 v40, s39
v_mov_b32 v41, 1
s_waitcnt vmcnt(0) lgkmcnt(0)
s_mov_b64 exec, 1
global_store_dword v40, v41, s[96:97] sc0 sc1
s_mov_b64 exec, -1
s_endpgm
L_own1:
s_waitcnt lgkmcnt(0)
v_pk_add_f32 v[204:205], v[204:205], v[60:61]
v_pk_add_f32 v[206:207], v[206:207], v[62:63]
v_pk_add_f32 v[208:209], v[208:209], v[64:65]
v_pk_add_f32 v[210:211], v[210:211], v[66:67]
v_pk_add_f32 v[212:213], v[212:213], v[68:69]
v_pk_add_f32 v[214:215], v[214:215], v[70:71]
v_pk_add_f32 v[216:217], v[216:217], v[72:73]
v_pk_add_f32 v[218:219], v[218:219], v[74:75]
v_pk_add_f32 v[220:221], v[220:221], v[76:77]
v_pk_add_f32 v[222:223], v[222:223], v[78:79]
v_pk_add_f32 v[224:225], v[224:225], v[80:81]
v_pk_add_f32 v[226:227], v[226:227], v[82:83]
v_pk_add_f32 v[228:229], v[228:229], v[84:85]
v_pk_add_f32 v[230:231], v[230:231], v[86:87]
v_pk_add_f32 v[232:233], v[232:233], v[88:89]
v_pk_add_f32 v[234:235], v[234:235], v[90:91]
v_pk_add_f32 v[236:237], v[236:237], v[92:93]
v_pk_add_f32 v[238:239], v[238:239], v[94:95]
v_pk_add_f32 v[240:241], v[240:241], v[96:97]
v_pk_add_f32 v[242:243], v[242:243], v[98:99]
v_pk_add_f32 v[244:245], v[244:245], v[100:101]
v_pk_add_f32 v[246:247], v[246:247], v[102:103]
v_pk_add_f32 v[248:249], v[248:249], v[104:105]
v_pk_add_f32 v[250:251], v[250:251], v[106:107]
v_pk_add_f32 v[252:253], v[252:253], v[108:109]
v_pk_add_f32 v[254:255], v[254:255], v[110:111]
s_mov_b32 s93, 0
v_mbcnt_lo_u32_b32 v43, -1, 0
v_lshl_add_u32 v43, v43, 2, s39
s_mov_b64 exec, 1
L_xp1_l:
global_load_dword v42, v43, s[96:97] sc0 sc1
s_waitcnt vmcnt(0)
v_cmp_gt_u32 vcc, 1, v42
s_add_u32 s93, s93, 1
s_nop 4
s_cmp_eq_u64 vcc, 0
s_cbranch_scc1 L_xp1_d
s_sleep 4
s_cmp_lt_u32 s93, 100000
s_cbranch_scc1 L_xp1_l
L_xp1_d:
s_mov_b64 exec, -1
s_movk_i32 s72, 0
buffer_load_dwordx4 v[60:63], v49, s[28:31], s72 offen offset:0 sc1
buffer_load_dwordx4 v[64:67], v49, s[28:31], s72 offen offset:1024 sc1
buffer_load_dwordx4 v[68:71], v49, s[28:31], s72 offen offset:2048 sc1
buffer_load_dwordx4 v[72:75], v49, s[28:31], s72 offen offset:3072 sc1
s_movk_i32 s72, 4096
buffer_load_dwordx4 v[76:79], v49, s[28:31], s72 offen offset:0 sc1
buffer_load_dwordx4 v[80:83], v49, s[28:31], s72 offen offset:1024 sc1
buffer_load_dwordx4 v[84:87], v49, s[28:31], s72 offen offset:2048 sc1
s_waitcnt vmcnt(6)
v_lshlrev_b32 v120, 16, v60
v_and_b32 v121, 0xffff0000, v60
v_pk_add_f32 v[204:205], v[204:205], v[120:121]
v_lshlrev_b32 v120, 16, v61
v_and_b32 v121, 0xffff0000, v61
v_pk_add_f32 v[206:207], v[206:207], v[120:121]
v_cvt_pk_bf16_f32 v204, v204, v205
v_cvt_pk_bf16_f32 v205, v206, v207
s_mov_b32 s72, 73728
buffer_store_dwordx2 v[204:205], v48, s[20:23], s72 offen offset:128
v_lshlrev_b32 v120, 16, v62
v_and_b32 v121, 0xffff0000, v62
v_pk_add_f32 v[208:209], v[208:209], v[120:121]
v_lshlrev_b32 v120, 16, v63
v_and_b32 v121, 0xffff0000, v63
v_pk_add_f32 v[210:211], v[210:211], v[120:121]
v_cvt_pk_bf16_f32 v208, v208, v209
v_cvt_pk_bf16_f32 v209, v210, v211
s_mov_b32 s72, 0
buffer_store_dwordx2 v[208:209], v48, s[20:23], s72 offen offset:160
s_waitcnt vmcnt(7)
v_lshlrev_b32 v120, 16, v64
v_and_b32 v121, 0xffff0000, v64
v_pk_add_f32 v[212:213], v[212:213], v[120:121]
v_lshlrev_b32 v120, 16, v65
v_and_b32 v121, 0xffff0000, v65
v_pk_add_f32 v[214:215], v[214:215], v[120:121]
v_cvt_pk_bf16_f32 v212, v212, v213
v_cvt_pk_bf16_f32 v213, v214, v215
s_mov_b32 s72, 36864
buffer_store_dwordx2 v[212:213], v48, s[20:23], s72 offen offset:160
v_lshlrev_b32 v120, 16, v66
v_and_b32 v121, 0xffff0000, v66
v_pk_add_f32 v[216:217], v[216:217], v[120:121]
v_lshlrev_b32 v120, 16, v67
v_and_b32 v121, 0xffff0000, v67
v_pk_add_f32 v[218:219], v[218:219], v[120:121]
v_cvt_pk_bf16_f32 v216, v216, v217
v_cvt_pk_bf16_f32 v217, v218, v219
s_mov_b32 s72, 73728
buffer_store_dwordx2 v[216:217], v48, s[20:23], s72 offen offset:160
s_waitcnt vmcnt(8)
v_lshlrev_b32 v120, 16, v68
v_and_b32 v121, 0xffff0000, v68
v_pk_add_f32 v[220:221], v[220:221], v[120:121]
v_lshlrev_b32 v120, 16, v69
v_and_b32 v121, 0xffff0000, v69
v_pk_add_f32 v[222:223], v[222:223], v[120:121]
v_cvt_pk_bf16_f32 v220, v220, v221
v_cvt_pk_bf16_f32 v221, v222, v223
s_mov_b32 s72, 0
buffer_store_dwordx2 v[220:221], v48, s[20:23], s72 offen offset:192
v_lshlrev_b32 v120, 16, v70
v_and_b32 v121, 0xffff0000, v70
v_pk_add_f32 v[224:225], v[224:225], v[120:121]
v_lshlrev_b32 v120, 16, v71
v_and_b32 v121, 0xffff0000, v71
v_pk_add_f32 v[226:227], v[226:227], v[120:121]
v_cvt_pk_bf16_f32 v224, v224, v225
v_cvt_pk_bf16_f32 v225, v226, v227
s_mov_b32 s72, 36864
buffer_store_dwordx2 v[224:225], v48, s[20:23], s72 offen offset:192
s_waitcnt vmcnt(9)
v_lshlrev_b32 v120, 16, v72
v_and_b32 v121, 0xffff0000, v72
v_pk_add_f32 v[228:229], v[228:229], v[120:121]
v_lshlrev_b32 v120, 16, v73
v_and_b32 v121, 0xffff0000, v73
v_pk_add_f32 v[230:231], v[230:231], v[120:121]
v_cvt_pk_bf16_f32 v228, v228, v229
v_cvt_pk_bf16_f32 v229, v230, v231
s_mov_b32 s72, 73728
buffer_store_dwordx2 v[228:229], v48, s[20:23], s72 offen offset:192
v_lshlrev_b32 v120, 16, v74
v_and_b32 v121, 0xffff0000, v74
v_pk_add_f32 v[232:233], v[232:233], v[120:121]
v_lshlrev_b32 v120, 16, v75
v_and_b32 v121, 0xffff0000, v75
v_pk_add_f32 v[234:235], v[234:235], v[120:121]
v_cvt_pk_bf16_f32 v232, v232, v233
v_cvt_pk_bf16_f32 v233, v234, v235
s_mov_b32 s72, 0
buffer_store_dwordx2 v[232:233], v48, s[20:23], s72 offen offset:224
s_waitcnt vmcnt(10)
v_lshlrev_b32 v120, 16, v76
v_and_b32 v121, 0xffff0000, v76
v_pk_add_f32 v[236:237], v[236:237], v[120:121]
v_lshlrev_b32 v120, 16, v77
v_and_b32 v121, 0xffff0000, v77
v_pk_add_f32 v[238:239], v[238:239], v[120:121]
v_cvt_pk_bf16_f32 v236, v236, v237
v_cvt_pk_bf16_f32 v237, v238, v239
s_mov_b32 s72, 36864
buffer_store_dwordx2 v[236:237], v48, s[20:23], s72 offen offset:224
v_lshlrev_b32 v120, 16, v78
v_and_b32 v121, 0xffff0000, v78
v_pk_add_f32 v[240:241], v[240:241], v[120:121]
v_lshlrev_b32 v120, 16, v79
v_and_b32 v121, 0xffff0000, v79
v_pk_add_f32 v[242:243], v[242:243], v[120:121]
v_cvt_pk_bf16_f32 v240, v240, v241
v_cvt_pk_bf16_f32 v241, v242, v243
s_mov_b32 s72, 73728
buffer_store_dwordx2 v[240:241], v48, s[20:23], s72 offen offset:224
s_waitcnt vmcnt(11)
v_lshlrev_b32 v120, 16, v80
v_and_b32 v121, 0xffff0000, v80
v_pk_add_f32 v[244:245], v[244:245], v[120:121]
v_lshlrev_b32 v120, 16, v81
v_and_b32 v121, 0xffff0000, v81
v_pk_add_f32 v[246:247], v[246:247], v[120:121]
v_cvt_pk_bf16_f32 v244, v244, v245
v_cvt_pk_bf16_f32 v245, v246, v247
s_mov_b32 s72, 0
buffer_store_dwordx2 v[244:245], v48, s[20:23], s72 offen offset:256
v_lshlrev_b32 v120, 16, v82
v_and_b32 v121, 0xffff0000, v82
v_pk_add_f32 v[248:249], v[248:249], v[120:121]
v_lshlrev_b32 v120, 16, v83
v_and_b32 v121, 0xffff0000, v83
v_pk_add_f32 v[250:251], v[250:251], v[120:121]
v_cvt_pk_bf16_f32 v248, v248, v249
v_cvt_pk_bf16_f32 v249, v250, v251
s_mov_b32 s72, 36864
buffer_store_dwordx2 v[248:249], v48, s[20:23], s72 offen offset:256
s_waitcnt vmcnt(12)
v_lshlrev_b32 v120, 16, v84
v_and_b32 v121, 0xffff0000, v84
v_pk_add_f32 v[252:253], v[252:253], v[120:121]
v_lshlrev_b32 v120, 16, v85
v_and_b32 v121, 0xffff0000, v85
v_pk_add_f32 v[254:255], v[254:255], v[120:121]
v_cvt_pk_bf16_f32 v252, v252, v253
v_cvt_pk_bf16_f32 v253, v254, v255
s_mov_b32 s72, 73728
buffer_store_dwordx2 v[252:253], v48, s[20:23], s72 offen offset:256
s_endpgm
s_waitcnt vmcnt(0) lgkmcnt(0)
L_fallback:
s_waitcnt vmcnt(0) lgkmcnt(0)
s_nop 7
s_lshl_b32 s95, s99, 21
s_lshl_b32 s35, s99, 12
s_barrier
v_mbcnt_lo_u32_b32 v21, -1, 0
v_mbcnt_hi_u32_b32 v21, -1, v21
v_lshrrev_b32 v19, 4, v21
v_lshl_add_u32 v16, s60, 2, v19
v_and_b32 v17, 15, v21
v_and_b32 v18, 3, v16
v_lshrrev_b32 v20, 3, v16
v_lshl_add_u32 v18, v20, 2, v18
v_lshlrev_b32 v18, 1, v18
v_xor_b32 v18, v18, v17
v_lshlrev_b32 v18, 4, v18
v_lshl_add_u32 v0, v16, 13, v18
s_lshr_b32 s73, s62, 2
s_mul_i32 s73, s73, 96
s_lshl_b32 s74, s60, 3
s_add_u32 s73, s73, s74
s_and_b32 s74, s60, 1
s_lshl_b32 s74, s74, 2
v_lshrrev_b32 v18, 3, v21
v_add_u32 v18, s73, v18
v_mul_u32_u24 v18, 1152, v18
v_and_b32 v20, 7, v21
v_xor_b32 v20, v20, v19
v_xor_b32 v20, s74, v20
v_lshl_add_u32 v1, v20, 4, v18
v_mbcnt_lo_u32_b32 v28, -1, 0
v_mbcnt_hi_u32_b32 v28, -1, v28
v_and_b32 v25, 15, v28
v_lshrrev_b32 v27, 4, v28
v_lshrrev_b32 v26, 1, v25
v_xor_b32 v26, v26, v27
v_lshlrev_b32 v26, 4, v26
v_lshl_add_u32 v26, v25, 7, v26
v_add_u32 v60, s32, v26
v_xor_b32 v61, 64, v60
v_lshrrev_b32 v24, 2, v28
v_and_b32 v24, 3, v24
v_lshl_add_u32 v25, v27, 3, v24
v_and_b32 v26, 1, v27
v_lshl_add_u32 v26, v26, 2, v24
v_lshlrev_b32 v26, 5, v26
v_lshl_add_u32 v26, v25, 8, v26
v_and_b32 v28, 3, v28
v_lshl_add_u32 v26, v28, 3, v26
v_add_u32 v26, 24576, v26
v_add_u32 v52, s63, v26
v_xor_b32 v53, 32, v52
v_xor_b32 v54, 64, v52
v_xor_b32 v55, 96, v52
v_xor_b32 v56, 128, v52
v_xor_b32 v57, 160, v52
v_xor_b32 v58, 192, v52
v_xor_b32 v59, 224, v52
v_mbcnt_lo_u32_b32 v24, -1, 0
v_mbcnt_hi_u32_b32 v24, -1, v24
v_and_b32 v25, 15, v24
v_lshrrev_b32 v26, 4, v24
v_xor_b32 v27, v25, v26
v_lshlrev_b32 v27, 4, v27
v_lshl_add_u32 v27, v25, 8, v27
v_add_u32 v4, s63, v27
v_xor_b32 v5, 64, v4
v_xor_b32 v6, 128, v4
v_xor_b32 v7, 192, v4
v_lshrrev_b32 v25, 2, v24
v_and_b32 v26, 3, v24
v_lshlrev_b32 v26, 3, v26
v_lshl_add_u32 v26, v25, 8, v26
v_and_b32 v27, 7, v25
v_lshl_add_u32 v26, v27, 5, v26
v_add_u32 v26, 40960, v26
v_add_u32 v8, s63, v26
v_xor_b32 v9, 32, v8
v_xor_b32 v10, 64, v8
v_xor_b32 v11, 96, v8
v_xor_b32 v12, 128, v8
v_xor_b32 v13, 160, v8
v_xor_b32 v14, 192, v8
v_xor_b32 v15, 224, v8
v_and_b32 v25, 3, v24
v_mov_b32 v26, 0x3f803f80
v_cmp_eq_u32 vcc, 0, v25
s_nop 1
v_cndmask_b32 v36, 0, v26, vcc
v_mov_b32 v37, v36
v_mov_b32 v38, v36
v_mov_b32 v39, v36
s_add_u32 m0, s61, 0
s_mov_b32 s66, 0
buffer_load_dwordx4 v1, s[40:43], s66 offen lds
s_add_u32 m0, s61, 4096
s_mov_b32 s66, 36864
buffer_load_dwordx4 v1, s[40:43], s66 offen lds
s_add_u32 m0, s61, 8192
s_mov_b32 s66, 73728
buffer_load_dwordx4 v1, s[40:43], s66 offen lds
s_add_u32 m0, s61, 40960
s_add_u32 s66, s35, 0
buffer_load_dwordx4 v0, s[44:47], s66 offen lds
s_add_u32 m0, s61, 45056
s_add_u32 s66, s35, 131072
buffer_load_dwordx4 v0, s[44:47], s66 offen lds
s_add_u32 m0, s61, 12288
s_mov_b32 s66, 128
buffer_load_dwordx4 v1, s[40:43], s66 offen lds
s_add_u32 m0, s61, 16384
s_mov_b32 s66, 36992
buffer_load_dwordx4 v1, s[40:43], s66 offen lds
s_add_u32 m0, s61, 20480
s_mov_b32 s66, 73856
buffer_load_dwordx4 v1, s[40:43], s66 offen lds
s_add_u32 m0, s61, 49152
s_add_u32 s66, s35, 262144
buffer_load_dwordx4 v0, s[44:47], s66 offen lds
s_add_u32 m0, s61, 53248
s_add_u32 s66, s35, 393216
buffer_load_dwordx4 v0, s[44:47], s66 offen lds
s_add_u32 m0, s61, 57344
s_add_u32 s66, s35, 524288
buffer_load_dwordx4 v0, s[44:47], s66 offen lds
s_add_u32 m0, s61, 61440
s_add_u32 s66, s35, 655360
buffer_load_dwordx4 v0, s[44:47], s66 offen lds
s_add_u32 m0, s61, 24576
s_mov_b32 s66, 256
buffer_load_dwordx4 v1, s[40:43], s66 offen lds
s_add_u32 m0, s61, 28672
s_mov_b32 s66, 37120
buffer_load_dwordx4 v1, s[40:43], s66 offen lds
s_add_u32 m0, s61, 32768
s_mov_b32 s66, 73984
buffer_load_dwordx4 v1, s[40:43], s66 offen lds
s_add_u32 m0, s61, 65536
s_add_u32 s66, s35, 786432
buffer_load_dwordx4 v0, s[44:47], s66 offen lds
s_add_u32 m0, s61, 69632
s_add_u32 s66, s35, 917504
buffer_load_dwordx4 v0, s[44:47], s66 offen lds
s_add_u32 m0, s61, 73728
s_add_u32 s66, s35, 1048576
buffer_load_dwordx4 v0, s[44:47], s66 offen lds
s_add_u32 m0, s61, 77824
s_add_u32 s66, s35, 1179648
buffer_load_dwordx4 v0, s[44:47], s66 offen lds
s_waitcnt vmcnt(7)
s_barrier
ds_read_b128 v[64:67], v60 offset:0
ds_read_b128 v[76:79], v61 offset:0
ds_read_b128 v[68:71], v60 offset:2048
ds_read_b128 v[80:83], v61 offset:2048
ds_read_b128 v[72:75], v60 offset:4096
ds_read_b128 v[84:87], v61 offset:4096
TR 16,52,16384
TR 18,52,17408
s_waitcnt lgkmcnt(0)
MZ 160,16,64
TR 20,53,16384
TR 22,53,17408
MZ 164,16,68
TR 24,54,16384
TR 26,54,17408
MZ 168,16,72
TR 28,55,16384
TR 30,55,17408
s_waitcnt lgkmcnt(4)
MZ 172,20,64
TR 32,56,16384
TR 34,56,17408
MZ 176,20,68
ds_read_b128 v[88:91], v60 offset:12288
ds_read_b128 v[100:103], v61 offset:12288
MZ 180,20,72
TR 16,57,16384
TR 18,57,17408
s_waitcnt lgkmcnt(8)
MZ 184,24,64
ds_read_b128 v[92:95], v60 offset:14336
ds_read_b128 v[104:107], v61 offset:14336
MZ 188,24,68
TR 20,58,16384
TR 22,58,17408
MZ 192,24,72
ds_read_b128 v[96:99], v60 offset:16384
ds_read_b128 v[108:111], v61 offset:16384
s_waitcnt lgkmcnt(12)
MZ 196,28,64
TR 24,59,16384
TR 26,59,17408
MZ 200,28,68
MZ 204,28,72
TR 28,52,24576
TR 30,52,25600
s_waitcnt lgkmcnt(14)
MZ 208,32,64
MZ 212,32,68
MZ 216,32,72
TR 32,53,24576
TR 34,53,25600
s_waitcnt lgkmcnt(12)
MZ 220,16,64
MZ 224,16,68
MZ 228,16,72
TR 16,54,24576
TR 18,54,25600
s_waitcnt lgkmcnt(10)
MZ 232,20,64
MZ 236,20,68
MZ 240,20,72
TR 20,55,24576
TR 22,55,25600
s_waitcnt lgkmcnt(8)
MZ 244,24,64
MZ 248,24,68
MZ 252,24,72
TR 24,56,24576
TR 26,56,25600
s_waitcnt lgkmcnt(8)
MA 160,28,76
MA 164,28,80
MA 168,28,84
TR 28,57,24576
TR 30,57,25600
s_waitcnt lgkmcnt(8)
MA 172,32,76
MA 176,32,80
MA 180,32,84
TR 32,58,24576
TR 34,58,25600
s_waitcnt lgkmcnt(8)
MA 184,16,76
MA 188,16,80
MA 192,16,84
TR 16,59,24576
TR 18,59,25600
s_waitcnt lgkmcnt(8)
MA 196,20,76
MA 200,20,80
MA 204,20,84
TR 20,52,32768
TR 22,52,33792
s_waitcnt lgkmcnt(8)
MA 208,24,76
MA 212,24,80
MA 216,24,84
TR 24,53,32768
TR 26,53,33792
s_waitcnt lgkmcnt(8)
MA 220,28,76
MA 224,28,80
MA 228,28,84
TR 28,54,32768
TR 30,54,33792
s_waitcnt lgkmcnt(8)
MA 232,32,76
MA 236,32,80
MA 240,32,84
TR 32,55,32768
TR 34,55,33792
s_waitcnt lgkmcnt(8)
MA 244,16,76
MA 248,16,80
MA 252,16,84
TR 16,56,32768
TR 18,56,33792
s_waitcnt vmcnt(0)
s_barrier
s_waitcnt lgkmcnt(8)
MA 160,20,88
ds_read_b128 v[64:67], v60 offset:24576
ds_read_b128 v[76:79], v61 offset:24576
MA 164,20,92
s_add_u32 m0, s61, 0
s_mov_b32 s66, 384
buffer_load_dwordx4 v1, s[40:43], s66 offen lds
MA 168,20,96
TR 20,57,32768
TR 22,57,33792
s_waitcnt lgkmcnt(10)
MA 172,24,88
s_add_u32 m0, s61, 4096
s_mov_b32 s66, 37248
buffer_load_dwordx4 v1, s[40:43], s66 offen lds
ds_read_b128 v[68:71], v60 offset:26624
ds_read_b128 v[80:83], v61 offset:26624
MA 176,24,92
MA 180,24,96
s_add_u32 m0, s61, 8192
s_mov_b32 s66, 74112
buffer_load_dwordx4 v1, s[40:43], s66 offen lds
TR 24,58,32768
TR 26,58,33792
s_waitcnt lgkmcnt(12)
MA 184,28,88
ds_read_b128 v[72:75], v60 offset:28672
ds_read_b128 v[84:87], v61 offset:28672
MA 188,28,92
s_add_u32 m0, s61, 40960
s_add_u32 s66, s35, 1310720
buffer_load_dwordx4 v0, s[44:47], s66 offen lds
MA 192,28,96
TR 28,59,32768
TR 30,59,33792
s_waitcnt lgkmcnt(14)
MA 196,32,88
s_add_u32 m0, s61, 45056
s_add_u32 s66, s35, 1441792
buffer_load_dwordx4 v0, s[44:47], s66 offen lds
MA 200,32,92
MA 204,32,96
s_add_u32 m0, s61, 49152
s_add_u32 s66, s35, 1572864
buffer_load_dwordx4 v0, s[44:47], s66 offen lds
TR 32,52,40960
TR 34,52,41984
s_waitcnt lgkmcnt(14)
MA 208,16,88
MA 212,16,92
s_add_u32 m0, s61, 53248
s_add_u32 s66, s35, 1703936
buffer_load_dwordx4 v0, s[44:47], s66 offen lds
MA 216,16,96
TR 16,53,40960
TR 18,53,41984
s_waitcnt lgkmcnt(12)
MA 220,20,88
MA 224,20,92
MA 228,20,96
TR 20,54,40960
TR 22,54,41984
s_waitcnt lgkmcnt(10)
MA 232,24,88
MA 236,24,92
MA 240,24,96
TR 24,55,40960
TR 26,55,41984
s_waitcnt lgkmcnt(8)
MA 244,28,88
MA 248,28,92
MA 252,28,96
s_add_u32 m0, s61, 12288
s_mov_b32 s66, 512
buffer_load_dwordx4 v1, s[40:43], s66 offen lds
TR 28,56,40960
TR 30,56,41984
s_waitcnt lgkmcnt(8)
MA 160,32,100
MA 164,32,104
MA 168,32,108
TR 32,57,40960
TR 34,57,41984
s_waitcnt lgkmcnt(8)
MA 172,16,100
MA 176,16,104
MA 180,16,108
TR 16,58,40960
TR 18,58,41984
s_waitcnt lgkmcnt(8)
MA 184,20,100
MA 188,20,104
MA 192,20,108
TR 20,59,40960
TR 22,59,41984
s_waitcnt lgkmcnt(8)
MA 196,24,100
s_add_u32 m0, s61, 16384
s_mov_b32 s66, 37376
buffer_load_dwordx4 v1, s[40:43], s66 offen lds
MA 200,24,104
MA 204,24,108
TR 24,52,49152
TR 26,52,50176
s_waitcnt lgkmcnt(8)
MA 208,28,100
MA 212,28,104
MA 216,28,108
TR 28,53,49152
TR 30,53,50176
s_waitcnt lgkmcnt(8)
MA 220,32,100
MA 224,32,104
MA 228,32,108
TR 32,54,49152
TR 34,54,50176
s_waitcnt lgkmcnt(8)
MA 232,16,100
MA 236,16,104
s_add_u32 m0, s61, 20480
s_mov_b32 s66, 74240
buffer_load_dwordx4 v1, s[40:43], s66 offen lds
MA 240,16,108
TR 16,55,49152
TR 18,55,50176
s_waitcnt lgkmcnt(8)
MA 244,20,100
MA 248,20,104
MA 252,20,108
TR 20,56,49152
TR 22,56,50176
s_waitcnt vmcnt(3)
s_barrier
s_waitcnt lgkmcnt(8)
MA 160,24,64
ds_read_b128 v[88:91], v60 offset:0
ds_read_b128 v[100:103], v61 offset:0
MA 164,24,68
s_add_u32 m0, s61, 57344
s_add_u32 s66, s35, 1835008
buffer_load_dwordx4 v0, s[44:47], s66 offen lds
MA 168,24,72
TR 24,57,49152
TR 26,57,50176
s_waitcnt lgkmcnt(10)
MA 172,28,64
s_add_u32 m0, s61, 61440
s_add_u32 s66, s35, 1966080
buffer_load_dwordx4 v0, s[44:47], s66 offen lds
ds_read_b128 v[92:95], v60 offset:2048
ds_read_b128 v[104:107], v61 offset:2048
MA 176,28,68
MA 180,28,72
s_add_u32 m0, s61, 65536
s_add_u32 s66, s35, 2097152
buffer_load_dwordx4 v0, s[44:47], s66 offen lds
TR 28,58,49152
TR 30,58,50176
s_waitcnt lgkmcnt(12)
MA 184,32,64
ds_read_b128 v[96:99], v60 offset:4096
ds_read_b128 v[108:111], v61 offset:4096
MA 188,32,68
s_add_u32 m0, s61, 69632
s_add_u32 s66, s35, 2228224
buffer_load_dwordx4 v0, s[44:47], s66 offen lds
MA 192,32,72
TR 32,59,49152
TR 34,59,50176
s_waitcnt lgkmcnt(14)
MA 196,16,64
MA 200,16,68
MA 204,16,72
TR 16,52,16384
TR 18,52,17408
s_waitcnt lgkmcnt(14)
MA 208,20,64
MA 212,20,68
MA 216,20,72
TR 20,53,16384
TR 22,53,17408
s_waitcnt lgkmcnt(12)
MA 220,24,64
MA 224,24,68
MA 228,24,72
s_add_u32 m0, s61, 24576
s_mov_b32 s66, 640
buffer_load_dwordx4 v1, s[40:43], s66 offen lds
TR 24,54,16384
TR 26,54,17408
s_waitcnt lgkmcnt(10)
MA 232,28,64
MA 236,28,68
MA 240,28,72
TR 28,55,16384
TR 30,55,17408
s_waitcnt lgkmcnt(8)
MA 244,32,64
MA 248,32,68
MA 252,32,72
TR 32,56,16384
TR 34,56,17408
s_waitcnt lgkmcnt(8)
MA 160,16,76
MA 164,16,80
MA 168,16,84
TR 16,57,16384
TR 18,57,17408
s_waitcnt lgkmcnt(8)
MA 172,20,76
s_add_u32 m0, s61, 28672
s_mov_b32 s66, 37504
buffer_load_dwordx4 v1, s[40:43], s66 offen lds
MA 176,20,80
MA 180,20,84
TR 20,58,16384
TR 22,58,17408
s_waitcnt lgkmcnt(8)
MA 184,24,76
MA 188,24,80
MA 192,24,84
TR 24,59,16384
TR 26,59,17408
s_waitcnt lgkmcnt(8)
MA 196,28,76
MA 200,28,80
MA 204,28,84
TR 28,52,24576
TR 30,52,25600
s_waitcnt lgkmcnt(8)
MA 208,32,76
MA 212,32,80
s_add_u32 m0, s61, 32768
s_mov_b32 s66, 74368
buffer_load_dwordx4 v1, s[40:43], s66 offen lds
MA 216,32,84
TR 32,53,24576
TR 34,53,25600
s_waitcnt lgkmcnt(8)
MA 220,16,76
MA 224,16,80
MA 228,16,84
TR 16,54,24576
TR 18,54,25600
s_waitcnt lgkmcnt(8)
MA 232,20,76
MA 236,20,80
MA 240,20,84
TR 20,55,24576
TR 22,55,25600
s_waitcnt lgkmcnt(8)
MA 244,24,76
MA 248,24,80
MA 252,24,84
TR 24,56,24576
TR 26,56,25600
s_waitcnt vmcnt(3)
s_barrier
s_waitcnt lgkmcnt(8)
MA 160,28,88
ds_read_b128 v[64:67], v60 offset:12288
ds_read_b128 v[76:79], v61 offset:12288
MA 164,28,92
s_add_u32 m0, s61, 40960
s_add_u32 s66, s35, 2359296
buffer_load_dwordx4 v0, s[44:47], s66 offen lds
MA 168,28,96
TR 28,57,24576
TR 30,57,25600
s_waitcnt lgkmcnt(10)
MA 172,32,88
s_add_u32 m0, s61, 45056
s_add_u32 s66, s35, 2490368
buffer_load_dwordx4 v0, s[44:47], s66 offen lds
ds_read_b128 v[68:71], v60 offset:14336
ds_read_b128 v[80:83], v61 offset:14336
MA 176,32,92
MA 180,32,96
s_add_u32 m0, s61, 73728
s_add_u32 s66, s35, 2621440
buffer_load_dwordx4 v0, s[44:47], s66 offen lds
TR 32,58,24576
TR 34,58,25600
s_waitcnt lgkmcnt(12)
MA 184,16,88
ds_read_b128 v[72:75], v60 offset:16384
ds_read_b128 v[84:87], v61 offset:16384
MA 188,16,92
s_add_u32 m0, s61, 77824
s_add_u32 s66, s35, 2752512
buffer_load_dwordx4 v0, s[44:47], s66 offen lds
MA 192,16,96
TR 16,59,24576
TR 18,59,25600
s_waitcnt lgkmcnt(14)
MA 196,20,88
MA 200,20,92
MA 204,20,96
TR 20,52,32768
TR 22,52,33792
s_waitcnt lgkmcnt(14)
MA 208,24,88
MA 212,24,92
MA 216,24,96
TR 24,53,32768
TR 26,53,33792
s_waitcnt lgkmcnt(12)
MA 220,28,88
MA 224,28,92
MA 228,28,96
s_add_u32 m0, s61, 0
s_mov_b32 s66, 768
buffer_load_dwordx4 v1, s[40:43], s66 offen lds
TR 28,54,32768
TR 30,54,33792
s_waitcnt lgkmcnt(10)
MA 232,32,88
MA 236,32,92
MA 240,32,96
TR 32,55,32768
TR 34,55,33792
s_waitcnt lgkmcnt(8)
MA 244,16,88
MA 248,16,92
MA 252,16,96
TR 16,56,32768
TR 18,56,33792
s_waitcnt lgkmcnt(8)
MA 160,20,100
MA 164,20,104
MA 168,20,108
TR 20,57,32768
TR 22,57,33792
s_waitcnt lgkmcnt(8)
MA 172,24,100
s_add_u32 m0, s61, 4096
s_mov_b32 s66, 37632
buffer_load_dwordx4 v1, s[40:43], s66 offen lds
MA 176,24,104
MA 180,24,108
TR 24,58,32768
TR 26,58,33792
s_waitcnt lgkmcnt(8)
MA 184,28,100
MA 188,28,104
MA 192,28,108
TR 28,59,32768
TR 30,59,33792
s_waitcnt lgkmcnt(8)
MA 196,32,100
MA 200,32,104
MA 204,32,108
TR 32,52,40960
TR 34,52,41984
s_waitcnt lgkmcnt(8)
MA 208,16,100
MA 212,16,104
s_add_u32 m0, s61, 8192
s_mov_b32 s66, 74496
buffer_load_dwordx4 v1, s[40:43], s66 offen lds
MA 216,16,108
TR 16,53,40960
TR 18,53,41984
s_waitcnt lgkmcnt(8)
MA 220,20,100
MA 224,20,104
MA 228,20,108
TR 20,54,40960
TR 22,54,41984
s_waitcnt lgkmcnt(8)
MA 232,24,100
MA 236,24,104
MA 240,24,108
TR 24,55,40960
TR 26,55,41984
s_waitcnt lgkmcnt(8)
MA 244,28,100
MA 248,28,104
MA 252,28,108
TR 28,56,40960
TR 30,56,41984
s_waitcnt vmcnt(3)
s_barrier
s_waitcnt lgkmcnt(8)
MA 160,32,64
ds_read_b128 v[88:91], v60 offset:24576
ds_read_b128 v[100:103], v61 offset:24576
MA 164,32,68
s_add_u32 m0, s61, 49152
s_add_u32 s66, s35, 2883584
buffer_load_dwordx4 v0, s[44:47], s66 offen lds
MA 168,32,72
TR 32,57,40960
TR 34,57,41984
s_waitcnt lgkmcnt(10)
MA 172,16,64
s_add_u32 m0, s61, 53248
s_add_u32 s66, s35, 3014656
buffer_load_dwordx4 v0, s[44:47], s66 offen lds
ds_read_b128 v[92:95], v60 offset:26624
ds_read_b128 v[104:107], v61 offset:26624
MA 176,16,68
MA 180,16,72
s_add_u32 m0, s61, 57344
s_add_u32 s66, s35, 3145728
buffer_load_dwordx4 v0, s[44:47], s66 offen lds
TR 16,58,40960
TR 18,58,41984
s_waitcnt lgkmcnt(12)
MA 184,20,64
ds_read_b128 v[96:99], v60 offset:28672
ds_read_b128 v[108:111], v61 offset:28672
MA 188,20,68
s_add_u32 m0, s61, 61440
s_add_u32 s66, s35, 3276800
buffer_load_dwordx4 v0, s[44:47], s66 offen lds
MA 192,20,72
TR 20,59,40960
TR 22,59,41984
s_waitcnt lgkmcnt(14)
MA 196,24,64
MA 200,24,68
MA 204,24,72
TR 24,52,16384
TR 26,52,17408
s_waitcnt lgkmcnt(14)
MA 208,28,64
MA 212,28,68
MA 216,28,72
TR 28,53,16384
TR 30,53,17408
s_waitcnt lgkmcnt(12)
MA 220,32,64
MA 224,32,68
MA 228,32,72
s_add_u32 m0, s61, 12288
s_mov_b32 s66, 896
buffer_load_dwordx4 v1, s[40:43], s66 offen lds
TR 32,54,16384
TR 34,54,17408
s_waitcnt lgkmcnt(10)
MA 232,16,64
MA 236,16,68
MA 240,16,72
TR 16,55,16384
TR 18,55,17408
s_waitcnt lgkmcnt(8)
MA 244,20,64
MA 248,20,68
MA 252,20,72
TR 20,56,16384
TR 22,56,17408
s_waitcnt lgkmcnt(8)
MA 160,24,76
MA 164,24,80
MA 168,24,84
TR 24,57,16384
TR 26,57,17408
s_waitcnt lgkmcnt(8)
MA 172,28,76
s_add_u32 m0, s61, 16384
s_mov_b32 s66, 37760
buffer_load_dwordx4 v1, s[40:43], s66 offen lds
MA 176,28,80
MA 180,28,84
TR 28,58,16384
TR 30,58,17408
s_waitcnt lgkmcnt(8)
MA 184,32,76
MA 188,32,80
MA 192,32,84
TR 32,59,16384
TR 34,59,17408
s_waitcnt lgkmcnt(8)
MA 196,16,76
MA 200,16,80
MA 204,16,84
TR 16,52,49152
TR 18,52,50176
s_waitcnt lgkmcnt(8)
MA 208,20,76
MA 212,20,80
s_add_u32 m0, s61, 20480
s_mov_b32 s66, 74624
buffer_load_dwordx4 v1, s[40:43], s66 offen lds
MA 216,20,84
TR 20,53,49152
TR 22,53,50176
s_waitcnt lgkmcnt(8)
MA 220,24,76
MA 224,24,80
MA 228,24,84
TR 24,54,49152
TR 26,54,50176
s_waitcnt lgkmcnt(8)
MA 232,28,76
MA 236,28,80
MA 240,28,84
TR 28,55,49152
TR 30,55,50176
s_waitcnt lgkmcnt(8)
MA 244,32,76
MA 248,32,80
MA 252,32,84
TR 32,56,49152
TR 34,56,50176
s_waitcnt vmcnt(3)
s_barrier
s_waitcnt lgkmcnt(8)
MA 160,16,88
ds_read_b128 v[64:67], v60 offset:0
ds_read_b128 v[76:79], v61 offset:0
MA 164,16,92
s_add_u32 m0, s61, 40960
s_add_u32 s66, s35, 3407872
buffer_load_dwordx4 v0, s[44:47], s66 offen lds
MA 168,16,96
TR 16,57,49152
TR 18,57,50176
s_waitcnt lgkmcnt(10)
MA 172,20,88
s_add_u32 m0, s61, 45056
s_add_u32 s66, s35, 3538944
buffer_load_dwordx4 v0, s[44:47], s66 offen lds
ds_read_b128 v[68:71], v60 offset:2048
ds_read_b128 v[80:83], v61 offset:2048
MA 176,20,92
MA 180,20,96
s_add_u32 m0, s61, 65536
s_add_u32 s66, s35, 3670016
buffer_load_dwordx4 v0, s[44:47], s66 offen lds
TR 20,58,49152
TR 22,58,50176
s_waitcnt lgkmcnt(12)
MA 184,24,88
ds_read_b128 v[72:75], v60 offset:4096
ds_read_b128 v[84:87], v61 offset:4096
MA 188,24,92
s_add_u32 m0, s61, 69632
s_add_u32 s66, s35, 3801088
buffer_load_dwordx4 v0, s[44:47], s66 offen lds
MA 192,24,96
TR 24,59,49152
TR 26,59,50176
s_waitcnt lgkmcnt(14)
MA 196,28,88
MA 200,28,92
MA 204,28,96
TR 28,52,24576
TR 30,52,25600
s_waitcnt lgkmcnt(14)
MA 208,32,88
MA 212,32,92
MA 216,32,96
TR 32,53,24576
TR 34,53,25600
s_waitcnt lgkmcnt(12)
MA 220,16,88
MA 224,16,92
MA 228,16,96
s_add_u32 m0, s61, 24576
s_mov_b32 s66, 1024
buffer_load_dwordx4 v1, s[40:43], s66 offen lds
TR 16,54,24576
TR 18,54,25600
s_waitcnt lgkmcnt(10)
MA 232,20,88
MA 236,20,92
MA 240,20,96
TR 20,55,24576
TR 22,55,25600
s_waitcnt lgkmcnt(8)
MA 244,24,88
MA 248,24,92
MA 252,24,96
TR 24,56,24576
TR 26,56,25600
s_waitcnt lgkmcnt(8)
MA 160,28,100
MA 164,28,104
MA 168,28,108
TR 28,57,24576
TR 30,57,25600
s_waitcnt lgkmcnt(8)
MA 172,32,100
s_add_u32 m0, s61, 28672
s_mov_b32 s66, 37888
buffer_load_dwordx4 v1, s[40:43], s66 offen lds
MA 176,32,104
MA 180,32,108
TR 32,58,24576
TR 34,58,25600
s_waitcnt lgkmcnt(8)
MA 184,16,100
MA 188,16,104
MA 192,16,108
TR 16,59,24576
TR 18,59,25600
s_waitcnt lgkmcnt(8)
MA 196,20,100
MA 200,20,104
MA 204,20,108
TR 20,52,32768
TR 22,52,33792
s_waitcnt lgkmcnt(8)
MA 208,24,100
MA 212,24,104
s_add_u32 m0, s61, 32768
s_mov_b32 s66, 74752
buffer_load_dwordx4 v1, s[40:43], s66 offen lds
MA 216,24,108
TR 24,53,32768
TR 26,53,33792
s_waitcnt lgkmcnt(8)
MA 220,28,100
MA 224,28,104
MA 228,28,108
TR 28,54,32768
TR 30,54,33792
s_waitcnt lgkmcnt(8)
MA 232,32,100
MA 236,32,104
MA 240,32,108
TR 32,55,32768
TR 34,55,33792
s_waitcnt lgkmcnt(8)
MA 244,16,100
MA 248,16,104
MA 252,16,108
TR 16,56,32768
TR 18,56,33792
s_waitcnt vmcnt(3)
s_barrier
s_waitcnt lgkmcnt(8)
MA 160,20,64
ds_read_b128 v[88:91], v60 offset:12288
ds_read_b128 v[100:103], v61 offset:12288
MA 164,20,68
s_add_u32 m0, s61, 49152
s_add_u32 s66, s35, 3932160
buffer_load_dwordx4 v0, s[44:47], s66 offen lds
MA 168,20,72
TR 20,57,32768
TR 22,57,33792
s_waitcnt lgkmcnt(10)
MA 172,24,64
s_add_u32 m0, s61, 53248
s_add_u32 s66, s35, 4063232
buffer_load_dwordx4 v0, s[44:47], s66 offen lds
ds_read_b128 v[92:95], v60 offset:14336
ds_read_b128 v[104:107], v61 offset:14336
MA 176,24,68
MA 180,24,72
s_add_u32 m0, s61, 73728
s_add_u32 s66, s35, 4194304
buffer_load_dwordx4 v0, s[44:47], s66 offen lds
TR 24,58,32768
TR 26,58,33792
s_waitcnt lgkmcnt(12)
MA 184,28,64
ds_read_b128 v[96:99], v60 offset:16384
ds_read_b128 v[108:111], v61 offset:16384
MA 188,28,68
s_add_u32 m0, s61, 77824
s_add_u32 s66, s35, 4325376
buffer_load_dwordx4 v0, s[44:47], s66 offen lds
MA 192,28,72
TR 28,59,32768
TR 30,59,33792
s_waitcnt lgkmcnt(14)
MA 196,32,64
MA 200,32,68
MA 204,32,72
TR 32,52,16384
TR 34,52,17408
s_waitcnt lgkmcnt(14)
MA 208,16,64
MA 212,16,68
MA 216,16,72
TR 16,53,16384
TR 18,53,17408
s_waitcnt lgkmcnt(12)
MA 220,20,64
MA 224,20,68
MA 228,20,72
TR 20,54,16384
TR 22,54,17408
s_waitcnt lgkmcnt(10)
MA 232,24,64
MA 236,24,68
MA 240,24,72
TR 24,55,16384
TR 26,55,17408
s_waitcnt lgkmcnt(8)
MA 244,28,64
MA 248,28,68
MA 252,28,72
TR 28,56,16384
TR 30,56,17408
s_waitcnt lgkmcnt(8)
MA 160,32,76
MA 164,32,80
MA 168,32,84
TR 32,57,16384
TR 34,57,17408
s_waitcnt lgkmcnt(8)
MA 172,16,76
MA 176,16,80
MA 180,16,84
TR 16,58,16384
TR 18,58,17408
s_waitcnt lgkmcnt(8)
MA 184,20,76
MA 188,20,80
MA 192,20,84
TR 20,59,16384
TR 22,59,17408
s_waitcnt lgkmcnt(8)
MA 196,24,76
MA 200,24,80
MA 204,24,84
TR 24,52,40960
TR 26,52,41984
s_waitcnt lgkmcnt(8)
MA 208,28,76
MA 212,28,80
MA 216,28,84
TR 28,53,40960
TR 30,53,41984
s_waitcnt lgkmcnt(8)
MA 220,32,76
MA 224,32,80
MA 228,32,84
TR 32,54,40960
TR 34,54,41984
s_waitcnt lgkmcnt(8)
MA 232,16,76
MA 236,16,80
MA 240,16,84
TR 16,55,40960
TR 18,55,41984
s_waitcnt lgkmcnt(8)
MA 244,20,76
MA 248,20,80
MA 252,20,84
TR 20,56,40960
TR 22,56,41984
s_waitcnt vmcnt(0)
s_barrier
s_waitcnt lgkmcnt(8)
MA 160,24,88
ds_read_b128 v[64:67], v60 offset:24576
ds_read_b128 v[76:79], v61 offset:24576
MA 164,24,92
s_add_u32 m0, s61, 40960
s_add_u32 s66, s35, 4456448
buffer_load_dwordx4 v0, s[44:47], s66 offen lds
MA 168,24,96
TR 24,57,40960
TR 26,57,41984
s_waitcnt lgkmcnt(10)
MA 172,28,88
s_add_u32 m0, s61, 45056
s_add_u32 s66, s35, 4587520
buffer_load_dwordx4 v0, s[44:47], s66 offen lds
ds_read_b128 v[68:71], v60 offset:26624
ds_read_b128 v[80:83], v61 offset:26624
MA 176,28,92
MA 180,28,96
TR 28,58,40960
TR 30,58,41984
s_waitcnt lgkmcnt(12)
MA 184,32,88
ds_read_b128 v[72:75], v60 offset:28672
ds_read_b128 v[84:87], v61 offset:28672
MA 188,32,92
MA 192,32,96
TR 32,59,40960
TR 34,59,41984
s_waitcnt lgkmcnt(14)
MA 196,16,88
MA 200,16,92
MA 204,16,96
TR 16,52,24576
TR 18,52,25600
s_waitcnt lgkmcnt(14)
MA 208,20,88
MA 212,20,92
MA 216,20,96
TR 20,53,24576
TR 22,53,25600
s_waitcnt lgkmcnt(12)
MA 220,24,88
MA 224,24,92
MA 228,24,96
TR 24,54,24576
TR 26,54,25600
s_waitcnt lgkmcnt(10)
MA 232,28,88
MA 236,28,92
MA 240,28,96
TR 28,55,24576
TR 30,55,25600
s_waitcnt lgkmcnt(8)
MA 244,32,88
MA 248,32,92
MA 252,32,96
TR 32,56,24576
TR 34,56,25600
s_waitcnt lgkmcnt(8)
MA 160,16,100
MA 164,16,104
MA 168,16,108
TR 16,57,24576
TR 18,57,25600
s_waitcnt lgkmcnt(8)
MA 172,20,100
MA 176,20,104
MA 180,20,108
TR 20,58,24576
TR 22,58,25600
s_waitcnt lgkmcnt(8)
MA 184,24,100
MA 188,24,104
MA 192,24,108
TR 24,59,24576
TR 26,59,25600
s_waitcnt lgkmcnt(8)
MA 196,28,100
MA 200,28,104
MA 204,28,108
TR 28,52,49152
TR 30,52,50176
s_waitcnt lgkmcnt(8)
MA 208,32,100
MA 212,32,104
MA 216,32,108
TR 32,53,49152
TR 34,53,50176
s_waitcnt lgkmcnt(8)
MA 220,16,100
MA 224,16,104
MA 228,16,108
TR 16,54,49152
TR 18,54,50176
s_waitcnt lgkmcnt(8)
MA 232,20,100
MA 236,20,104
MA 240,20,108
TR 20,55,49152
TR 22,55,50176
s_waitcnt lgkmcnt(8)
MA 244,24,100
MA 248,24,104
MA 252,24,108
TR 24,56,49152
TR 26,56,50176
s_waitcnt vmcnt(0)
s_barrier
s_waitcnt lgkmcnt(8)
MA 160,28,64
MA 164,28,68
MA 168,28,72
TR 28,57,49152
TR 30,57,50176
s_waitcnt lgkmcnt(8)
MA 172,32,64
MA 176,32,68
MA 180,32,72
TR 32,58,49152
TR 34,58,50176
s_waitcnt lgkmcnt(8)
MA 184,16,64
MA 188,16,68
MA 192,16,72
TR 16,59,49152
TR 18,59,50176
s_waitcnt lgkmcnt(8)
MA 196,20,64
MA 200,20,68
MA 204,20,72
TR 20,52,16384
TR 22,52,17408
s_waitcnt lgkmcnt(8)
MA 208,24,64
MA 212,24,68
MA 216,24,72
TR 24,53,16384
TR 26,53,17408
s_waitcnt lgkmcnt(8)
MA 220,28,64
MA 224,28,68
MA 228,28,72
TR 28,54,16384
TR 30,54,17408
s_waitcnt lgkmcnt(8)
MA 232,32,64
MA 236,32,68
MA 240,32,72
TR 32,55,16384
TR 34,55,17408
s_waitcnt lgkmcnt(8)
MA 244,16,64
MA 248,16,68
MA 252,16,72
TR 16,56,16384
TR 18,56,17408
s_waitcnt lgkmcnt(8)
MA 160,20,76
MA 164,20,80
MA 168,20,84
TR 20,57,16384
TR 22,57,17408
s_waitcnt lgkmcnt(8)
MA 172,24,76
MA 176,24,80
MA 180,24,84
TR 24,58,16384
v_pk_mul_f32 v[160:161], v[160:161], s[68:69]
TR 26,58,17408
v_pk_mul_f32 v[162:163], v[162:163], s[68:69]
s_waitcnt lgkmcnt(8)
MA 184,28,76
MA 188,28,80
v_pk_mul_f32 v[172:173], v[172:173], s[68:69]
v_pk_mul_f32 v[174:175], v[174:175], s[68:69]
v_cvt_pk_bf16_f32 v112, v160, v161
MA 192,28,84
TR 28,59,16384
v_cvt_pk_bf16_f32 v113, v162, v163
TR 30,59,17408
v_cvt_pk_bf16_f32 v114, v172, v173
v_cvt_pk_bf16_f32 v115, v174, v175
s_waitcnt lgkmcnt(8)
MA 196,32,76
v_pk_mul_f32 v[164:165], v[164:165], s[68:69]
v_pk_mul_f32 v[166:167], v[166:167], s[68:69]
v_pk_mul_f32 v[176:177], v[176:177], s[68:69]
MA 200,32,80
v_pk_mul_f32 v[178:179], v[178:179], s[68:69]
v_cvt_pk_bf16_f32 v128, v164, v165
v_cvt_pk_bf16_f32 v129, v166, v167
MA 204,32,84
v_cvt_pk_bf16_f32 v130, v176, v177
v_cvt_pk_bf16_f32 v131, v178, v179
v_pk_mul_f32 v[168:169], v[168:169], s[68:69]
s_waitcnt lgkmcnt(6)
MA 208,16,76
v_pk_mul_f32 v[170:171], v[170:171], s[68:69]
v_pk_mul_f32 v[180:181], v[180:181], s[68:69]
v_pk_mul_f32 v[182:183], v[182:183], s[68:69]
MA 212,16,80
v_cvt_pk_bf16_f32 v144, v168, v169
v_cvt_pk_bf16_f32 v145, v170, v171
v_cvt_pk_bf16_f32 v146, v180, v181
MA 216,16,84
v_cvt_pk_bf16_f32 v147, v182, v183
v_permlane32_swap_b32 v112, v114
v_permlane32_swap_b32 v113, v115
s_waitcnt lgkmcnt(4)
MA 220,20,76
v_permlane32_swap_b32 v128, v130
v_permlane32_swap_b32 v129, v131
v_permlane32_swap_b32 v144, v146
MA 224,20,80
v_permlane32_swap_b32 v145, v147
v_permlane16_swap_b32 v112, v114
v_permlane16_swap_b32 v113, v115
MA 228,20,84
v_permlane16_swap_b32 v128, v130
v_permlane16_swap_b32 v129, v131
v_permlane16_swap_b32 v144, v146
s_waitcnt lgkmcnt(2)
MA 232,24,76
v_permlane16_swap_b32 v145, v147
v_pk_mul_f32 v[184:185], v[184:185], s[68:69]
v_pk_mul_f32 v[186:187], v[186:187], s[68:69]
MA 236,24,80
v_pk_mul_f32 v[196:197], v[196:197], s[68:69]
v_pk_mul_f32 v[198:199], v[198:199], s[68:69]
v_cvt_pk_bf16_f32 v116, v184, v185
MA 240,24,84
v_cvt_pk_bf16_f32 v117, v186, v187
v_cvt_pk_bf16_f32 v118, v196, v197
v_cvt_pk_bf16_f32 v119, v198, v199
s_waitcnt lgkmcnt(0)
MA 244,28,76
v_pk_mul_f32 v[188:189], v[188:189], s[68:69]
v_pk_mul_f32 v[190:191], v[190:191], s[68:69]
v_pk_mul_f32 v[200:201], v[200:201], s[68:69]
MA 248,28,80
v_pk_mul_f32 v[202:203], v[202:203], s[68:69]
v_cvt_pk_bf16_f32 v132, v188, v189
v_cvt_pk_bf16_f32 v133, v190, v191
MA 252,28,84
v_cvt_pk_bf16_f32 v134, v200, v201
v_cvt_pk_bf16_f32 v135, v202, v203
v_pk_mul_f32 v[192:193], v[192:193], s[68:69]
v_pk_mul_f32 v[194:195], v[194:195], s[68:69]
v_pk_mul_f32 v[204:205], v[204:205], s[68:69]
v_pk_mul_f32 v[206:207], v[206:207], s[68:69]
v_cvt_pk_bf16_f32 v148, v192, v193
v_cvt_pk_bf16_f32 v149, v194, v195
v_cvt_pk_bf16_f32 v150, v204, v205
v_cvt_pk_bf16_f32 v151, v206, v207
v_permlane32_swap_b32 v116, v118
v_permlane32_swap_b32 v117, v119
v_permlane32_swap_b32 v132, v134
v_permlane32_swap_b32 v133, v135
v_permlane32_swap_b32 v148, v150
v_permlane32_swap_b32 v149, v151
v_permlane16_swap_b32 v116, v118
v_permlane16_swap_b32 v117, v119
v_permlane16_swap_b32 v132, v134
v_permlane16_swap_b32 v133, v135
v_permlane16_swap_b32 v148, v150
v_permlane16_swap_b32 v149, v151
v_pk_mul_f32 v[208:209], v[208:209], s[68:69]
v_pk_mul_f32 v[210:211], v[210:211], s[68:69]
v_pk_mul_f32 v[220:221], v[220:221], s[68:69]
v_pk_mul_f32 v[222:223], v[222:223], s[68:69]
v_cvt_pk_bf16_f32 v120, v208, v209
v_cvt_pk_bf16_f32 v121, v210, v211
v_cvt_pk_bf16_f32 v122, v220, v221
v_cvt_pk_bf16_f32 v123, v222, v223
v_pk_mul_f32 v[212:213], v[212:213], s[68:69]
v_pk_mul_f32 v[214:215], v[214:215], s[68:69]
v_pk_mul_f32 v[224:225], v[224:225], s[68:69]
v_pk_mul_f32 v[226:227], v[226:227], s[68:69]
v_cvt_pk_bf16_f32 v136, v212, v213
v_cvt_pk_bf16_f32 v137, v214, v215
v_cvt_pk_bf16_f32 v138, v224, v225
v_cvt_pk_bf16_f32 v139, v226, v227
v_pk_mul_f32 v[216:217], v[216:217], s[68:69]
v_pk_mul_f32 v[218:219], v[218:219], s[68:69]
v_pk_mul_f32 v[228:229], v[228:229], s[68:69]
v_pk_mul_f32 v[230:231], v[230:231], s[68:69]
v_cvt_pk_bf16_f32 v152, v216, v217
v_cvt_pk_bf16_f32 v153, v218, v219
v_cvt_pk_bf16_f32 v154, v228, v229
v_cvt_pk_bf16_f32 v155, v230, v231
v_permlane32_swap_b32 v120, v122
v_permlane32_swap_b32 v121, v123
v_permlane32_swap_b32 v136, v138
v_permlane32_swap_b32 v137, v139
v_permlane32_swap_b32 v152, v154
v_permlane32_swap_b32 v153, v155
v_permlane16_swap_b32 v120, v122
v_permlane16_swap_b32 v121, v123
v_permlane16_swap_b32 v136, v138
v_permlane16_swap_b32 v137, v139
v_permlane16_swap_b32 v152, v154
v_permlane16_swap_b32 v153, v155
v_pk_mul_f32 v[232:233], v[232:233], s[68:69]
v_pk_mul_f32 v[234:235], v[234:235], s[68:69]
v_pk_mul_f32 v[244:245], v[244:245], s[68:69]
v_pk_mul_f32 v[246:247], v[246:247], s[68:69]
v_cvt_pk_bf16_f32 v124, v232, v233
v_cvt_pk_bf16_f32 v125, v234, v235
v_cvt_pk_bf16_f32 v126, v244, v245
v_cvt_pk_bf16_f32 v127, v246, v247
v_pk_mul_f32 v[236:237], v[236:237], s[68:69]
v_pk_mul_f32 v[238:239], v[238:239], s[68:69]
v_pk_mul_f32 v[248:249], v[248:249], s[68:69]
v_pk_mul_f32 v[250:251], v[250:251], s[68:69]
v_cvt_pk_bf16_f32 v140, v236, v237
v_cvt_pk_bf16_f32 v141, v238, v239
v_cvt_pk_bf16_f32 v142, v248, v249
v_cvt_pk_bf16_f32 v143, v250, v251
v_pk_mul_f32 v[240:241], v[240:241], s[68:69]
v_pk_mul_f32 v[242:243], v[242:243], s[68:69]
v_pk_mul_f32 v[252:253], v[252:253], s[68:69]
v_pk_mul_f32 v[254:255], v[254:255], s[68:69]
v_cvt_pk_bf16_f32 v156, v240, v241
v_cvt_pk_bf16_f32 v157, v242, v243
v_cvt_pk_bf16_f32 v158, v252, v253
v_cvt_pk_bf16_f32 v159, v254, v255
v_permlane32_swap_b32 v124, v126
v_permlane32_swap_b32 v125, v127
v_permlane32_swap_b32 v140, v142
v_permlane32_swap_b32 v141, v143
v_permlane32_swap_b32 v156, v158
v_permlane32_swap_b32 v157, v159
v_permlane16_swap_b32 v124, v126
v_permlane16_swap_b32 v125, v127
v_permlane16_swap_b32 v140, v142
v_permlane16_swap_b32 v141, v143
v_permlane16_swap_b32 v156, v158
v_permlane16_swap_b32 v157, v159
v_mov_b32 v53, 0xff800000
v_mov_b32 v57, 0xff800000
v_mov_b32 v61, 0xff800000
s_mov_b32 s70, 0
L_fb_loop:
s_waitcnt vmcnt(0) lgkmcnt(0)
s_barrier
s_add_u32 m0, s61, 0
s_add_u32 s66, s70, 0
s_add_u32 s66, s66, s95
buffer_load_dwordx4 v3, s[48:51], s66 offen lds
s_add_u32 m0, s61, 4096
s_add_u32 s66, s70, 4096
s_add_u32 s66, s66, s95
buffer_load_dwordx4 v3, s[48:51], s66 offen lds
s_waitcnt vmcnt(0) lgkmcnt(0)
s_barrier
ds_read_b128 v[160:163], v4 offset:0
ds_read_b128 v[164:167], v5 offset:0
ds_read_b128 v[168:171], v6 offset:0
ds_read_b128 v[172:175], v7 offset:0
ds_read_b128 v[176:179], v4 offset:4096
ds_read_b128 v[180:183], v5 offset:4096
ds_read_b128 v[184:187], v6 offset:4096
ds_read_b128 v[188:191], v7 offset:4096
s_waitcnt lgkmcnt(7)
MZ 64,160,112
MZ 68,160,128
MZ 72,160,144
s_waitcnt lgkmcnt(6)
MA 64,164,116
MA 68,164,132
MA 72,164,148
s_waitcnt lgkmcnt(5)
MA 64,168,120
MA 68,168,136
MA 72,168,152
s_waitcnt lgkmcnt(4)
MA 64,172,124
MA 68,172,140
MA 72,172,156
s_waitcnt lgkmcnt(3)
MZ 76,176,112
MZ 80,176,128
MZ 84,176,144
s_waitcnt lgkmcnt(2)
MA 76,180,116
MA 80,180,132
MA 84,180,148
s_waitcnt lgkmcnt(1)
MA 76,184,120
MA 80,184,136
MA 84,184,152
s_waitcnt lgkmcnt(0)
MA 76,188,124
MA 80,188,140
MA 84,188,156
v_max3_f32 v53, v53, v64, v65
v_max3_f32 v53, v53, v66, v67
s_nop 3
v_max3_f32 v53, v53, v76, v77
v_max3_f32 v53, v53, v78, v79
v_max3_f32 v57, v57, v68, v69
v_max3_f32 v57, v57, v70, v71
v_max3_f32 v57, v57, v80, v81
v_max3_f32 v57, v57, v82, v83
v_max3_f32 v61, v61, v72, v73
v_max3_f32 v61, v61, v74, v75
v_max3_f32 v61, v61, v84, v85
v_max3_f32 v61, v61, v86, v87
s_nop 7
s_add_u32 s70, s70, 8192
s_cmp_lt_u32 s70, 131072
s_cbranch_scc1 L_fb_loop
v_mov_b32 v54, v53
s_nop 1
v_permlane32_swap_b32 v53, v54
v_max_f32 v53, v53, v54
v_mov_b32 v54, v53
s_nop 1
v_permlane16_swap_b32 v53, v54
v_max_f32 v53, v53, v54
v_mov_b32 v58, v57
s_nop 1
v_permlane32_swap_b32 v57, v58
v_max_f32 v57, v57, v58
v_mov_b32 v58, v57
s_nop 1
v_permlane16_swap_b32 v57, v58
v_max_f32 v57, v57, v58
v_mov_b32 v62, v61
s_nop 1
v_permlane32_swap_b32 v61, v62
v_max_f32 v61, v61, v62
v_mov_b32 v62, v61
s_nop 1
v_permlane16_swap_b32 v61, v62
v_max_f32 v61, v61, v62
v_sub_f32 v52, 0, v53
v_mov_b32 v53, v52
v_mov_b32 v54, v52
v_mov_b32 v55, v52
v_sub_f32 v56, 0, v57
v_mov_b32 v57, v56
v_mov_b32 v58, v56
v_mov_b32 v59, v56
v_sub_f32 v60, 0, v61
v_mov_b32 v61, v60
v_mov_b32 v62, v60
v_mov_b32 v63, v60
s_waitcnt vmcnt(0) lgkmcnt(0)
s_barrier
s_add_u32 m0, s61, 0
s_add_u32 s66, s95, 0
buffer_load_dwordx4 v3, s[48:51], s66 offen nt lds
s_add_u32 m0, s61, 4096
s_add_u32 s66, s95, 4096
buffer_load_dwordx4 v3, s[48:51], s66 offen nt lds
s_add_u32 m0, s61, 8192
s_add_u32 s66, s95, 8192
buffer_load_dwordx4 v3, s[48:51], s66 offen nt lds
s_add_u32 m0, s61, 12288
s_add_u32 s66, s95, 12288
buffer_load_dwordx4 v3, s[48:51], s66 offen nt lds
s_add_u32 m0, s61, 40960
s_add_u32 s66, s95, 0
buffer_load_dwordx4 v2, s[52:55], s66 offen nt lds
s_add_u32 m0, s61, 45056
s_add_u32 s66, s95, 4096
buffer_load_dwordx4 v2, s[52:55], s66 offen nt lds
s_add_u32 m0, s61, 16384
s_add_u32 s66, s95, 16384
buffer_load_dwordx4 v3, s[48:51], s66 offen nt lds
s_add_u32 m0, s61, 20480
s_add_u32 s66, s95, 20480
buffer_load_dwordx4 v3, s[48:51], s66 offen nt lds
s_add_u32 m0, s61, 49152
s_add_u32 s66, s95, 8192
buffer_load_dwordx4 v2, s[52:55], s66 offen nt lds
s_add_u32 m0, s61, 53248
s_add_u32 s66, s95, 12288
buffer_load_dwordx4 v2, s[52:55], s66 offen nt lds
s_waitcnt vmcnt(4)
s_barrier
ds_read_b128 v[16:19], v4 offset:0
s_waitcnt lgkmcnt(0)
MC 64,16,112,52
ds_read_b128 v[20:23], v5 offset:0
ds_read_b128 v[24:27], v6 offset:0
MC 68,16,128,56
ds_read_b128 v[28:31], v7 offset:0
ds_read_b128 v[32:35], v4 offset:4096
MC 72,16,144,60
ds_read_b128 v[16:19], v5 offset:4096
s_waitcnt lgkmcnt(4)
MA 64,20,116
MA 68,20,132
MA 72,20,148
ds_read_b128 v[20:23], v6 offset:4096
s_waitcnt lgkmcnt(4)
MA 64,24,120
MA 68,24,136
MA 72,24,152
ds_read_b128 v[24:27], v7 offset:4096
s_waitcnt lgkmcnt(4)
MA 64,28,124
MA 68,28,140
MA 72,28,156
s_add_u32 m0, s61, 24576
s_add_u32 s66, s95, 24576
buffer_load_dwordx4 v3, s[48:51], s66 offen nt lds
ds_read_b128 v[28:31], v4 offset:8192
s_waitcnt lgkmcnt(4)
MC 76,32,112,52
MC 80,32,128,56
MC 84,32,144,60
ds_read_b128 v[32:35], v5 offset:8192
s_waitcnt lgkmcnt(4)
MA 76,16,116
v_exp_f32 v64, v64
MA 80,16,132
v_exp_f32 v65, v65
MA 84,16,148
ds_read_b128 v[16:19], v6 offset:8192
v_cvt_pk_bf16_f32 v64, v64, v65
v_exp_f32 v66, v66
s_waitcnt lgkmcnt(4)
MA 76,20,120
v_exp_f32 v67, v67
MA 80,20,136
v_cvt_pk_bf16_f32 v65, v66, v67
MA 84,20,152
ds_read_b128 v[20:23], v7 offset:8192
s_waitcnt lgkmcnt(4)
MA 76,24,124
MA 80,24,140
MA 84,24,156
s_add_u32 m0, s61, 28672
s_add_u32 s66, s95, 28672
buffer_load_dwordx4 v3, s[48:51], s66 offen nt lds
ds_read_b128 v[24:27], v4 offset:12288
s_waitcnt lgkmcnt(4)
MC 88,28,112,52
MC 92,28,128,56
MC 96,28,144,60
ds_read_b128 v[28:31], v5 offset:12288
s_waitcnt lgkmcnt(4)
MA 88,32,116
v_exp_f32 v76, v76
MA 92,32,132
v_exp_f32 v77, v77
MA 96,32,148
ds_read_b128 v[32:35], v6 offset:12288
v_cvt_pk_bf16_f32 v66, v76, v77
v_exp_f32 v78, v78
s_waitcnt lgkmcnt(4)
MA 88,16,120
v_exp_f32 v79, v79
MA 92,16,136
v_cvt_pk_bf16_f32 v67, v78, v79
MA 96,16,152
ds_read_b128 v[16:19], v7 offset:12288
v_exp_f32 v68, v68
s_waitcnt lgkmcnt(4)
MA 88,20,124
v_exp_f32 v69, v69
MA 92,20,140
v_cvt_pk_bf16_f32 v68, v68, v69
v_exp_f32 v70, v70
MA 96,20,156
s_add_u32 m0, s61, 57344
s_add_u32 s66, s95, 16384
buffer_load_dwordx4 v2, s[52:55], s66 offen nt lds
TR 20,8,0
v_exp_f32 v71, v71
TR 22,8,4096
s_waitcnt lgkmcnt(5)
MC 100,24,112,52
v_cvt_pk_bf16_f32 v69, v70, v71
MC 104,24,128,56
v_exp_f32 v80, v80
MC 108,24,144,60
TR 24,9,0
v_exp_f32 v81, v81
TR 26,9,4096
s_waitcnt lgkmcnt(6)
MA 100,28,116
v_cvt_pk_bf16_f32 v70, v80, v81
v_exp_f32 v82, v82
MA 104,28,132
v_exp_f32 v83, v83
MA 108,28,148
TR 28,10,0
v_cvt_pk_bf16_f32 v71, v82, v83
TR 30,10,4096
s_waitcnt lgkmcnt(7)
MA 100,32,120
v_exp_f32 v72, v72
MA 104,32,136
v_exp_f32 v73, v73
MA 108,32,152
TR 32,11,0
v_cvt_pk_bf16_f32 v72, v72, v73
TR 34,11,4096
v_exp_f32 v74, v74
s_waitcnt lgkmcnt(8)
MA 100,16,124
v_exp_f32 v75, v75
MA 104,16,140
v_cvt_pk_bf16_f32 v73, v74, v75
MA 108,16,156
s_add_u32 m0, s61, 61440
s_add_u32 s66, s95, 20480
buffer_load_dwordx4 v2, s[52:55], s66 offen nt lds
TR 16,12,0
v_exp_f32 v84, v84
TR 18,12,4096
v_exp_f32 v85, v85
s_nop 0
v_cvt_pk_bf16_f32 v74, v84, v85
v_exp_f32 v86, v86
v_exp_f32 v87, v87
s_nop 0
v_cvt_pk_bf16_f32 v75, v86, v87
s_waitcnt vmcnt(4)
s_barrier
MZ 40,36,64
v_exp_f32 v88, v88
MZ 44,36,68
v_exp_f32 v89, v89
MZ 48,36,72
v_cvt_pk_bf16_f32 v88, v88, v89
v_exp_f32 v90, v90
s_waitcnt lgkmcnt(8)
MZ 160,20,64
v_exp_f32 v91, v91
MZ 164,20,68
v_cvt_pk_bf16_f32 v89, v90, v91
MZ 168,20,72
TR 20,13,0
v_exp_f32 v100, v100
TR 22,13,4096
s_waitcnt lgkmcnt(8)
MZ 172,24,64
v_exp_f32 v101, v101
MZ 176,24,68
v_cvt_pk_bf16_f32 v90, v100, v101
v_exp_f32 v102, v102
MZ 180,24,72
TR 24,14,0
v_exp_f32 v103, v103
TR 26,14,4096
s_waitcnt lgkmcnt(8)
MZ 184,28,64
v_cvt_pk_bf16_f32 v91, v102, v103
MZ 188,28,68
v_exp_f32 v92, v92
MZ 192,28,72
s_add_u32 m0, s61, 32768
s_add_u32 s66, s95, 32768
buffer_load_dwordx4 v3, s[48:51], s66 offen nt lds
TR 28,15,0
v_exp_f32 v93, v93
TR 30,15,4096
s_waitcnt lgkmcnt(8)
MZ 196,32,64
v_cvt_pk_bf16_f32 v92, v92, v93
v_exp_f32 v94, v94
MZ 200,32,68
v_exp_f32 v95, v95
MZ 204,32,72
ds_read_b128 v[32:35], v4 offset:16384
v_cvt_pk_bf16_f32 v93, v94, v95
s_waitcnt lgkmcnt(7)
MZ 208,16,64
v_exp_f32 v104, v104
MZ 212,16,68
v_exp_f32 v105, v105
MZ 216,16,72
ds_read_b128 v[16:19], v5 offset:16384
v_cvt_pk_bf16_f32 v94, v104, v105
v_exp_f32 v106, v106
s_waitcnt lgkmcnt(6)
MZ 220,20,64
v_exp_f32 v107, v107
MZ 224,20,68
v_cvt_pk_bf16_f32 v95, v106, v107
MZ 228,20,72
ds_read_b128 v[20:23], v6 offset:16384
v_exp_f32 v96, v96
s_waitcnt lgkmcnt(5)
MZ 232,24,64
v_exp_f32 v97, v97
MZ 236,24,68
v_cvt_pk_bf16_f32 v96, v96, v97
v_exp_f32 v98, v98
MZ 240,24,72
s_add_u32 m0, s61, 36864
s_add_u32 s66, s95, 36864
buffer_load_dwordx4 v3, s[48:51], s66 offen nt lds
ds_read_b128 v[24:27], v7 offset:16384
v_exp_f32 v99, v99
s_waitcnt lgkmcnt(4)
MZ 244,28,64
v_cvt_pk_bf16_f32 v97, v98, v99
MZ 248,28,68
v_exp_f32 v108, v108
MZ 252,28,72
ds_read_b128 v[28:31], v4 offset:20480
v_exp_f32 v109, v109
s_waitcnt lgkmcnt(4)
MC 64,32,112,52
v_cvt_pk_bf16_f32 v98, v108, v109
v_exp_f32 v110, v110
MC 68,32,128,56
v_exp_f32 v111, v111
MC 72,32,144,60
ds_read_b128 v[32:35], v5 offset:20480
v_cvt_pk_bf16_f32 v99, v110, v111
s_waitcnt lgkmcnt(4)
MA 64,16,116
MA 68,16,132
MA 72,16,148
ds_read_b128 v[16:19], v6 offset:20480
s_waitcnt lgkmcnt(4)
MA 64,20,120
MA 68,20,136
MA 72,20,152
s_add_u32 m0, s61, 65536
s_add_u32 s66, s95, 24576
buffer_load_dwordx4 v2, s[52:55], s66 offen nt lds
ds_read_b128 v[20:23], v7 offset:20480
s_waitcnt lgkmcnt(4)
MA 64,24,124
MA 68,24,140
MA 72,24,156
TR 24,8,8192
TR 26,8,12288
s_waitcnt lgkmcnt(5)
MC 76,28,112,52
MC 80,28,128,56
MC 84,28,144,60
TR 28,9,8192
v_exp_f32 v64, v64
TR 30,9,12288
s_waitcnt lgkmcnt(6)
MA 76,32,116
v_exp_f32 v65, v65
MA 80,32,132
v_cvt_pk_bf16_f32 v64, v64, v65
v_exp_f32 v66, v66
MA 84,32,148
TR 32,10,8192
v_exp_f32 v67, v67
TR 34,10,12288
s_waitcnt lgkmcnt(7)
MA 76,16,120
v_cvt_pk_bf16_f32 v65, v66, v67
MA 80,16,136
MA 84,16,152
s_add_u32 m0, s61, 69632
s_add_u32 s66, s95, 28672
buffer_load_dwordx4 v2, s[52:55], s66 offen nt lds
TR 16,11,8192
TR 18,11,12288
s_waitcnt lgkmcnt(8)
MA 76,20,124
MA 80,20,140
MA 84,20,156
TR 20,12,8192
TR 22,12,12288
s_waitcnt vmcnt(4)
s_barrier
MA 40,36,88
MA 44,36,92
MA 48,36,96
v_exp_f32 v76, v76
s_waitcnt lgkmcnt(8)
MA 160,24,88
v_exp_f32 v77, v77
MA 164,24,92
v_cvt_pk_bf16_f32 v66, v76, v77
v_exp_f32 v78, v78
MA 168,24,96
TR 24,13,8192
v_exp_f32 v79, v79
TR 26,13,12288
s_waitcnt lgkmcnt(8)
MA 172,28,88
v_cvt_pk_bf16_f32 v67, v78, v79
MA 176,28,92
v_exp_f32 v68, v68
MA 180,28,96
TR 28,14,8192
v_exp_f32 v69, v69
TR 30,14,12288
s_waitcnt lgkmcnt(8)
MA 184,32,88
v_cvt_pk_bf16_f32 v68, v68, v69
v_exp_f32 v70, v70
MA 188,32,92
v_exp_f32 v71, v71
MA 192,32,96
s_add_u32 m0, s61, 0
s_add_u32 s66, s95, 40960
buffer_load_dwordx4 v3, s[48:51], s66 offen nt lds
TR 32,15,8192
v_cvt_pk_bf16_f32 v69, v70, v71
TR 34,15,12288
s_waitcnt lgkmcnt(8)
MA 196,16,88
v_exp_f32 v80, v80
MA 200,16,92
v_exp_f32 v81, v81
MA 204,16,96
ds_read_b128 v[16:19], v4 offset:24576
v_cvt_pk_bf16_f32 v70, v80, v81
v_exp_f32 v82, v82
s_waitcnt lgkmcnt(7)
MA 208,20,88
v_exp_f32 v83, v83
MA 212,20,92
v_cvt_pk_bf16_f32 v71, v82, v83
MA 216,20,96
ds_read_b128 v[20:23], v5 offset:24576
v_exp_f32 v72, v72
s_waitcnt lgkmcnt(6)
MA 220,24,88
v_exp_f32 v73, v73
MA 224,24,92
v_cvt_pk_bf16_f32 v72, v72, v73
v_exp_f32 v74, v74
MA 228,24,96
ds_read_b128 v[24:27], v6 offset:24576
v_exp_f32 v75, v75
s_waitcnt lgkmcnt(5)
MA 232,28,88
v_cvt_pk_bf16_f32 v73, v74, v75
MA 236,28,92
v_exp_f32 v84, v84
MA 240,28,96
s_add_u32 m0, s61, 4096
s_add_u32 s66, s95, 45056
buffer_load_dwordx4 v3, s[48:51], s66 offen nt lds
ds_read_b128 v[28:31], v7 offset:24576
v_exp_f32 v85, v85
s_waitcnt lgkmcnt(4)
MA 244,32,88
v_cvt_pk_bf16_f32 v74, v84, v85
v_exp_f32 v86, v86
MA 248,32,92
v_exp_f32 v87, v87
MA 252,32,96
ds_read_b128 v[32:35], v4 offset:28672
v_cvt_pk_bf16_f32 v75, v86, v87
s_waitcnt lgkmcnt(4)
MC 88,16,112,52
MC 92,16,128,56
MC 96,16,144,60
ds_read_b128 v[16:19], v5 offset:28672
s_waitcnt lgkmcnt(4)
MA 88,20,116
MA 92,20,132
MA 96,20,148
ds_read_b128 v[20:23], v6 offset:28672
s_waitcnt lgkmcnt(4)
MA 88,24,120
MA 92,24,136
MA 96,24,152
s_add_u32 m0, s61, 73728
s_add_u32 s66, s95, 32768
buffer_load_dwordx4 v2, s[52:55], s66 offen nt lds
ds_read_b128 v[24:27], v7 offset:28672
s_waitcnt lgkmcnt(4)
MA 88,28,124
MA 92,28,140
MA 96,28,156
TR 28,8,16384
TR 30,8,20480
s_waitcnt lgkmcnt(5)
MC 100,32,112,52
MC 104,32,128,56
MC 108,32,144,60
TR 32,9,16384
v_exp_f32 v88, v88
TR 34,9,20480
s_waitcnt lgkmcnt(6)
MA 100,16,116
v_exp_f32 v89, v89
MA 104,16,132
v_cvt_pk_bf16_f32 v88, v88, v89
v_exp_f32 v90, v90
MA 108,16,148
TR 16,10,16384
v_exp_f32 v91, v91
TR 18,10,20480
s_waitcnt lgkmcnt(7)
MA 100,20,120
v_cvt_pk_bf16_f32 v89, v90, v91
MA 104,20,136
MA 108,20,152
s_add_u32 m0, s61, 77824
s_add_u32 s66, s95, 36864
buffer_load_dwordx4 v2, s[52:55], s66 offen nt lds
TR 20,11,16384
TR 22,11,20480
s_waitcnt lgkmcnt(8)
MA 100,24,124
MA 104,24,140
MA 108,24,156
TR 24,12,16384
TR 26,12,20480
s_waitcnt vmcnt(4)
s_barrier
MA 40,36,64
MA 44,36,68
MA 48,36,72
v_exp_f32 v100, v100
s_waitcnt lgkmcnt(8)
MA 160,28,64
v_exp_f32 v101, v101
MA 164,28,68
v_cvt_pk_bf16_f32 v90, v100, v101
v_exp_f32 v102, v102
MA 168,28,72
TR 28,13,16384
v_exp_f32 v103, v103
TR 30,13,20480
s_waitcnt lgkmcnt(8)
MA 172,32,64
v_cvt_pk_bf16_f32 v91, v102, v103
MA 176,32,68
v_exp_f32 v92, v92
MA 180,32,72
TR 32,14,16384
v_exp_f32 v93, v93
TR 34,14,20480
s_waitcnt lgkmcnt(8)
MA 184,16,64
v_cvt_pk_bf16_f32 v92, v92, v93
v_exp_f32 v94, v94
MA 188,16,68
v_exp_f32 v95, v95
MA 192,16,72
s_add_u32 m0, s61, 8192
s_add_u32 s66, s95, 49152
buffer_load_dwordx4 v3, s[48:51], s66 offen nt lds
TR 16,15,16384
v_cvt_pk_bf16_f32 v93, v94, v95
TR 18,15,20480
s_waitcnt lgkmcnt(8)
MA 196,20,64
v_exp_f32 v104, v104
MA 200,20,68
v_exp_f32 v105, v105
MA 204,20,72
ds_read_b128 v[20:23], v4 offset:32768
v_cvt_pk_bf16_f32 v94, v104, v105
v_exp_f32 v106, v106
s_waitcnt lgkmcnt(7)
MA 208,24,64
v_exp_f32 v107, v107
MA 212,24,68
v_cvt_pk_bf16_f32 v95, v106, v107
MA 216,24,72
ds_read_b128 v[24:27], v5 offset:32768
v_exp_f32 v96, v96
s_waitcnt lgkmcnt(6)
MA 220,28,64
v_exp_f32 v97, v97
MA 224,28,68
v_cvt_pk_bf16_f32 v96, v96, v97
v_exp_f32 v98, v98
MA 228,28,72
ds_read_b128 v[28:31], v6 offset:32768
v_exp_f32 v99, v99
s_waitcnt lgkmcnt(5)
MA 232,32,64
v_cvt_pk_bf16_f32 v97, v98, v99
MA 236,32,68
v_exp_f32 v108, v108
MA 240,32,72
s_add_u32 m0, s61, 12288
s_add_u32 s66, s95, 53248
buffer_load_dwordx4 v3, s[48:51], s66 offen nt lds
ds_read_b128 v[32:35], v7 offset:32768
v_exp_f32 v109, v109
s_waitcnt lgkmcnt(4)
MA 244,16,64
v_cvt_pk_bf16_f32 v98, v108, v109
v_exp_f32 v110, v110
MA 248,16,68
v_exp_f32 v111, v111
MA 252,16,72
ds_read_b128 v[16:19], v4 offset:36864
v_cvt_pk_bf16_f32 v99, v110, v111
s_waitcnt lgkmcnt(4)
MC 64,20,112,52
MC 68,20,128,56
MC 72,20,144,60
ds_read_b128 v[20:23], v5 offset:36864
s_waitcnt lgkmcnt(4)
MA 64,24,116
MA 68,24,132
MA 72,24,148
ds_read_b128 v[24:27], v6 offset:36864
s_waitcnt lgkmcnt(4)
MA 64,28,120
MA 68,28,136
MA 72,28,152
s_add_u32 m0, s61, 40960
s_add_u32 s66, s95, 40960
buffer_load_dwordx4 v2, s[52:55], s66 offen nt lds
ds_read_b128 v[28:31], v7 offset:36864
s_waitcnt lgkmcnt(4)
MA 64,32,124
MA 68,32,140
MA 72,32,156
TR 32,8,24576
TR 34,8,28672
s_waitcnt lgkmcnt(5)
MC 76,16,112,52
MC 80,16,128,56
MC 84,16,144,60
TR 16,9,24576
v_exp_f32 v64, v64
TR 18,9,28672
s_waitcnt lgkmcnt(6)
MA 76,20,116
v_exp_f32 v65, v65
MA 80,20,132
v_cvt_pk_bf16_f32 v64, v64, v65
v_exp_f32 v66, v66
MA 84,20,148
TR 20,10,24576
v_exp_f32 v67, v67
TR 22,10,28672
s_waitcnt lgkmcnt(7)
MA 76,24,120
v_cvt_pk_bf16_f32 v65, v66, v67
MA 80,24,136
MA 84,24,152
s_add_u32 m0, s61, 45056
s_add_u32 s66, s95, 45056
buffer_load_dwordx4 v2, s[52:55], s66 offen nt lds
TR 24,11,24576
TR 26,11,28672
s_waitcnt lgkmcnt(8)
MA 76,28,124
MA 80,28,140
MA 84,28,156
TR 28,12,24576
TR 30,12,28672
s_waitcnt vmcnt(4)
s_barrier
MA 40,36,88
MA 44,36,92
MA 48,36,96
v_exp_f32 v76, v76
s_waitcnt lgkmcnt(8)
MA 160,32,88
v_exp_f32 v77, v77
MA 164,32,92
v_cvt_pk_bf16_f32 v66, v76, v77
v_exp_f32 v78, v78
MA 168,32,96
TR 32,13,24576
v_exp_f32 v79, v79
TR 34,13,28672
s_waitcnt lgkmcnt(8)
MA 172,16,88
v_cvt_pk_bf16_f32 v67, v78, v79
MA 176,16,92
v_exp_f32 v68, v68
MA 180,16,96
TR 16,14,24576
v_exp_f32 v69, v69
TR 18,14,28672
s_waitcnt lgkmcnt(8)
MA 184,20,88
v_cvt_pk_bf16_f32 v68, v68, v69
v_exp_f32 v70, v70
MA 188,20,92
v_exp_f32 v71, v71
MA 192,20,96
s_add_u32 m0, s61, 16384
s_add_u32 s66, s95, 57344
buffer_load_dwordx4 v3, s[48:51], s66 offen nt lds
TR 20,15,24576
v_cvt_pk_bf16_f32 v69, v70, v71
TR 22,15,28672
s_waitcnt lgkmcnt(8)
MA 196,24,88
v_exp_f32 v80, v80
MA 200,24,92
v_exp_f32 v81, v81
MA 204,24,96
ds_read_b128 v[24:27], v4 offset:0
v_cvt_pk_bf16_f32 v70, v80, v81
v_exp_f32 v82, v82
s_waitcnt lgkmcnt(7)
MA 208,28,88
v_exp_f32 v83, v83
MA 212,28,92
v_cvt_pk_bf16_f32 v71, v82, v83
MA 216,28,96
ds_read_b128 v[28:31], v5 offset:0
v_exp_f32 v72, v72
s_waitcnt lgkmcnt(6)
MA 220,32,88
v_exp_f32 v73, v73
MA 224,32,92
v_cvt_pk_bf16_f32 v72, v72, v73
v_exp_f32 v74, v74
MA 228,32,96
ds_read_b128 v[32:35], v6 offset:0
v_exp_f32 v75, v75
s_waitcnt lgkmcnt(5)
MA 232,16,88
v_cvt_pk_bf16_f32 v73, v74, v75
MA 236,16,92
v_exp_f32 v84, v84
MA 240,16,96
s_add_u32 m0, s61, 20480
s_add_u32 s66, s95, 61440
buffer_load_dwordx4 v3, s[48:51], s66 offen nt lds
ds_read_b128 v[16:19], v7 offset:0
v_exp_f32 v85, v85
s_waitcnt lgkmcnt(4)
MA 244,20,88
v_cvt_pk_bf16_f32 v74, v84, v85
v_exp_f32 v86, v86
MA 248,20,92
v_exp_f32 v87, v87
MA 252,20,96
ds_read_b128 v[20:23], v4 offset:4096
v_cvt_pk_bf16_f32 v75, v86, v87
s_waitcnt lgkmcnt(4)
MC 88,24,112,52
MC 92,24,128,56
MC 96,24,144,60
ds_read_b128 v[24:27], v5 offset:4096
s_waitcnt lgkmcnt(4)
MA 88,28,116
MA 92,28,132
MA 96,28,148
ds_read_b128 v[28:31], v6 offset:4096
s_waitcnt lgkmcnt(4)
MA 88,32,120
MA 92,32,136
MA 96,32,152
s_add_u32 m0, s61, 49152
s_add_u32 s66, s95, 49152
buffer_load_dwordx4 v2, s[52:55], s66 offen nt lds
ds_read_b128 v[32:35], v7 offset:4096
s_waitcnt lgkmcnt(4)
MA 88,16,124
MA 92,16,140
MA 96,16,156
TR 16,8,32768
TR 18,8,36864
s_waitcnt lgkmcnt(5)
MC 100,20,112,52
MC 104,20,128,56
MC 108,20,144,60
TR 20,9,32768
v_exp_f32 v88, v88
TR 22,9,36864
s_waitcnt lgkmcnt(6)
MA 100,24,116
v_exp_f32 v89, v89
MA 104,24,132
v_cvt_pk_bf16_f32 v88, v88, v89
v_exp_f32 v90, v90
MA 108,24,148
TR 24,10,32768
v_exp_f32 v91, v91
TR 26,10,36864
s_waitcnt lgkmcnt(7)
MA 100,28,120
v_cvt_pk_bf16_f32 v89, v90, v91
MA 104,28,136
MA 108,28,152
s_add_u32 m0, s61, 53248
s_add_u32 s66, s95, 53248
buffer_load_dwordx4 v2, s[52:55], s66 offen nt lds
TR 28,11,32768
TR 30,11,36864
s_waitcnt lgkmcnt(8)
MA 100,32,124
MA 104,32,140
MA 108,32,156
TR 32,12,32768
TR 34,12,36864
s_waitcnt vmcnt(4)
s_barrier
MA 40,36,64
MA 44,36,68
MA 48,36,72
v_exp_f32 v100, v100
s_waitcnt lgkmcnt(8)
MA 160,16,64
v_exp_f32 v101, v101
MA 164,16,68
v_cvt_pk_bf16_f32 v90, v100, v101
v_exp_f32 v102, v102
MA 168,16,72
TR 16,13,32768
v_exp_f32 v103, v103
TR 18,13,36864
s_waitcnt lgkmcnt(8)
MA 172,20,64
v_cvt_pk_bf16_f32 v91, v102, v103
MA 176,20,68
v_exp_f32 v92, v92
MA 180,20,72
TR 20,14,32768
v_exp_f32 v93, v93
TR 22,14,36864
s_waitcnt lgkmcnt(8)
MA 184,24,64
v_cvt_pk_bf16_f32 v92, v92, v93
v_exp_f32 v94, v94
MA 188,24,68
v_exp_f32 v95, v95
MA 192,24,72
s_add_u32 m0, s61, 24576
s_add_u32 s66, s95, 65536
buffer_load_dwordx4 v3, s[48:51], s66 offen nt lds
TR 24,15,32768
v_cvt_pk_bf16_f32 v93, v94, v95
TR 26,15,36864
s_waitcnt lgkmcnt(8)
MA 196,28,64
v_exp_f32 v104, v104
MA 200,28,68
v_exp_f32 v105, v105
MA 204,28,72
ds_read_b128 v[28:31], v4 offset:8192
v_cvt_pk_bf16_f32 v94, v104, v105
v_exp_f32 v106, v106
s_waitcnt lgkmcnt(7)
MA 208,32,64
v_exp_f32 v107, v107
MA 212,32,68
v_cvt_pk_bf16_f32 v95, v106, v107
MA 216,32,72
ds_read_b128 v[32:35], v5 offset:8192
v_exp_f32 v96, v96
s_waitcnt lgkmcnt(6)
MA 220,16,64
v_exp_f32 v97, v97
MA 224,16,68
v_cvt_pk_bf16_f32 v96, v96, v97
v_exp_f32 v98, v98
MA 228,16,72
ds_read_b128 v[16:19], v6 offset:8192
v_exp_f32 v99, v99
s_waitcnt lgkmcnt(5)
MA 232,20,64
v_cvt_pk_bf16_f32 v97, v98, v99
MA 236,20,68
v_exp_f32 v108, v108
MA 240,20,72
s_add_u32 m0, s61, 28672
s_add_u32 s66, s95, 69632
buffer_load_dwordx4 v3, s[48:51], s66 offen nt lds
ds_read_b128 v[20:23], v7 offset:8192
v_exp_f32 v109, v109
s_waitcnt lgkmcnt(4)
MA 244,24,64
v_cvt_pk_bf16_f32 v98, v108, v109
v_exp_f32 v110, v110
MA 248,24,68
v_exp_f32 v111, v111
MA 252,24,72
ds_read_b128 v[24:27], v4 offset:12288
v_cvt_pk_bf16_f32 v99, v110, v111
s_waitcnt lgkmcnt(4)
MC 64,28,112,52
MC 68,28,128,56
MC 72,28,144,60
ds_read_b128 v[28:31], v5 offset:12288
s_waitcnt lgkmcnt(4)
MA 64,32,116
MA 68,32,132
MA 72,32,148
ds_read_b128 v[32:35], v6 offset:12288
s_waitcnt lgkmcnt(4)
MA 64,16,120
MA 68,16,136
MA 72,16,152
s_add_u32 m0, s61, 57344
s_add_u32 s66, s95, 57344
buffer_load_dwordx4 v2, s[52:55], s66 offen nt lds
ds_read_b128 v[16:19], v7 offset:12288
s_waitcnt lgkmcnt(4)
MA 64,20,124
MA 68,20,140
MA 72,20,156
TR 20,8,0
TR 22,8,4096
s_waitcnt lgkmcnt(5)
MC 76,24,112,52
MC 80,24,128,56
MC 84,24,144,60
TR 24,9,0
v_exp_f32 v64, v64
TR 26,9,4096
s_waitcnt lgkmcnt(6)
MA 76,28,116
v_exp_f32 v65, v65
MA 80,28,132
v_cvt_pk_bf16_f32 v64, v64, v65
v_exp_f32 v66, v66
MA 84,28,148
TR 28,10,0
v_exp_f32 v67, v67
TR 30,10,4096
s_waitcnt lgkmcnt(7)
MA 76,32,120
v_cvt_pk_bf16_f32 v65, v66, v67
MA 80,32,136
MA 84,32,152
s_add_u32 m0, s61, 61440
s_add_u32 s66, s95, 61440
buffer_load_dwordx4 v2, s[52:55], s66 offen nt lds
TR 32,11,0
TR 34,11,4096
s_waitcnt lgkmcnt(8)
MA 76,16,124
MA 80,16,140
MA 84,16,156
TR 16,12,0
TR 18,12,4096
s_waitcnt vmcnt(4)
s_barrier
MA 40,36,88
MA 44,36,92
MA 48,36,96
v_exp_f32 v76, v76
s_waitcnt lgkmcnt(8)
MA 160,20,88
v_exp_f32 v77, v77
MA 164,20,92
v_cvt_pk_bf16_f32 v66, v76, v77
v_exp_f32 v78, v78
MA 168,20,96
TR 20,13,0
v_exp_f32 v79, v79
TR 22,13,4096
s_waitcnt lgkmcnt(8)
MA 172,24,88
v_cvt_pk_bf16_f32 v67, v78, v79
MA 176,24,92
v_exp_f32 v68, v68
MA 180,24,96
TR 24,14,0
v_exp_f32 v69, v69
TR 26,14,4096
s_waitcnt lgkmcnt(8)
MA 184,28,88
v_cvt_pk_bf16_f32 v68, v68, v69
v_exp_f32 v70, v70
MA 188,28,92
v_exp_f32 v71, v71
MA 192,28,96
s_add_u32 m0, s61, 32768
s_add_u32 s66, s95, 73728
buffer_load_dwordx4 v3, s[48:51], s66 offen nt lds
TR 28,15,0
v_cvt_pk_bf16_f32 v69, v70, v71
TR 30,15,4096
s_waitcnt lgkmcnt(8)
MA 196,32,88
v_exp_f32 v80, v80
MA 200,32,92
v_exp_f32 v81, v81
MA 204,32,96
ds_read_b128 v[32:35], v4 offset:16384
v_cvt_pk_bf16_f32 v70, v80, v81
v_exp_f32 v82, v82
s_waitcnt lgkmcnt(7)
MA 208,16,88
v_exp_f32 v83, v83
MA 212,16,92
v_cvt_pk_bf16_f32 v71, v82, v83
MA 216,16,96
ds_read_b128 v[16:19], v5 offset:16384
v_exp_f32 v72, v72
s_waitcnt lgkmcnt(6)
MA 220,20,88
v_exp_f32 v73, v73
MA 224,20,92
v_cvt_pk_bf16_f32 v72, v72, v73
v_exp_f32 v74, v74
MA 228,20,96
ds_read_b128 v[20:23], v6 offset:16384
v_exp_f32 v75, v75
s_waitcnt lgkmcnt(5)
MA 232,24,88
v_cvt_pk_bf16_f32 v73, v74, v75
MA 236,24,92
v_exp_f32 v84, v84
MA 240,24,96
s_add_u32 m0, s61, 36864
s_add_u32 s66, s95, 77824
buffer_load_dwordx4 v3, s[48:51], s66 offen nt lds
ds_read_b128 v[24:27], v7 offset:16384
v_exp_f32 v85, v85
s_waitcnt lgkmcnt(4)
MA 244,28,88
v_cvt_pk_bf16_f32 v74, v84, v85
v_exp_f32 v86, v86
MA 248,28,92
v_exp_f32 v87, v87
MA 252,28,96
ds_read_b128 v[28:31], v4 offset:20480
v_cvt_pk_bf16_f32 v75, v86, v87
s_waitcnt lgkmcnt(4)
MC 88,32,112,52
MC 92,32,128,56
MC 96,32,144,60
ds_read_b128 v[32:35], v5 offset:20480
s_waitcnt lgkmcnt(4)
MA 88,16,116
MA 92,16,132
MA 96,16,148
ds_read_b128 v[16:19], v6 offset:20480
s_waitcnt lgkmcnt(4)
MA 88,20,120
MA 92,20,136
MA 96,20,152
s_add_u32 m0, s61, 65536
s_add_u32 s66, s95, 65536
buffer_load_dwordx4 v2, s[52:55], s66 offen nt lds
ds_read_b128 v[20:23], v7 offset:20480
s_waitcnt lgkmcnt(4)
MA 88,24,124
MA 92,24,140
MA 96,24,156
TR 24,8,8192
TR 26,8,12288
s_waitcnt lgkmcnt(5)
MC 100,28,112,52
MC 104,28,128,56
MC 108,28,144,60
TR 28,9,8192
v_exp_f32 v88, v88
TR 30,9,12288
s_waitcnt lgkmcnt(6)
MA 100,32,116
v_exp_f32 v89, v89
MA 104,32,132
v_cvt_pk_bf16_f32 v88, v88, v89
v_exp_f32 v90, v90
MA 108,32,148
TR 32,10,8192
v_exp_f32 v91, v91
TR 34,10,12288
s_waitcnt lgkmcnt(7)
MA 100,16,120
v_cvt_pk_bf16_f32 v89, v90, v91
MA 104,16,136
MA 108,16,152
s_add_u32 m0, s61, 69632
s_add_u32 s66, s95, 69632
buffer_load_dwordx4 v2, s[52:55], s66 offen nt lds
TR 16,11,8192
TR 18,11,12288
s_waitcnt lgkmcnt(8)
MA 100,20,124
MA 104,20,140
MA 108,20,156
TR 20,12,8192
TR 22,12,12288
s_waitcnt vmcnt(4)
s_barrier
MA 40,36,64
MA 44,36,68
MA 48,36,72
v_exp_f32 v100, v100
s_waitcnt lgkmcnt(8)
MA 160,24,64
v_exp_f32 v101, v101
MA 164,24,68
v_cvt_pk_bf16_f32 v90, v100, v101
v_exp_f32 v102, v102
MA 168,24,72
TR 24,13,8192
v_exp_f32 v103, v103
TR 26,13,12288
s_waitcnt lgkmcnt(8)
MA 172,28,64
v_cvt_pk_bf16_f32 v91, v102, v103
MA 176,28,68
v_exp_f32 v92, v92
MA 180,28,72
TR 28,14,8192
v_exp_f32 v93, v93
TR 30,14,12288
s_waitcnt lgkmcnt(8)
MA 184,32,64
v_cvt_pk_bf16_f32 v92, v92, v93
v_exp_f32 v94, v94
MA 188,32,68
v_exp_f32 v95, v95
MA 192,32,72
s_add_u32 m0, s61, 0
s_add_u32 s66, s95, 81920
buffer_load_dwordx4 v3, s[48:51], s66 offen nt lds
TR 32,15,8192
v_cvt_pk_bf16_f32 v93, v94, v95
TR 34,15,12288
s_waitcnt lgkmcnt(8)
MA 196,16,64
v_exp_f32 v104, v104
MA 200,16,68
v_exp_f32 v105, v105
MA 204,16,72
ds_read_b128 v[16:19], v4 offset:24576
v_cvt_pk_bf16_f32 v94, v104, v105
v_exp_f32 v106, v106
s_waitcnt lgkmcnt(7)
MA 208,20,64
v_exp_f32 v107, v107
MA 212,20,68
v_cvt_pk_bf16_f32 v95, v106, v107
MA 216,20,72
ds_read_b128 v[20:23], v5 offset:24576
v_exp_f32 v96, v96
s_waitcnt lgkmcnt(6)
MA 220,24,64
v_exp_f32 v97, v97
MA 224,24,68
v_cvt_pk_bf16_f32 v96, v96, v97
v_exp_f32 v98, v98
MA 228,24,72
ds_read_b128 v[24:27], v6 offset:24576
v_exp_f32 v99, v99
s_waitcnt lgkmcnt(5)
MA 232,28,64
v_cvt_pk_bf16_f32 v97, v98, v99
MA 236,28,68
v_exp_f32 v108, v108
MA 240,28,72
s_add_u32 m0, s61, 4096
s_add_u32 s66, s95, 86016
buffer_load_dwordx4 v3, s[48:51], s66 offen nt lds
ds_read_b128 v[28:31], v7 offset:24576
v_exp_f32 v109, v109
s_waitcnt lgkmcnt(4)
MA 244,32,64
v_cvt_pk_bf16_f32 v98, v108, v109
v_exp_f32 v110, v110
MA 248,32,68
v_exp_f32 v111, v111
MA 252,32,72
ds_read_b128 v[32:35], v4 offset:28672
v_cvt_pk_bf16_f32 v99, v110, v111
s_waitcnt lgkmcnt(4)
MC 64,16,112,52
MC 68,16,128,56
MC 72,16,144,60
ds_read_b128 v[16:19], v5 offset:28672
s_waitcnt lgkmcnt(4)
MA 64,20,116
MA 68,20,132
MA 72,20,148
ds_read_b128 v[20:23], v6 offset:28672
s_waitcnt lgkmcnt(4)
MA 64,24,120
MA 68,24,136
MA 72,24,152
s_add_u32 m0, s61, 73728
s_add_u32 s66, s95, 73728
buffer_load_dwordx4 v2, s[52:55], s66 offen nt lds
ds_read_b128 v[24:27], v7 offset:28672
s_waitcnt lgkmcnt(4)
MA 64,28,124
MA 68,28,140
MA 72,28,156
TR 28,8,16384
TR 30,8,20480
s_waitcnt lgkmcnt(5)
MC 76,32,112,52
MC 80,32,128,56
MC 84,32,144,60
TR 32,9,16384
v_exp_f32 v64, v64
TR 34,9,20480
s_waitcnt lgkmcnt(6)
MA 76,16,116
v_exp_f32 v65, v65
MA 80,16,132
v_cvt_pk_bf16_f32 v64, v64, v65
v_exp_f32 v66, v66
MA 84,16,148
TR 16,10,16384
v_exp_f32 v67, v67
TR 18,10,20480
s_waitcnt lgkmcnt(7)
MA 76,20,120
v_cvt_pk_bf16_f32 v65, v66, v67
MA 80,20,136
MA 84,20,152
s_add_u32 m0, s61, 77824
s_add_u32 s66, s95, 77824
buffer_load_dwordx4 v2, s[52:55], s66 offen nt lds
TR 20,11,16384
TR 22,11,20480
s_waitcnt lgkmcnt(8)
MA 76,24,124
MA 80,24,140
MA 84,24,156
TR 24,12,16384
TR 26,12,20480
s_waitcnt vmcnt(4)
s_barrier
MA 40,36,88
MA 44,36,92
MA 48,36,96
v_exp_f32 v76, v76
s_waitcnt lgkmcnt(8)
MA 160,28,88
v_exp_f32 v77, v77
MA 164,28,92
v_cvt_pk_bf16_f32 v66, v76, v77
v_exp_f32 v78, v78
MA 168,28,96
TR 28,13,16384
v_exp_f32 v79, v79
TR 30,13,20480
s_waitcnt lgkmcnt(8)
MA 172,32,88
v_cvt_pk_bf16_f32 v67, v78, v79
MA 176,32,92
v_exp_f32 v68, v68
MA 180,32,96
TR 32,14,16384
v_exp_f32 v69, v69
TR 34,14,20480
s_waitcnt lgkmcnt(8)
MA 184,16,88
v_cvt_pk_bf16_f32 v68, v68, v69
v_exp_f32 v70, v70
MA 188,16,92
v_exp_f32 v71, v71
MA 192,16,96
s_add_u32 m0, s61, 8192
s_add_u32 s66, s95, 90112
buffer_load_dwordx4 v3, s[48:51], s66 offen nt lds
TR 16,15,16384
v_cvt_pk_bf16_f32 v69, v70, v71
TR 18,15,20480
s_waitcnt lgkmcnt(8)
MA 196,20,88
v_exp_f32 v80, v80
MA 200,20,92
v_exp_f32 v81, v81
MA 204,20,96
ds_read_b128 v[20:23], v4 offset:32768
v_cvt_pk_bf16_f32 v70, v80, v81
v_exp_f32 v82, v82
s_waitcnt lgkmcnt(7)
MA 208,24,88
v_exp_f32 v83, v83
MA 212,24,92
v_cvt_pk_bf16_f32 v71, v82, v83
MA 216,24,96
ds_read_b128 v[24:27], v5 offset:32768
v_exp_f32 v72, v72
s_waitcnt lgkmcnt(6)
MA 220,28,88
v_exp_f32 v73, v73
MA 224,28,92
v_cvt_pk_bf16_f32 v72, v72, v73
v_exp_f32 v74, v74
MA 228,28,96
ds_read_b128 v[28:31], v6 offset:32768
v_exp_f32 v75, v75
s_waitcnt lgkmcnt(5)
MA 232,32,88
v_cvt_pk_bf16_f32 v73, v74, v75
MA 236,32,92
v_exp_f32 v84, v84
MA 240,32,96
s_add_u32 m0, s61, 12288
s_add_u32 s66, s95, 94208
buffer_load_dwordx4 v3, s[48:51], s66 offen nt lds
ds_read_b128 v[32:35], v7 offset:32768
v_exp_f32 v85, v85
s_waitcnt lgkmcnt(4)
MA 244,16,88
v_cvt_pk_bf16_f32 v74, v84, v85
v_exp_f32 v86, v86
MA 248,16,92
v_exp_f32 v87, v87
MA 252,16,96
ds_read_b128 v[16:19], v4 offset:36864
v_cvt_pk_bf16_f32 v75, v86, v87
s_waitcnt lgkmcnt(4)
MC 88,20,112,52
MC 92,20,128,56
MC 96,20,144,60
ds_read_b128 v[20:23], v5 offset:36864
s_waitcnt lgkmcnt(4)
MA 88,24,116
MA 92,24,132
MA 96,24,148
ds_read_b128 v[24:27], v6 offset:36864
s_waitcnt lgkmcnt(4)
MA 88,28,120
MA 92,28,136
MA 96,28,152
s_add_u32 m0, s61, 40960
s_add_u32 s66, s95, 81920
buffer_load_dwordx4 v2, s[52:55], s66 offen nt lds
ds_read_b128 v[28:31], v7 offset:36864
s_waitcnt lgkmcnt(4)
MA 88,32,124
MA 92,32,140
MA 96,32,156
TR 32,8,24576
TR 34,8,28672
s_waitcnt lgkmcnt(5)
MC 100,16,112,52
MC 104,16,128,56
MC 108,16,144,60
TR 16,9,24576
v_exp_f32 v88, v88
TR 18,9,28672
s_waitcnt lgkmcnt(6)
MA 100,20,116
v_exp_f32 v89, v89
MA 104,20,132
v_cvt_pk_bf16_f32 v88, v88, v89
v_exp_f32 v90, v90
MA 108,20,148
TR 20,10,24576
v_exp_f32 v91, v91
TR 22,10,28672
s_waitcnt lgkmcnt(7)
MA 100,24,120
v_cvt_pk_bf16_f32 v89, v90, v91
MA 104,24,136
MA 108,24,152
s_add_u32 m0, s61, 45056
s_add_u32 s66, s95, 86016
buffer_load_dwordx4 v2, s[52:55], s66 offen nt lds
TR 24,11,24576
TR 26,11,28672
s_waitcnt lgkmcnt(8)
MA 100,28,124
MA 104,28,140
MA 108,28,156
TR 28,12,24576
TR 30,12,28672
s_waitcnt vmcnt(4)
s_barrier
MA 40,36,64
MA 44,36,68
MA 48,36,72
v_exp_f32 v100, v100
s_waitcnt lgkmcnt(8)
MA 160,32,64
v_exp_f32 v101, v101
MA 164,32,68
v_cvt_pk_bf16_f32 v90, v100, v101
v_exp_f32 v102, v102
MA 168,32,72
TR 32,13,24576
v_exp_f32 v103, v103
TR 34,13,28672
s_waitcnt lgkmcnt(8)
MA 172,16,64
v_cvt_pk_bf16_f32 v91, v102, v103
MA 176,16,68
v_exp_f32 v92, v92
MA 180,16,72
TR 16,14,24576
v_exp_f32 v93, v93
TR 18,14,28672
s_waitcnt lgkmcnt(8)
MA 184,20,64
v_cvt_pk_bf16_f32 v92, v92, v93
v_exp_f32 v94, v94
MA 188,20,68
v_exp_f32 v95, v95
MA 192,20,72
s_add_u32 m0, s61, 16384
s_add_u32 s66, s95, 98304
buffer_load_dwordx4 v3, s[48:51], s66 offen nt lds
TR 20,15,24576
v_cvt_pk_bf16_f32 v93, v94, v95
TR 22,15,28672
s_waitcnt lgkmcnt(8)
MA 196,24,64
v_exp_f32 v104, v104
MA 200,24,68
v_exp_f32 v105, v105
MA 204,24,72
ds_read_b128 v[24:27], v4 offset:0
v_cvt_pk_bf16_f32 v94, v104, v105
v_exp_f32 v106, v106
s_waitcnt lgkmcnt(7)
MA 208,28,64
v_exp_f32 v107, v107
MA 212,28,68
v_cvt_pk_bf16_f32 v95, v106, v107
MA 216,28,72
ds_read_b128 v[28:31], v5 offset:0
v_exp_f32 v96, v96
s_waitcnt lgkmcnt(6)
MA 220,32,64
v_exp_f32 v97, v97
MA 224,32,68
v_cvt_pk_bf16_f32 v96, v96, v97
v_exp_f32 v98, v98
MA 228,32,72
ds_read_b128 v[32:35], v6 offset:0
v_exp_f32 v99, v99
s_waitcnt lgkmcnt(5)
MA 232,16,64
v_cvt_pk_bf16_f32 v97, v98, v99
MA 236,16,68
v_exp_f32 v108, v108
MA 240,16,72
s_add_u32 m0, s61, 20480
s_add_u32 s66, s95, 102400
buffer_load_dwordx4 v3, s[48:51], s66 offen nt lds
ds_read_b128 v[16:19], v7 offset:0
v_exp_f32 v109, v109
s_waitcnt lgkmcnt(4)
MA 244,20,64
v_cvt_pk_bf16_f32 v98, v108, v109
v_exp_f32 v110, v110
MA 248,20,68
v_exp_f32 v111, v111
MA 252,20,72
ds_read_b128 v[20:23], v4 offset:4096
v_cvt_pk_bf16_f32 v99, v110, v111
s_waitcnt lgkmcnt(4)
MC 64,24,112,52
MC 68,24,128,56
MC 72,24,144,60
ds_read_b128 v[24:27], v5 offset:4096
s_waitcnt lgkmcnt(4)
MA 64,28,116
MA 68,28,132
MA 72,28,148
ds_read_b128 v[28:31], v6 offset:4096
s_waitcnt lgkmcnt(4)
MA 64,32,120
MA 68,32,136
MA 72,32,152
s_add_u32 m0, s61, 49152
s_add_u32 s66, s95, 90112
buffer_load_dwordx4 v2, s[52:55], s66 offen nt lds
ds_read_b128 v[32:35], v7 offset:4096
s_waitcnt lgkmcnt(4)
MA 64,16,124
MA 68,16,140
MA 72,16,156
TR 16,8,32768
TR 18,8,36864
s_waitcnt lgkmcnt(5)
MC 76,20,112,52
MC 80,20,128,56
MC 84,20,144,60
TR 20,9,32768
v_exp_f32 v64, v64
TR 22,9,36864
s_waitcnt lgkmcnt(6)
MA 76,24,116
v_exp_f32 v65, v65
MA 80,24,132
v_cvt_pk_bf16_f32 v64, v64, v65
v_exp_f32 v66, v66
MA 84,24,148
TR 24,10,32768
v_exp_f32 v67, v67
TR 26,10,36864
s_waitcnt lgkmcnt(7)
MA 76,28,120
v_cvt_pk_bf16_f32 v65, v66, v67
MA 80,28,136
MA 84,28,152
s_add_u32 m0, s61, 53248
s_add_u32 s66, s95, 94208
buffer_load_dwordx4 v2, s[52:55], s66 offen nt lds
TR 28,11,32768
TR 30,11,36864
s_waitcnt lgkmcnt(8)
MA 76,32,124
MA 80,32,140
MA 84,32,156
TR 32,12,32768
TR 34,12,36864
s_waitcnt vmcnt(4)
s_barrier
MA 40,36,88
MA 44,36,92
MA 48,36,96
v_exp_f32 v76, v76
s_waitcnt lgkmcnt(8)
MA 160,16,88
v_exp_f32 v77, v77
MA 164,16,92
v_cvt_pk_bf16_f32 v66, v76, v77
v_exp_f32 v78, v78
MA 168,16,96
TR 16,13,32768
v_exp_f32 v79, v79
TR 18,13,36864
s_waitcnt lgkmcnt(8)
MA 172,20,88
v_cvt_pk_bf16_f32 v67, v78, v79
MA 176,20,92
v_exp_f32 v68, v68
MA 180,20,96
TR 20,14,32768
v_exp_f32 v69, v69
TR 22,14,36864
s_waitcnt lgkmcnt(8)
MA 184,24,88
v_cvt_pk_bf16_f32 v68, v68, v69
v_exp_f32 v70, v70
MA 188,24,92
v_exp_f32 v71, v71
MA 192,24,96
s_add_u32 m0, s61, 24576
s_add_u32 s66, s95, 106496
buffer_load_dwordx4 v3, s[48:51], s66 offen nt lds
TR 24,15,32768
v_cvt_pk_bf16_f32 v69, v70, v71
TR 26,15,36864
s_waitcnt lgkmcnt(8)
MA 196,28,88
v_exp_f32 v80, v80
MA 200,28,92
v_exp_f32 v81, v81
MA 204,28,96
ds_read_b128 v[28:31], v4 offset:8192
v_cvt_pk_bf16_f32 v70, v80, v81
v_exp_f32 v82, v82
s_waitcnt lgkmcnt(7)
MA 208,32,88
v_exp_f32 v83, v83
MA 212,32,92
v_cvt_pk_bf16_f32 v71, v82, v83
MA 216,32,96
ds_read_b128 v[32:35], v5 offset:8192
v_exp_f32 v72, v72
s_waitcnt lgkmcnt(6)
MA 220,16,88
v_exp_f32 v73, v73
MA 224,16,92
v_cvt_pk_bf16_f32 v72, v72, v73
v_exp_f32 v74, v74
MA 228,16,96
ds_read_b128 v[16:19], v6 offset:8192
v_exp_f32 v75, v75
s_waitcnt lgkmcnt(5)
MA 232,20,88
v_cvt_pk_bf16_f32 v73, v74, v75
MA 236,20,92
v_exp_f32 v84, v84
MA 240,20,96
s_add_u32 m0, s61, 28672
s_add_u32 s66, s95, 110592
buffer_load_dwordx4 v3, s[48:51], s66 offen nt lds
ds_read_b128 v[20:23], v7 offset:8192
v_exp_f32 v85, v85
s_waitcnt lgkmcnt(4)
MA 244,24,88
v_cvt_pk_bf16_f32 v74, v84, v85
v_exp_f32 v86, v86
MA 248,24,92
v_exp_f32 v87, v87
MA 252,24,96
ds_read_b128 v[24:27], v4 offset:12288
v_cvt_pk_bf16_f32 v75, v86, v87
s_waitcnt lgkmcnt(4)
MC 88,28,112,52
MC 92,28,128,56
MC 96,28,144,60
ds_read_b128 v[28:31], v5 offset:12288
s_waitcnt lgkmcnt(4)
MA 88,32,116
MA 92,32,132
MA 96,32,148
ds_read_b128 v[32:35], v6 offset:12288
s_waitcnt lgkmcnt(4)
MA 88,16,120
MA 92,16,136
MA 96,16,152
s_add_u32 m0, s61, 57344
s_add_u32 s66, s95, 98304
buffer_load_dwordx4 v2, s[52:55], s66 offen nt lds
ds_read_b128 v[16:19], v7 offset:12288
s_waitcnt lgkmcnt(4)
MA 88,20,124
MA 92,20,140
MA 96,20,156
TR 20,8,0
TR 22,8,4096
s_waitcnt lgkmcnt(5)
MC 100,24,112,52
MC 104,24,128,56
MC 108,24,144,60
TR 24,9,0
v_exp_f32 v88, v88
TR 26,9,4096
s_waitcnt lgkmcnt(6)
MA 100,28,116
v_exp_f32 v89, v89
MA 104,28,132
v_cvt_pk_bf16_f32 v88, v88, v89
v_exp_f32 v90, v90
MA 108,28,148
TR 28,10,0
v_exp_f32 v91, v91
TR 30,10,4096
s_waitcnt lgkmcnt(7)
MA 100,32,120
v_cvt_pk_bf16_f32 v89, v90, v91
MA 104,32,136
MA 108,32,152
s_add_u32 m0, s61, 61440
s_add_u32 s66, s95, 102400
buffer_load_dwordx4 v2, s[52:55], s66 offen nt lds
TR 32,11,0
TR 34,11,4096
s_waitcnt lgkmcnt(8)
MA 100,16,124
MA 104,16,140
MA 108,16,156
TR 16,12,0
TR 18,12,4096
s_waitcnt vmcnt(4)
s_barrier
MA 40,36,64
MA 44,36,68
MA 48,36,72
v_exp_f32 v100, v100
s_waitcnt lgkmcnt(8)
MA 160,20,64
v_exp_f32 v101, v101
MA 164,20,68
v_cvt_pk_bf16_f32 v90, v100, v101
v_exp_f32 v102, v102
MA 168,20,72
TR 20,13,0
v_exp_f32 v103, v103
TR 22,13,4096
s_waitcnt lgkmcnt(8)
MA 172,24,64
v_cvt_pk_bf16_f32 v91, v102, v103
MA 176,24,68
v_exp_f32 v92, v92
MA 180,24,72
TR 24,14,0
v_exp_f32 v93, v93
TR 26,14,4096
s_waitcnt lgkmcnt(8)
MA 184,28,64
v_cvt_pk_bf16_f32 v92, v92, v93
v_exp_f32 v94, v94
MA 188,28,68
v_exp_f32 v95, v95
MA 192,28,72
s_add_u32 m0, s61, 32768
s_add_u32 s66, s95, 114688
buffer_load_dwordx4 v3, s[48:51], s66 offen nt lds
TR 28,15,0
v_cvt_pk_bf16_f32 v93, v94, v95
TR 30,15,4096
s_waitcnt lgkmcnt(8)
MA 196,32,64
v_exp_f32 v104, v104
MA 200,32,68
v_exp_f32 v105, v105
MA 204,32,72
ds_read_b128 v[32:35], v4 offset:16384
v_cvt_pk_bf16_f32 v94, v104, v105
v_exp_f32 v106, v106
s_waitcnt lgkmcnt(7)
MA 208,16,64
v_exp_f32 v107, v107
MA 212,16,68
v_cvt_pk_bf16_f32 v95, v106, v107
MA 216,16,72
ds_read_b128 v[16:19], v5 offset:16384
v_exp_f32 v96, v96
s_waitcnt lgkmcnt(6)
MA 220,20,64
v_exp_f32 v97, v97
MA 224,20,68
v_cvt_pk_bf16_f32 v96, v96, v97
v_exp_f32 v98, v98
MA 228,20,72
ds_read_b128 v[20:23], v6 offset:16384
v_exp_f32 v99, v99
s_waitcnt lgkmcnt(5)
MA 232,24,64
v_cvt_pk_bf16_f32 v97, v98, v99
MA 236,24,68
v_exp_f32 v108, v108
MA 240,24,72
s_add_u32 m0, s61, 36864
s_add_u32 s66, s95, 118784
buffer_load_dwordx4 v3, s[48:51], s66 offen nt lds
ds_read_b128 v[24:27], v7 offset:16384
v_exp_f32 v109, v109
s_waitcnt lgkmcnt(4)
MA 244,28,64
v_cvt_pk_bf16_f32 v98, v108, v109
v_exp_f32 v110, v110
MA 248,28,68
v_exp_f32 v111, v111
MA 252,28,72
ds_read_b128 v[28:31], v4 offset:20480
v_cvt_pk_bf16_f32 v99, v110, v111
s_waitcnt lgkmcnt(4)
MC 64,32,112,52
MC 68,32,128,56
MC 72,32,144,60
ds_read_b128 v[32:35], v5 offset:20480
s_waitcnt lgkmcnt(4)
MA 64,16,116
MA 68,16,132
MA 72,16,148
ds_read_b128 v[16:19], v6 offset:20480
s_waitcnt lgkmcnt(4)
MA 64,20,120
MA 68,20,136
MA 72,20,152
s_add_u32 m0, s61, 65536
s_add_u32 s66, s95, 106496
buffer_load_dwordx4 v2, s[52:55], s66 offen nt lds
ds_read_b128 v[20:23], v7 offset:20480
s_waitcnt lgkmcnt(4)
MA 64,24,124
MA 68,24,140
MA 72,24,156
TR 24,8,8192
TR 26,8,12288
s_waitcnt lgkmcnt(5)
MC 76,28,112,52
MC 80,28,128,56
MC 84,28,144,60
TR 28,9,8192
v_exp_f32 v64, v64
TR 30,9,12288
s_waitcnt lgkmcnt(6)
MA 76,32,116
v_exp_f32 v65, v65
MA 80,32,132
v_cvt_pk_bf16_f32 v64, v64, v65
v_exp_f32 v66, v66
MA 84,32,148
TR 32,10,8192
v_exp_f32 v67, v67
TR 34,10,12288
s_waitcnt lgkmcnt(7)
MA 76,16,120
v_cvt_pk_bf16_f32 v65, v66, v67
MA 80,16,136
MA 84,16,152
s_add_u32 m0, s61, 69632
s_add_u32 s66, s95, 110592
buffer_load_dwordx4 v2, s[52:55], s66 offen nt lds
TR 16,11,8192
TR 18,11,12288
s_waitcnt lgkmcnt(8)
MA 76,20,124
MA 80,20,140
MA 84,20,156
TR 20,12,8192
TR 22,12,12288
s_waitcnt vmcnt(4)
s_barrier
MA 40,36,88
MA 44,36,92
MA 48,36,96
v_exp_f32 v76, v76
s_waitcnt lgkmcnt(8)
MA 160,24,88
v_exp_f32 v77, v77
MA 164,24,92
v_cvt_pk_bf16_f32 v66, v76, v77
v_exp_f32 v78, v78
MA 168,24,96
TR 24,13,8192
v_exp_f32 v79, v79
TR 26,13,12288
s_waitcnt lgkmcnt(8)
MA 172,28,88
v_cvt_pk_bf16_f32 v67, v78, v79
MA 176,28,92
v_exp_f32 v68, v68
MA 180,28,96
TR 28,14,8192
v_exp_f32 v69, v69
TR 30,14,12288
s_waitcnt lgkmcnt(8)
MA 184,32,88
v_cvt_pk_bf16_f32 v68, v68, v69
v_exp_f32 v70, v70
MA 188,32,92
v_exp_f32 v71, v71
MA 192,32,96
s_add_u32 m0, s61, 0
s_add_u32 s66, s95, 122880
buffer_load_dwordx4 v3, s[48:51], s66 offen nt lds
TR 32,15,8192
v_cvt_pk_bf16_f32 v69, v70, v71
TR 34,15,12288
s_waitcnt lgkmcnt(8)
MA 196,16,88
v_exp_f32 v80, v80
MA 200,16,92
v_exp_f32 v81, v81
MA 204,16,96
ds_read_b128 v[16:19], v4 offset:24576
v_cvt_pk_bf16_f32 v70, v80, v81
v_exp_f32 v82, v82
s_waitcnt lgkmcnt(7)
MA 208,20,88
v_exp_f32 v83, v83
MA 212,20,92
v_cvt_pk_bf16_f32 v71, v82, v83
MA 216,20,96
ds_read_b128 v[20:23], v5 offset:24576
v_exp_f32 v72, v72
s_waitcnt lgkmcnt(6)
MA 220,24,88
v_exp_f32 v73, v73
MA 224,24,92
v_cvt_pk_bf16_f32 v72, v72, v73
v_exp_f32 v74, v74
MA 228,24,96
ds_read_b128 v[24:27], v6 offset:24576
v_exp_f32 v75, v75
s_waitcnt lgkmcnt(5)
MA 232,28,88
v_cvt_pk_bf16_f32 v73, v74, v75
MA 236,28,92
v_exp_f32 v84, v84
MA 240,28,96
s_add_u32 m0, s61, 4096
s_add_u32 s66, s95, 126976
buffer_load_dwordx4 v3, s[48:51], s66 offen nt lds
ds_read_b128 v[28:31], v7 offset:24576
v_exp_f32 v85, v85
s_waitcnt lgkmcnt(4)
MA 244,32,88
v_cvt_pk_bf16_f32 v74, v84, v85
v_exp_f32 v86, v86
MA 248,32,92
v_exp_f32 v87, v87
MA 252,32,96
ds_read_b128 v[32:35], v4 offset:28672
v_cvt_pk_bf16_f32 v75, v86, v87
s_waitcnt lgkmcnt(4)
MC 88,16,112,52
MC 92,16,128,56
MC 96,16,144,60
ds_read_b128 v[16:19], v5 offset:28672
s_waitcnt lgkmcnt(4)
MA 88,20,116
MA 92,20,132
MA 96,20,148
ds_read_b128 v[20:23], v6 offset:28672
s_waitcnt lgkmcnt(4)
MA 88,24,120
MA 92,24,136
MA 96,24,152
s_add_u32 m0, s61, 73728
s_add_u32 s66, s95, 114688
buffer_load_dwordx4 v2, s[52:55], s66 offen nt lds
ds_read_b128 v[24:27], v7 offset:28672
s_waitcnt lgkmcnt(4)
MA 88,28,124
MA 92,28,140
MA 96,28,156
TR 28,8,16384
TR 30,8,20480
s_waitcnt lgkmcnt(5)
MC 100,32,112,52
MC 104,32,128,56
MC 108,32,144,60
TR 32,9,16384
v_exp_f32 v88, v88
TR 34,9,20480
s_waitcnt lgkmcnt(6)
MA 100,16,116
v_exp_f32 v89, v89
MA 104,16,132
v_cvt_pk_bf16_f32 v88, v88, v89
v_exp_f32 v90, v90
MA 108,16,148
TR 16,10,16384
v_exp_f32 v91, v91
TR 18,10,20480
s_waitcnt lgkmcnt(7)
MA 100,20,120
v_cvt_pk_bf16_f32 v89, v90, v91
MA 104,20,136
MA 108,20,152
s_add_u32 m0, s61, 77824
s_add_u32 s66, s95, 118784
buffer_load_dwordx4 v2, s[52:55], s66 offen nt lds
TR 20,11,16384
TR 22,11,20480
s_waitcnt lgkmcnt(8)
MA 100,24,124
MA 104,24,140
MA 108,24,156
TR 24,12,16384
TR 26,12,20480
s_waitcnt vmcnt(4)
s_barrier
MA 40,36,64
MA 44,36,68
MA 48,36,72
v_exp_f32 v100, v100
s_waitcnt lgkmcnt(8)
MA 160,28,64
v_exp_f32 v101, v101
MA 164,28,68
v_cvt_pk_bf16_f32 v90, v100, v101
v_exp_f32 v102, v102
MA 168,28,72
TR 28,13,16384
v_exp_f32 v103, v103
TR 30,13,20480
s_waitcnt lgkmcnt(8)
MA 172,32,64
v_cvt_pk_bf16_f32 v91, v102, v103
MA 176,32,68
v_exp_f32 v92, v92
MA 180,32,72
TR 32,14,16384
v_exp_f32 v93, v93
TR 34,14,20480
s_waitcnt lgkmcnt(8)
MA 184,16,64
v_cvt_pk_bf16_f32 v92, v92, v93
v_exp_f32 v94, v94
MA 188,16,68
v_exp_f32 v95, v95
MA 192,16,72
s_add_u32 m0, s61, 40960
s_add_u32 s66, s95, 122880
buffer_load_dwordx4 v2, s[52:55], s66 offen nt lds
TR 16,15,16384
v_cvt_pk_bf16_f32 v93, v94, v95
TR 18,15,20480
s_waitcnt lgkmcnt(8)
MA 196,20,64
v_exp_f32 v104, v104
MA 200,20,68
v_exp_f32 v105, v105
MA 204,20,72
ds_read_b128 v[20:23], v4 offset:32768
v_cvt_pk_bf16_f32 v94, v104, v105
v_exp_f32 v106, v106
s_waitcnt lgkmcnt(7)
MA 208,24,64
v_exp_f32 v107, v107
MA 212,24,68
v_cvt_pk_bf16_f32 v95, v106, v107
MA 216,24,72
ds_read_b128 v[24:27], v5 offset:32768
v_exp_f32 v96, v96
s_waitcnt lgkmcnt(6)
MA 220,28,64
v_exp_f32 v97, v97
MA 224,28,68
v_cvt_pk_bf16_f32 v96, v96, v97
v_exp_f32 v98, v98
MA 228,28,72
ds_read_b128 v[28:31], v6 offset:32768
v_exp_f32 v99, v99
s_waitcnt lgkmcnt(5)
MA 232,32,64
v_cvt_pk_bf16_f32 v97, v98, v99
MA 236,32,68
v_exp_f32 v108, v108
MA 240,32,72
s_add_u32 m0, s61, 45056
s_add_u32 s66, s95, 126976
buffer_load_dwordx4 v2, s[52:55], s66 offen nt lds
ds_read_b128 v[32:35], v7 offset:32768
v_exp_f32 v109, v109
s_waitcnt lgkmcnt(4)
MA 244,16,64
v_cvt_pk_bf16_f32 v98, v108, v109
v_exp_f32 v110, v110
MA 248,16,68
v_exp_f32 v111, v111
MA 252,16,72
ds_read_b128 v[16:19], v4 offset:36864
v_cvt_pk_bf16_f32 v99, v110, v111
s_waitcnt lgkmcnt(4)
MC 64,20,112,52
MC 68,20,128,56
MC 72,20,144,60
ds_read_b128 v[20:23], v5 offset:36864
s_waitcnt lgkmcnt(4)
MA 64,24,116
MA 68,24,132
MA 72,24,148
ds_read_b128 v[24:27], v6 offset:36864
s_waitcnt lgkmcnt(4)
MA 64,28,120
MA 68,28,136
MA 72,28,152
ds_read_b128 v[28:31], v7 offset:36864
s_waitcnt lgkmcnt(4)
MA 64,32,124
MA 68,32,140
MA 72,32,156
TR 32,8,24576
TR 34,8,28672
s_waitcnt lgkmcnt(5)
MC 76,16,112,52
MC 80,16,128,56
MC 84,16,144,60
TR 16,9,24576
v_exp_f32 v64, v64
TR 18,9,28672
s_waitcnt lgkmcnt(6)
MA 76,20,116
v_exp_f32 v65, v65
MA 80,20,132
v_cvt_pk_bf16_f32 v64, v64, v65
v_exp_f32 v66, v66
MA 84,20,148
TR 20,10,24576
v_exp_f32 v67, v67
TR 22,10,28672
s_waitcnt lgkmcnt(7)
MA 76,24,120
v_cvt_pk_bf16_f32 v65, v66, v67
MA 80,24,136
MA 84,24,152
TR 24,11,24576
TR 26,11,28672
s_waitcnt lgkmcnt(8)
MA 76,28,124
MA 80,28,140
MA 84,28,156
TR 28,12,24576
TR 30,12,28672
s_waitcnt vmcnt(2)
s_barrier
MA 40,36,88
MA 44,36,92
MA 48,36,96
v_exp_f32 v76, v76
s_waitcnt lgkmcnt(8)
MA 160,32,88
v_exp_f32 v77, v77
MA 164,32,92
v_cvt_pk_bf16_f32 v66, v76, v77
v_exp_f32 v78, v78
MA 168,32,96
TR 32,13,24576
v_exp_f32 v79, v79
TR 34,13,28672
s_waitcnt lgkmcnt(8)
MA 172,16,88
v_cvt_pk_bf16_f32 v67, v78, v79
MA 176,16,92
v_exp_f32 v68, v68
MA 180,16,96
TR 16,14,24576
v_exp_f32 v69, v69
TR 18,14,28672
s_waitcnt lgkmcnt(8)
MA 184,20,88
v_cvt_pk_bf16_f32 v68, v68, v69
v_exp_f32 v70, v70
MA 188,20,92
v_exp_f32 v71, v71
MA 192,20,96
TR 20,15,24576
v_cvt_pk_bf16_f32 v69, v70, v71
TR 22,15,28672
s_waitcnt lgkmcnt(8)
MA 196,24,88
v_exp_f32 v80, v80
MA 200,24,92
v_exp_f32 v81, v81
MA 204,24,96
ds_read_b128 v[24:27], v4 offset:0
v_cvt_pk_bf16_f32 v70, v80, v81
v_exp_f32 v82, v82
s_waitcnt lgkmcnt(7)
MA 208,28,88
v_exp_f32 v83, v83
MA 212,28,92
v_cvt_pk_bf16_f32 v71, v82, v83
MA 216,28,96
ds_read_b128 v[28:31], v5 offset:0
v_exp_f32 v72, v72
s_waitcnt lgkmcnt(6)
MA 220,32,88
v_exp_f32 v73, v73
MA 224,32,92
v_cvt_pk_bf16_f32 v72, v72, v73
v_exp_f32 v74, v74
MA 228,32,96
ds_read_b128 v[32:35], v6 offset:0
v_exp_f32 v75, v75
s_waitcnt lgkmcnt(5)
MA 232,16,88
v_cvt_pk_bf16_f32 v73, v74, v75
MA 236,16,92
v_exp_f32 v84, v84
MA 240,16,96
ds_read_b128 v[16:19], v7 offset:0
v_exp_f32 v85, v85
s_waitcnt lgkmcnt(4)
MA 244,20,88
v_cvt_pk_bf16_f32 v74, v84, v85
v_exp_f32 v86, v86
MA 248,20,92
v_exp_f32 v87, v87
MA 252,20,96
ds_read_b128 v[20:23], v4 offset:4096
v_cvt_pk_bf16_f32 v75, v86, v87
s_waitcnt lgkmcnt(4)
MC 88,24,112,52
MC 92,24,128,56
MC 96,24,144,60
ds_read_b128 v[24:27], v5 offset:4096
s_waitcnt lgkmcnt(4)
MA 88,28,116
MA 92,28,132
MA 96,28,148
ds_read_b128 v[28:31], v6 offset:4096
s_waitcnt lgkmcnt(4)
MA 88,32,120
MA 92,32,136
MA 96,32,152
ds_read_b128 v[32:35], v7 offset:4096
s_waitcnt lgkmcnt(4)
MA 88,16,124
MA 92,16,140
MA 96,16,156
TR 16,8,32768
TR 18,8,36864
s_waitcnt lgkmcnt(5)
MC 100,20,112,52
MC 104,20,128,56
MC 108,20,144,60
TR 20,9,32768
v_exp_f32 v88, v88
TR 22,9,36864
s_waitcnt lgkmcnt(6)
MA 100,24,116
v_exp_f32 v89, v89
MA 104,24,132
v_cvt_pk_bf16_f32 v88, v88, v89
v_exp_f32 v90, v90
MA 108,24,148
TR 24,10,32768
v_exp_f32 v91, v91
TR 26,10,36864
s_waitcnt lgkmcnt(7)
MA 100,28,120
v_cvt_pk_bf16_f32 v89, v90, v91
MA 104,28,136
MA 108,28,152
TR 28,11,32768
TR 30,11,36864
s_waitcnt lgkmcnt(8)
MA 100,32,124
MA 104,32,140
MA 108,32,156
TR 32,12,32768
TR 34,12,36864
s_waitcnt vmcnt(0)
s_barrier
MA 40,36,64
MA 44,36,68
MA 48,36,72
v_exp_f32 v100, v100
s_waitcnt lgkmcnt(8)
MA 160,16,64
v_exp_f32 v101, v101
MA 164,16,68
v_cvt_pk_bf16_f32 v90, v100, v101
v_exp_f32 v102, v102
MA 168,16,72
TR 16,13,32768
v_exp_f32 v103, v103
TR 18,13,36864
s_waitcnt lgkmcnt(8)
MA 172,20,64
v_cvt_pk_bf16_f32 v91, v102, v103
MA 176,20,68
v_exp_f32 v92, v92
MA 180,20,72
TR 20,14,32768
v_exp_f32 v93, v93
TR 22,14,36864
s_waitcnt lgkmcnt(8)
MA 184,24,64
v_cvt_pk_bf16_f32 v92, v92, v93
v_exp_f32 v94, v94
MA 188,24,68
v_exp_f32 v95, v95
MA 192,24,72
TR 24,15,32768
v_cvt_pk_bf16_f32 v93, v94, v95
TR 26,15,36864
s_waitcnt lgkmcnt(8)
MA 196,28,64
v_exp_f32 v104, v104
MA 200,28,68
v_exp_f32 v105, v105
MA 204,28,72
TR 28,8,0
v_cvt_pk_bf16_f32 v94, v104, v105
TR 30,8,4096
v_exp_f32 v106, v106
s_waitcnt lgkmcnt(8)
MA 208,32,64
v_exp_f32 v107, v107
MA 212,32,68
v_cvt_pk_bf16_f32 v95, v106, v107
MA 216,32,72
TR 32,9,0
v_exp_f32 v96, v96
TR 34,9,4096
s_waitcnt lgkmcnt(8)
MA 220,16,64
v_exp_f32 v97, v97
MA 224,16,68
v_cvt_pk_bf16_f32 v96, v96, v97
v_exp_f32 v98, v98
MA 228,16,72
TR 16,10,0
v_exp_f32 v99, v99
TR 18,10,4096
s_waitcnt lgkmcnt(8)
MA 232,20,64
v_cvt_pk_bf16_f32 v97, v98, v99
MA 236,20,68
v_exp_f32 v108, v108
MA 240,20,72
TR 20,11,0
v_exp_f32 v109, v109
TR 22,11,4096
s_waitcnt lgkmcnt(8)
MA 244,24,64
v_cvt_pk_bf16_f32 v98, v108, v109
v_exp_f32 v110, v110
MA 248,24,68
v_exp_f32 v111, v111
MA 252,24,72
TR 24,12,0
v_cvt_pk_bf16_f32 v99, v110, v111
TR 26,12,4096
MA 40,36,88
MA 44,36,92
MA 48,36,96
s_waitcnt lgkmcnt(8)
MA 160,28,88
MA 164,28,92
MA 168,28,96
TR 28,13,0
TR 30,13,4096
s_waitcnt lgkmcnt(8)
MA 172,32,88
MA 176,32,92
MA 180,32,96
TR 32,14,0
TR 34,14,4096
s_waitcnt lgkmcnt(8)
MA 184,16,88
MA 188,16,92
MA 192,16,96
TR 16,15,0
TR 18,15,4096
s_waitcnt lgkmcnt(8)
MA 196,20,88
MA 200,20,92
MA 204,20,96
s_waitcnt lgkmcnt(6)
MA 208,24,88
MA 212,24,92
MA 216,24,96
s_waitcnt lgkmcnt(4)
MA 220,28,88
MA 224,28,92
MA 228,28,96
s_waitcnt lgkmcnt(2)
MA 232,32,88
MA 236,32,92
MA 240,32,96
s_waitcnt lgkmcnt(0)
MA 244,16,88
MA 248,16,92
MA 252,16,96
s_waitcnt vmcnt(0) lgkmcnt(0)
s_nop 7
s_barrier
s_cmp_eq_u32 s99, 0
s_cbranch_scc0 L_fbn0
v_mbcnt_lo_u32_b32 v28, -1, 0
v_mbcnt_hi_u32_b32 v28, -1, v28
v_and_b32 v25, 15, v28
v_lshrrev_b32 v27, 4, v28
v_lshrrev_b32 v26, 1, v25
v_xor_b32 v26, v26, v27
v_lshlrev_b32 v26, 4, v26
v_lshl_add_u32 v26, v25, 7, v26
v_add_u32 v60, s32, v26
v_xor_b32 v61, 64, v60
v_lshrrev_b32 v24, 2, v28
v_and_b32 v24, 3, v24
v_lshl_add_u32 v25, v27, 3, v24
v_and_b32 v26, 1, v27
v_lshl_add_u32 v26, v26, 2, v24
v_lshlrev_b32 v26, 5, v26
v_lshl_add_u32 v26, v25, 8, v26
v_and_b32 v28, 3, v28
v_lshl_add_u32 v26, v28, 3, v26
v_add_u32 v26, 24576, v26
v_add_u32 v52, s63, v26
v_xor_b32 v53, 32, v52
v_xor_b32 v54, 64, v52
v_xor_b32 v55, 96, v52
v_xor_b32 v56, 128, v52
v_xor_b32 v57, 160, v52
v_xor_b32 v58, 192, v52
v_xor_b32 v59, 224, v52
v_rcp_f32 v42, v40
s_nop 0
v_mov_b32 v43, v42
v_rcp_f32 v46, v44
s_nop 0
v_mov_b32 v47, v46
v_rcp_f32 v50, v48
s_nop 0
v_mov_b32 v51, v50
v_pk_mul_f32 v[160:161], v[160:161], v[42:43]
v_pk_mul_f32 v[162:163], v[162:163], v[42:43]
v_pk_mul_f32 v[172:173], v[172:173], v[42:43]
v_pk_mul_f32 v[174:175], v[174:175], v[42:43]
v_cvt_pk_bf16_f32 v112, v160, v161
v_cvt_pk_bf16_f32 v113, v162, v163
v_cvt_pk_bf16_f32 v114, v172, v173
v_cvt_pk_bf16_f32 v115, v174, v175
v_pk_mul_f32 v[164:165], v[164:165], v[46:47]
v_pk_mul_f32 v[166:167], v[166:167], v[46:47]
v_pk_mul_f32 v[176:177], v[176:177], v[46:47]
v_pk_mul_f32 v[178:179], v[178:179], v[46:47]
v_cvt_pk_bf16_f32 v128, v164, v165
v_cvt_pk_bf16_f32 v129, v166, v167
v_cvt_pk_bf16_f32 v130, v176, v177
v_cvt_pk_bf16_f32 v131, v178, v179
v_pk_mul_f32 v[168:169], v[168:169], v[50:51]
v_pk_mul_f32 v[170:171], v[170:171], v[50:51]
v_pk_mul_f32 v[180:181], v[180:181], v[50:51]
v_pk_mul_f32 v[182:183], v[182:183], v[50:51]
v_cvt_pk_bf16_f32 v144, v168, v169
v_cvt_pk_bf16_f32 v145, v170, v171
v_cvt_pk_bf16_f32 v146, v180, v181
v_cvt_pk_bf16_f32 v147, v182, v183
v_pk_mul_f32 v[184:185], v[184:185], v[42:43]
v_pk_mul_f32 v[186:187], v[186:187], v[42:43]
v_pk_mul_f32 v[196:197], v[196:197], v[42:43]
v_pk_mul_f32 v[198:199], v[198:199], v[42:43]
v_cvt_pk_bf16_f32 v116, v184, v185
v_cvt_pk_bf16_f32 v117, v186, v187
v_cvt_pk_bf16_f32 v118, v196, v197
v_cvt_pk_bf16_f32 v119, v198, v199
v_pk_mul_f32 v[188:189], v[188:189], v[46:47]
v_pk_mul_f32 v[190:191], v[190:191], v[46:47]
v_pk_mul_f32 v[200:201], v[200:201], v[46:47]
v_pk_mul_f32 v[202:203], v[202:203], v[46:47]
v_cvt_pk_bf16_f32 v132, v188, v189
v_cvt_pk_bf16_f32 v133, v190, v191
v_cvt_pk_bf16_f32 v134, v200, v201
v_cvt_pk_bf16_f32 v135, v202, v203
v_pk_mul_f32 v[192:193], v[192:193], v[50:51]
v_pk_mul_f32 v[194:195], v[194:195], v[50:51]
v_pk_mul_f32 v[204:205], v[204:205], v[50:51]
v_pk_mul_f32 v[206:207], v[206:207], v[50:51]
v_cvt_pk_bf16_f32 v148, v192, v193
v_cvt_pk_bf16_f32 v149, v194, v195
v_cvt_pk_bf16_f32 v150, v204, v205
v_cvt_pk_bf16_f32 v151, v206, v207
v_pk_mul_f32 v[208:209], v[208:209], v[42:43]
v_pk_mul_f32 v[210:211], v[210:211], v[42:43]
v_pk_mul_f32 v[220:221], v[220:221], v[42:43]
v_pk_mul_f32 v[222:223], v[222:223], v[42:43]
v_cvt_pk_bf16_f32 v120, v208, v209
v_cvt_pk_bf16_f32 v121, v210, v211
v_cvt_pk_bf16_f32 v122, v220, v221
v_cvt_pk_bf16_f32 v123, v222, v223
v_pk_mul_f32 v[212:213], v[212:213], v[46:47]
v_pk_mul_f32 v[214:215], v[214:215], v[46:47]
v_pk_mul_f32 v[224:225], v[224:225], v[46:47]
v_pk_mul_f32 v[226:227], v[226:227], v[46:47]
v_cvt_pk_bf16_f32 v136, v212, v213
v_cvt_pk_bf16_f32 v137, v214, v215
v_cvt_pk_bf16_f32 v138, v224, v225
v_cvt_pk_bf16_f32 v139, v226, v227
v_pk_mul_f32 v[216:217], v[216:217], v[50:51]
v_pk_mul_f32 v[218:219], v[218:219], v[50:51]
v_pk_mul_f32 v[228:229], v[228:229], v[50:51]
v_pk_mul_f32 v[230:231], v[230:231], v[50:51]
v_cvt_pk_bf16_f32 v152, v216, v217
v_cvt_pk_bf16_f32 v153, v218, v219
v_cvt_pk_bf16_f32 v154, v228, v229
v_cvt_pk_bf16_f32 v155, v230, v231
v_pk_mul_f32 v[232:233], v[232:233], v[42:43]
v_pk_mul_f32 v[234:235], v[234:235], v[42:43]
v_pk_mul_f32 v[244:245], v[244:245], v[42:43]
v_pk_mul_f32 v[246:247], v[246:247], v[42:43]
v_cvt_pk_bf16_f32 v124, v232, v233
v_cvt_pk_bf16_f32 v125, v234, v235
v_cvt_pk_bf16_f32 v126, v244, v245
v_cvt_pk_bf16_f32 v127, v246, v247
v_pk_mul_f32 v[236:237], v[236:237], v[46:47]
v_pk_mul_f32 v[238:239], v[238:239], v[46:47]
v_pk_mul_f32 v[248:249], v[248:249], v[46:47]
v_pk_mul_f32 v[250:251], v[250:251], v[46:47]
v_cvt_pk_bf16_f32 v140, v236, v237
v_cvt_pk_bf16_f32 v141, v238, v239
v_cvt_pk_bf16_f32 v142, v248, v249
v_cvt_pk_bf16_f32 v143, v250, v251
v_pk_mul_f32 v[240:241], v[240:241], v[50:51]
v_pk_mul_f32 v[242:243], v[242:243], v[50:51]
v_pk_mul_f32 v[252:253], v[252:253], v[50:51]
v_pk_mul_f32 v[254:255], v[254:255], v[50:51]
v_cvt_pk_bf16_f32 v156, v240, v241
v_cvt_pk_bf16_f32 v157, v242, v243
v_cvt_pk_bf16_f32 v158, v252, v253
v_cvt_pk_bf16_f32 v159, v254, v255
s_lshl_b32 s73, s62, 2
s_add_u32 s73, s73, s78
v_mov_b32 v16, s73
v_mov_b32 v17, 0
ds_write_b32 v16, v17
s_add_u32 m0, s61, 12288
s_mov_b32 s66, 0
buffer_load_dwordx4 v1, s[40:43], s66 offen lds
s_add_u32 m0, s61, 16384
s_mov_b32 s66, 36864
buffer_load_dwordx4 v1, s[40:43], s66 offen lds
s_add_u32 m0, s61, 20480
s_mov_b32 s66, 73728
buffer_load_dwordx4 v1, s[40:43], s66 offen lds
s_add_u32 m0, s61, 49152
s_mov_b32 s66, 4096
buffer_load_dwordx4 v0, s[44:47], s66 offen lds
s_add_u32 m0, s61, 53248
s_mov_b32 s66, 135168
buffer_load_dwordx4 v0, s[44:47], s66 offen lds
s_add_u32 m0, s61, 24576
s_mov_b32 s66, 128
buffer_load_dwordx4 v1, s[40:43], s66 offen lds
s_add_u32 m0, s61, 28672
s_mov_b32 s66, 36992
buffer_load_dwordx4 v1, s[40:43], s66 offen lds
s_add_u32 m0, s61, 32768
s_mov_b32 s66, 73856
buffer_load_dwordx4 v1, s[40:43], s66 offen lds
s_add_u32 m0, s61, 65536
s_mov_b32 s66, 266240
buffer_load_dwordx4 v0, s[44:47], s66 offen lds
s_add_u32 m0, s61, 69632
s_mov_b32 s66, 397312
buffer_load_dwordx4 v0, s[44:47], s66 offen lds
s_add_u32 m0, s61, 40960
s_mov_b32 s66, 528384
buffer_load_dwordx4 v0, s[44:47], s66 offen lds
s_add_u32 m0, s61, 45056
s_mov_b32 s66, 659456
buffer_load_dwordx4 v0, s[44:47], s66 offen lds
s_add_u32 m0, s61, 0
s_mov_b32 s66, 256
buffer_load_dwordx4 v1, s[40:43], s66 offen lds
s_add_u32 m0, s61, 4096
s_mov_b32 s66, 37120
buffer_load_dwordx4 v1, s[40:43], s66 offen lds
s_add_u32 m0, s61, 8192
s_mov_b32 s66, 73984
buffer_load_dwordx4 v1, s[40:43], s66 offen lds
s_waitcnt vmcnt(0) lgkmcnt(0)
s_nop 7
s_branch L_after0
L_fbn0:
s_cmp_eq_u32 s99, 1
s_cbranch_scc0 L_fbn1
v_mbcnt_lo_u32_b32 v59, -1, 0
v_mbcnt_hi_u32_b32 v59, -1, v59
s_movk_i32 s75, 3641
s_mul_i32 s73, s60, 144
v_add_u32 v60, s73, v59
v_mul_u32_u24 v61, s75, v60
v_lshrrev_b32 v61, 16, v61
v_mul_u32_u24 v62, 18, v61
v_sub_u32 v62, v60, v62
v_mul_u32_u24 v61, 1152, v61
v_lshl_add_u32 v52, v62, 4, v61
v_add_u32 v60, s73, v59
v_add_u32 v60, 64, v60
v_mul_u32_u24 v61, s75, v60
v_lshrrev_b32 v61, 16, v61
v_mul_u32_u24 v62, 18, v61
v_sub_u32 v62, v60, v62
v_mul_u32_u24 v61, 1152, v61
v_lshl_add_u32 v53, v62, 4, v61
v_add_u32 v60, s73, v59
v_add_u32 v60, 128, v60
v_mul_u32_u24 v61, s75, v60
v_lshrrev_b32 v61, 16, v61
v_mul_u32_u24 v62, 18, v61
v_sub_u32 v62, v60, v62
v_mul_u32_u24 v61, 1152, v61
v_lshl_add_u32 v54, v62, 4, v61
v_lshrrev_b32 v60, 2, v59
v_mul_u32_u24 v60, 288, v60
v_and_b32 v61, 3, v59
v_lshl_add_u32 v60, v61, 3, v60
v_add_u32 v57, s63, v60
v_lshl_add_u32 v55, v59, 4, s94
v_add_u32 v58, 0, v55
buffer_load_dwordx4 v[112:115], v58, s[56:59], 0 offen offset:0 sc1
buffer_load_dwordx4 v[116:119], v58, s[56:59], s64 offen offset:0 sc1
buffer_load_dwordx4 v[120:123], v58, s[56:59], s65 offen offset:0 sc1
buffer_load_dwordx4 v[124:127], v58, s[56:59], 0 offen offset:1024 sc1
buffer_load_dwordx4 v[128:131], v58, s[56:59], s64 offen offset:1024 sc1
buffer_load_dwordx4 v[132:135], v58, s[56:59], s65 offen offset:1024 sc1
buffer_load_dwordx4 v[136:139], v58, s[56:59], 0 offen offset:2048 sc1
buffer_load_dwordx4 v[140:143], v58, s[56:59], s64 offen offset:2048 sc1
buffer_load_dwordx4 v[144:147], v58, s[56:59], s65 offen offset:2048 sc1
v_rcp_f32 v42, v40
s_nop 0
v_mov_b32 v43, v42
v_rcp_f32 v46, v44
s_nop 0
v_mov_b32 v47, v46
v_rcp_f32 v50, v48
s_nop 0
v_mov_b32 v51, v50
v_pk_mul_f32 v[160:161], v[160:161], v[42:43]
v_pk_mul_f32 v[162:163], v[162:163], v[42:43]
v_pk_mul_f32 v[172:173], v[172:173], v[42:43]
v_pk_mul_f32 v[174:175], v[174:175], v[42:43]
v_cvt_pk_bf16_f32 v64, v160, v161
v_cvt_pk_bf16_f32 v65, v162, v163
v_cvt_pk_bf16_f32 v66, v172, v173
v_cvt_pk_bf16_f32 v67, v174, v175
v_pk_mul_f32 v[164:165], v[164:165], v[46:47]
v_pk_mul_f32 v[166:167], v[166:167], v[46:47]
v_pk_mul_f32 v[176:177], v[176:177], v[46:47]
v_pk_mul_f32 v[178:179], v[178:179], v[46:47]
v_cvt_pk_bf16_f32 v68, v164, v165
v_cvt_pk_bf16_f32 v69, v166, v167
v_cvt_pk_bf16_f32 v70, v176, v177
v_cvt_pk_bf16_f32 v71, v178, v179
v_pk_mul_f32 v[168:169], v[168:169], v[50:51]
v_pk_mul_f32 v[170:171], v[170:171], v[50:51]
v_pk_mul_f32 v[180:181], v[180:181], v[50:51]
v_pk_mul_f32 v[182:183], v[182:183], v[50:51]
v_cvt_pk_bf16_f32 v72, v168, v169
v_cvt_pk_bf16_f32 v73, v170, v171
v_cvt_pk_bf16_f32 v74, v180, v181
v_cvt_pk_bf16_f32 v75, v182, v183
v_pk_mul_f32 v[184:185], v[184:185], v[42:43]
v_pk_mul_f32 v[186:187], v[186:187], v[42:43]
v_pk_mul_f32 v[196:197], v[196:197], v[42:43]
v_pk_mul_f32 v[198:199], v[198:199], v[42:43]
v_cvt_pk_bf16_f32 v76, v184, v185
v_cvt_pk_bf16_f32 v77, v186, v187
v_cvt_pk_bf16_f32 v78, v196, v197
v_cvt_pk_bf16_f32 v79, v198, v199
v_pk_mul_f32 v[188:189], v[188:189], v[46:47]
v_pk_mul_f32 v[190:191], v[190:191], v[46:47]
v_pk_mul_f32 v[200:201], v[200:201], v[46:47]
v_pk_mul_f32 v[202:203], v[202:203], v[46:47]
v_cvt_pk_bf16_f32 v80, v188, v189
v_cvt_pk_bf16_f32 v81, v190, v191
v_cvt_pk_bf16_f32 v82, v200, v201
v_cvt_pk_bf16_f32 v83, v202, v203
v_pk_mul_f32 v[192:193], v[192:193], v[50:51]
v_pk_mul_f32 v[194:195], v[194:195], v[50:51]
v_pk_mul_f32 v[204:205], v[204:205], v[50:51]
v_pk_mul_f32 v[206:207], v[206:207], v[50:51]
v_cvt_pk_bf16_f32 v84, v192, v193
v_cvt_pk_bf16_f32 v85, v194, v195
v_cvt_pk_bf16_f32 v86, v204, v205
v_cvt_pk_bf16_f32 v87, v206, v207
v_pk_mul_f32 v[208:209], v[208:209], v[42:43]
v_pk_mul_f32 v[210:211], v[210:211], v[42:43]
v_pk_mul_f32 v[220:221], v[220:221], v[42:43]
v_pk_mul_f32 v[222:223], v[222:223], v[42:43]
v_cvt_pk_bf16_f32 v100, v208, v209
v_cvt_pk_bf16_f32 v101, v210, v211
v_cvt_pk_bf16_f32 v102, v220, v221
v_cvt_pk_bf16_f32 v103, v222, v223
v_pk_mul_f32 v[212:213], v[212:213], v[46:47]
v_pk_mul_f32 v[214:215], v[214:215], v[46:47]
v_pk_mul_f32 v[224:225], v[224:225], v[46:47]
v_pk_mul_f32 v[226:227], v[226:227], v[46:47]
v_cvt_pk_bf16_f32 v104, v212, v213
v_cvt_pk_bf16_f32 v105, v214, v215
v_cvt_pk_bf16_f32 v106, v224, v225
v_cvt_pk_bf16_f32 v107, v226, v227
v_pk_mul_f32 v[216:217], v[216:217], v[50:51]
v_pk_mul_f32 v[218:219], v[218:219], v[50:51]
v_pk_mul_f32 v[228:229], v[228:229], v[50:51]
v_pk_mul_f32 v[230:231], v[230:231], v[50:51]
v_cvt_pk_bf16_f32 v108, v216, v217
v_cvt_pk_bf16_f32 v109, v218, v219
v_cvt_pk_bf16_f32 v110, v228, v229
v_cvt_pk_bf16_f32 v111, v230, v231
v_pk_mul_f32 v[232:233], v[232:233], v[42:43]
v_pk_mul_f32 v[234:235], v[234:235], v[42:43]
v_pk_mul_f32 v[244:245], v[244:245], v[42:43]
v_pk_mul_f32 v[246:247], v[246:247], v[42:43]
v_cvt_pk_bf16_f32 v88, v232, v233
v_cvt_pk_bf16_f32 v89, v234, v235
v_cvt_pk_bf16_f32 v90, v244, v245
v_cvt_pk_bf16_f32 v91, v246, v247
v_pk_mul_f32 v[236:237], v[236:237], v[46:47]
v_pk_mul_f32 v[238:239], v[238:239], v[46:47]
v_pk_mul_f32 v[248:249], v[248:249], v[46:47]
v_pk_mul_f32 v[250:251], v[250:251], v[46:47]
v_cvt_pk_bf16_f32 v92, v236, v237
v_cvt_pk_bf16_f32 v93, v238, v239
v_cvt_pk_bf16_f32 v94, v248, v249
v_cvt_pk_bf16_f32 v95, v250, v251
v_pk_mul_f32 v[240:241], v[240:241], v[50:51]
v_pk_mul_f32 v[242:243], v[242:243], v[50:51]
v_pk_mul_f32 v[252:253], v[252:253], v[50:51]
v_pk_mul_f32 v[254:255], v[254:255], v[50:51]
v_cvt_pk_bf16_f32 v96, v240, v241
v_cvt_pk_bf16_f32 v97, v242, v243
v_cvt_pk_bf16_f32 v98, v252, v253
v_cvt_pk_bf16_f32 v99, v254, v255
s_lshl_b32 s73, s62, 2
s_add_u32 s73, s73, s78
v_mov_b32 v16, s73
v_mov_b32 v17, 0
ds_write_b32 v16, v17
s_add_u32 m0, s88, 27648
s_add_u32 s66, s8, 2359296
buffer_load_dwordx4 v52, s[16:19], s66 offen lds
s_add_u32 m0, s88, 28672
s_add_u32 s66, s8, 2359296
buffer_load_dwordx4 v53, s[16:19], s66 offen lds
s_add_u32 m0, s88, 29696
s_add_u32 s66, s8, 2359296
s_mov_b64 exec, 0xffff
buffer_load_dwordx4 v54, s[16:19], s66 offen lds
s_mov_b64 exec, -1
s_add_u32 m0, s88, 0
s_add_u32 s66, s8, 2396160
buffer_load_dwordx4 v52, s[16:19], s66 offen lds
s_add_u32 m0, s88, 1024
s_add_u32 s66, s8, 2396160
buffer_load_dwordx4 v53, s[16:19], s66 offen lds
s_add_u32 m0, s88, 2048
s_add_u32 s66, s8, 2396160
s_mov_b64 exec, 0xffff
buffer_load_dwordx4 v54, s[16:19], s66 offen lds
s_mov_b64 exec, -1
s_add_u32 m0, s88, 9216
s_add_u32 s66, s8, 2433024
buffer_load_dwordx4 v52, s[16:19], s66 offen lds
s_add_u32 m0, s88, 10240
s_add_u32 s66, s8, 2433024
buffer_load_dwordx4 v53, s[16:19], s66 offen lds
s_add_u32 m0, s88, 11264
s_add_u32 s66, s8, 2433024
s_mov_b64 exec, 0xffff
buffer_load_dwordx4 v54, s[16:19], s66 offen lds
s_mov_b64 exec, -1
s_add_u32 m0, s88, 18432
s_add_u32 s66, s8, 2469888
buffer_load_dwordx4 v52, s[16:19], s66 offen lds
s_add_u32 m0, s88, 19456
s_add_u32 s66, s8, 2469888
buffer_load_dwordx4 v53, s[16:19], s66 offen lds
s_add_u32 m0, s88, 20480
s_add_u32 s66, s8, 2469888
s_mov_b64 exec, 0xffff
buffer_load_dwordx4 v54, s[16:19], s66 offen lds
s_mov_b64 exec, -1
s_add_u32 m0, s88, 46080
s_mov_b32 s66, 0
buffer_load_dwordx4 v52, s[16:19], s66 offen lds
s_add_u32 m0, s88, 47104
s_mov_b32 s66, 0
buffer_load_dwordx4 v53, s[16:19], s66 offen lds
s_add_u32 m0, s88, 48128
s_mov_b32 s66, 0
s_mov_b64 exec, 0xffff
buffer_load_dwordx4 v54, s[16:19], s66 offen lds
s_mov_b64 exec, -1
s_add_u32 m0, s88, 55296
s_mov_b32 s66, 36864
buffer_load_dwordx4 v52, s[16:19], s66 offen lds
s_add_u32 m0, s88, 56320
s_mov_b32 s66, 36864
buffer_load_dwordx4 v53, s[16:19], s66 offen lds
s_add_u32 m0, s88, 57344
s_mov_b32 s66, 36864
s_mov_b64 exec, 0xffff
buffer_load_dwordx4 v54, s[16:19], s66 offen lds
s_mov_b64 exec, -1
s_waitcnt vmcnt(0) lgkmcnt(0)
s_nop 7
s_branch L_after1
L_fbn1:
s_endpgm
.section .rodata,"a"
.p2align 6
.amdhsa_kernel concat_heads__mha_block_cached__mha_block_cached__near_ridge_kernel
  .amdhsa_next_free_vgpr 256
  .amdhsa_next_free_sgpr 100
  .amdhsa_accum_offset 256
  .amdhsa_group_segment_fixed_size 0
  .amdhsa_kernarg_size 104
  .amdhsa_user_sgpr_count 2
  .amdhsa_user_sgpr_kernarg_segment_ptr 1
  .amdhsa_system_sgpr_workgroup_id_x 1
.end_amdhsa_kernel
```
